```python
import torch

def _softmax(x, axis=-1):
    return torch.softmax(x, dim=axis)
def _gelu(x):
    return torch.nn.functional.gelu(x, approximate="tanh")
def _silu(x):
    return torch.nn.functional.silu(x)
def _sigmoid(x):
    return torch.sigmoid(x)
def _layernorm(x, axis=-1, eps=1e-5):
    m = x.mean(dim=axis, keepdim=True)
    v = x.var(dim=axis, keepdim=True, unbiased=False)
    return (x - m) / torch.sqrt(v + eps)
def _scatter_add(tgt, idx, src, axis=0):
    return tgt.clone().index_add_(axis, idx, src)
def _segment_sum(src, seg, n):
    out = torch.zeros((n,) + src.shape[1:], dtype=src.dtype)
    return out.index_add_(0, seg, src)
def _pad(x, pw):
    flat = tuple(v for pair in reversed(pw) for v in pair)
    return torch.nn.functional.pad(x, flat)

kernel_name = 'interleave_layers__grouped_kv_mqa__dense_activation_gelu__prompt'

def setup_inputs():

    _w = (lambda a: (lambda t: t.to(torch.bfloat16) if t.is_floating_point() else t)(torch.as_tensor(a)))
    def _A_setup():
        B, S, D, H = 1, 2048, 640, 32
        Dh = D // H
        return {
            "x": _w((lambda *s: torch.randn(*s, dtype=torch.bfloat16) * 0.05)(B, S, D)),
            "wq": _w((lambda *s: torch.randn(*s, dtype=torch.bfloat16) * 0.05)(D, H * Dh)),
            "wk": _w((lambda *s: torch.randn(*s, dtype=torch.bfloat16) * 0.05)(D, Dh)),
            "wv": _w((lambda *s: torch.randn(*s, dtype=torch.bfloat16) * 0.05)(D, Dh)),
            "wo": _w((lambda *s: torch.randn(*s, dtype=torch.bfloat16) * 0.05)(H * Dh, D)),
        }
    _A_in = _A_setup()

    def _B_setup():
        B, S, D, F = 1, 2048, 640, 1536
        return {
            "x": _w((lambda *s: torch.randn(*s, dtype=torch.bfloat16) * 0.05)(B, S, D)),
            "w1": _w((lambda *s: torch.randn(*s, dtype=torch.bfloat16) * 0.8)(D, F) * (D ** -0.5)),
            "b1": _w((lambda *s: torch.randn(*s, dtype=torch.bfloat16) * 0.8)(F) * 0.01),
            "w2": _w((lambda *s: torch.randn(*s, dtype=torch.bfloat16) * 0.8)(F, D) * (F ** -0.5)),
            "b2": _w((lambda *s: torch.randn(*s, dtype=torch.bfloat16) * 0.8)(D) * 0.01),
        }
    _B_in = _B_setup()

    return {
        "A_x": _A_in["x"],
        "A_wq": _A_in["wq"],
        "A_wk": _A_in["wk"],
        "A_wv": _A_in["wv"],
        "A_wo": _A_in["wo"],
        "B_x": _B_in["x"],
        "B_w1": _B_in["w1"],
        "B_b1": _B_in["b1"],
        "B_w2": _B_in["w2"],
        "B_b2": _B_in["b2"],
    }

def reference(A_x, A_wq, A_wk, A_wv, A_wo, B_x, B_w1, B_b1, B_w2, B_b2):
    def _A_ref(x, wq, wk, wv, wo):
        B, S, D = x.shape
        H = 32
        Dh = D // H
        q = (lambda x, *d: x.permute(*d))((x @ wq).reshape(B, S, H, Dh), 0, 2, 1, 3)
        k = x @ wk
        v = x @ wv
        scores = torch.einsum("bhqd,bkd->bhqk", q, k) * (Dh ** -0.5)
        p = _softmax(scores, axis=-1)
        o = torch.einsum("bhqk,bkd->bhqd", p, v)
        return (lambda x, *d: x.permute(*d))(o, 0, 2, 1, 3).reshape(B, S, H * Dh) @ wo

    def _B_ref(x, w1, b1, w2, b2):
        h = torch.einsum("bsd,df->bsf", x, w1) + b1
        h = _gelu(h)
        return torch.einsum("bsf,fd->bsd", h, w2) + b2

    x = A_x
    x = x + _A_ref(_layernorm(x, axis=-1), A_wq, A_wk, A_wv, A_wo)
    x = x + _B_ref(_layernorm(x, axis=-1), B_w1, B_b1, B_w2, B_b2)
    x = x + _A_ref(_layernorm(x, axis=-1), A_wq, A_wk, A_wv, A_wo)
    x = x + _B_ref(_layernorm(x, axis=-1), B_w1, B_b1, B_w2, B_b2)
    return x
```

```asm
; @launch grid=(256,1,1) block=(256,1,1) lds=163840
.amdgcn_target "amdgcn-amd-amdhsa--gfx950"
.text
.globl interleave_layers__grouped_kv_mqa__dense_activation_gelu__prompt_kernel
.p2align 8
.type interleave_layers__grouped_kv_mqa__dense_activation_gelu__prompt_kernel,@function
interleave_layers__grouped_kv_mqa__dense_activation_gelu__prompt_kernel:
  s_cmp_ge_u32 s2, 256
  s_cbranch_scc1 L_END
  s_load_dwordx16 s[64:79], s[0:1], 0
  s_load_dwordx8 s[80:87], s[0:1], 64
  s_load_dwordx2 s[88:89], s[0:1], 96
  v_lshrrev_b32 v5, 6, v0
  v_and_b32 v1, 63, v0
  v_readfirstlane_b32 s28, v5
  v_lshlrev_b32 v2, 4, v1
  v_and_b32 v3, 15, v1
  v_lshrrev_b32 v4, 4, v1
  s_lshr_b32 s30, s2, 3
  s_and_b32 s30, s30, 7
  s_and_b32 s3, s2, 7
  s_lshl_b32 s3, s3, 2
  s_lshr_b32 s29, s2, 6
  s_add_u32 s29, s29, s3
  s_lshl_b32 s31, s29, 3
  s_add_u32 s31, s31, s30
  s_waitcnt lgkmcnt(0)
  s_mov_b32 s8, s88
  s_and_b32 s9, s89, 0xffff
  s_mov_b32 s10, 0x24ea000
  s_mov_b32 s11, 0x20000
  s_mov_b32 s12, s64
  s_and_b32 s13, s65, 0xffff
  s_mov_b32 s14, 0x280000
  s_mov_b32 s15, 0x20000
  s_mov_b32 s16, s84
  s_and_b32 s17, s85, 0xffff
  s_mov_b32 s18, 0x280000
  s_mov_b32 s19, 0x20000
  s_mov_b32 s20, s86
  s_and_b32 s21, s87, 0xffff
  s_mov_b32 s22, 0x100
  s_mov_b32 s23, 0x20000
  s_getreg_b32 s35, hwreg(HW_REG_XCC_ID)
  s_and_b32 s35, s35, 15
  s_or_b32 s35, s35, 0x100
  s_mov_b32 s34, 0
  s_mov_b32 s32, 0
  s_getpc_b64 s[38:39]
L_PC0:
  s_sub_u32 s38, s38, L_PC0-interleave_layers__grouped_kv_mqa__dense_activation_gelu__prompt_kernel
  s_subb_u32 s39, s39, 0
  s_lshr_b32 s40, s2, 3
  s_mul_i32 s40, s40, 3072
  s_mul_i32 s41, s28, 0
  s_cmp_eq_u32 s28, 3
  s_cbranch_scc0 CP_1
  v_add_u32 v250, s40, v2
  v_min_u32 v251, 64256, v250
  global_load_dword v249, v251, s[38:39]
  v_add_u32 v250, 1024, v250
  v_min_u32 v251, 64256, v250
  global_load_dword v249, v251, s[38:39]
  v_add_u32 v250, 1024, v250
  v_min_u32 v251, 64256, v250
  global_load_dword v249, v251, s[38:39]
  s_nop 0
CP_1:
  v_mov_b32 v5, 0x40000000
  v_mov_b32 v6, v2
  v_mov_b32 v119, v2
  s_lshl_b32 s39, s29, 7
  s_add_u32 s39, s39, 0
  s_lshl_b32 s33, s30, 2
  s_add_u32 s33, s33, s39
  s_cmp_eq_u32 s28, 0
  s_cbranch_scc0 ZF_2
  v_mov_b32 v8, 0
  v_mov_b32 v9, s35
  s_lshl_b32 s40, s29, 7
  s_lshl_b32 s41, s30, 2
  s_add_u32 s40, s40, s41
  s_add_u32 s40, s40, 0
  s_lshl_b32 s41, s31, 2
  s_mov_b64 exec, 1
  buffer_store_dword v8, v8, s[8:11], s40 offen sc1
  s_add_u32 s40, s41, 4096
  buffer_store_dword v8, v8, s[8:11], s40 offen sc1
  s_add_u32 s40, s41, 12288
  buffer_store_dword v8, v8, s[8:11], s40 offen sc1
  s_add_u32 s40, s41, 8192
  buffer_store_dword v9, v8, s[8:11], s40 offen sc1
  s_and_b32 s40, s2, 7
  s_lshl_b32 s40, s40, 7
  s_lshr_b32 s42, s2, 3
  s_lshl_b32 s42, s42, 2
  s_add_u32 s40, s40, s42
  s_add_u32 s40, s40, 16384
  buffer_store_dword v8, v8, s[8:11], s40 offen sc1
  s_mov_b64 exec, -1
ZF_2:
  s_mov_b32 s24, s12
  s_mov_b32 s25, s13
  s_mov_b32 s26, s14
  s_mov_b32 s27, s15
  v_mul_u32_u24 v8, 1280, v3
  v_lshlrev_b32 v9, 4, v4
  v_add_u32 v8, v8, v9
  s_mov_b32 s46, 64
  s_mov_b32 s47, 0
  s_lshl_b32 s40, s29, 2
  s_mul_i32 s40, s40, 20480
  s_add_u32 s47, s47, s40
  s_lshr_b32 s49, s30, 2
  s_and_b32 s50, s30, 3
  s_lshl_b32 s51, s30, 2
  s_add_u32 s51, s51, s28
  v_lshrrev_b32 v9, 3, v1
  v_and_b32 v8, 7, v1
  v_xor_b32 v8, v8, v9
  v_lshlrev_b32 v8, 4, v8
  v_mul_u32_u24 v9, 1280, v9
  v_add_u32 v8, v8, v9
  s_mov_b32 s41, 0x1999999a
  s_lshl_b32 s40, s28, 6
  v_add_u32 v11, s40, v1
  v_mul_hi_u32 v12, v11, s41
  v_mul_u32_u24 v13, 10, v12
  v_sub_u32 v13, v11, v13
  v_mul_u32_u24 v12, 1280, v12
  v_lshlrev_b32 v13, 4, v13
  v_add_u32 v116, v12, v13
  v_add_u32 v11, 256, v1
  v_mul_hi_u32 v12, v11, s41
  v_mul_u32_u24 v13, 10, v12
  v_sub_u32 v13, v11, v13
  v_mul_u32_u24 v12, 1280, v12
  v_lshlrev_b32 v13, 4, v13
  v_add_u32 v117, v12, v13
  s_mov_b32 s52, s66
  s_and_b32 s53, s67, 0xffff
  s_mov_b32 s54, 0xc8000
  s_mov_b32 s55, 0x20000
  s_lshr_b32 s86, s2, 3
  s_min_u32 s86, s86, 19
  s_and_b32 s87, s2, 7
  s_mul_i32 s45, s86, 40960
  s_mul_i32 s41, s87, 160
  s_add_u32 s45, s45, s41
  s_lshl_b32 s40, s28, 10
  s_add_u32 m0, s40, 82432
  s_nop 0
  buffer_load_dwordx4 v116, s[52:55], s45 offen lds
  s_mov_b32 m0, 86528
  s_nop 0
  buffer_load_dwordx4 v117, s[52:55], s45 offen lds
  s_mul_i32 s40, s50, 20480
  s_add_u32 s44, s47, s40
  s_mul_i32 s41, s28, 5
  s_add_u32 s41, s41, 0
  s_and_b32 s42, s41, 1
  s_mul_i32 s42, s42, 10240
  s_lshr_b32 s45, s41, 1
  s_lshl_b32 s45, s45, 7
  s_add_u32 s45, s45, s42
  s_add_u32 s45, s45, s44
  s_lshl_b32 m0, s41, 10
  s_nop 0
  buffer_load_dwordx4 v8, s[24:27], s45 offen lds
  s_mul_i32 s41, s28, 5
  s_add_u32 s41, s41, 1
  s_and_b32 s42, s41, 1
  s_mul_i32 s42, s42, 10240
  s_lshr_b32 s45, s41, 1
  s_lshl_b32 s45, s45, 7
  s_add_u32 s45, s45, s42
  s_add_u32 s45, s45, s44
  s_lshl_b32 m0, s41, 10
  s_nop 0
  buffer_load_dwordx4 v8, s[24:27], s45 offen lds
  s_mul_i32 s41, s28, 5
  s_add_u32 s41, s41, 2
  s_and_b32 s42, s41, 1
  s_mul_i32 s42, s42, 10240
  s_lshr_b32 s45, s41, 1
  s_lshl_b32 s45, s45, 7
  s_add_u32 s45, s45, s42
  s_add_u32 s45, s45, s44
  s_lshl_b32 m0, s41, 10
  s_nop 0
  buffer_load_dwordx4 v8, s[24:27], s45 offen lds
  s_mul_i32 s41, s28, 5
  s_add_u32 s41, s41, 3
  s_and_b32 s42, s41, 1
  s_mul_i32 s42, s42, 10240
  s_lshr_b32 s45, s41, 1
  s_lshl_b32 s45, s45, 7
  s_add_u32 s45, s45, s42
  s_add_u32 s45, s45, s44
  s_lshl_b32 m0, s41, 10
  s_nop 0
  buffer_load_dwordx4 v8, s[24:27], s45 offen lds
  s_mul_i32 s41, s28, 5
  s_add_u32 s41, s41, 4
  s_and_b32 s42, s41, 1
  s_mul_i32 s42, s42, 10240
  s_lshr_b32 s45, s41, 1
  s_lshl_b32 s45, s45, 7
  s_add_u32 s45, s45, s42
  s_add_u32 s45, s45, s44
  s_lshl_b32 m0, s41, 10
  s_nop 0
  buffer_load_dwordx4 v8, s[24:27], s45 offen lds
  s_cmp_eq_u32 s49, 0
  s_cselect_b32 s40, s68, s70
  s_cselect_b32 s41, s69, s71
  s_mov_b32 s52, s40
  s_and_b32 s53, s41, 0xffff
  s_mov_b32 s54, 25600
  s_mov_b32 s55, 0x20000
  s_lshl_b32 s40, s28, 10
  s_add_u32 s40, s40, 0
  s_min_u32 s40, s40, 24576
  s_add_u32 m0, s40, 122880
  s_nop 0
  buffer_load_dwordx4 v2, s[52:55], s40 offen lds
  s_lshl_b32 s40, s28, 10
  s_add_u32 s40, s40, 4096
  s_min_u32 s40, s40, 24576
  s_add_u32 m0, s40, 122880
  s_nop 0
  buffer_load_dwordx4 v2, s[52:55], s40 offen lds
  s_lshl_b32 s40, s28, 10
  s_add_u32 s40, s40, 8192
  s_min_u32 s40, s40, 24576
  s_add_u32 m0, s40, 122880
  s_nop 0
  buffer_load_dwordx4 v2, s[52:55], s40 offen lds
  s_lshl_b32 s40, s28, 10
  s_add_u32 s40, s40, 12288
  s_min_u32 s40, s40, 24576
  s_add_u32 m0, s40, 122880
  s_nop 0
  buffer_load_dwordx4 v2, s[52:55], s40 offen lds
  s_lshl_b32 s40, s28, 10
  s_add_u32 s40, s40, 16384
  s_min_u32 s40, s40, 24576
  s_add_u32 m0, s40, 122880
  s_nop 0
  buffer_load_dwordx4 v2, s[52:55], s40 offen lds
  s_lshl_b32 s40, s28, 10
  s_add_u32 s40, s40, 20480
  s_min_u32 s40, s40, 24576
  s_add_u32 m0, s40, 122880
  s_nop 0
  buffer_load_dwordx4 v2, s[52:55], s40 offen lds
  s_lshl_b32 s40, s28, 10
  s_add_u32 s40, s40, 24576
  s_min_u32 s40, s40, 24576
  s_add_u32 m0, s40, 122880
  s_nop 0
  buffer_load_dwordx4 v2, s[52:55], s40 offen lds
  s_cmp_lt_u32 s31, 96
  s_cbranch_scc0 PI2_3
  s_load_dwordx2 s[52:53], s[0:1], 48
  s_mov_b32 s54, 0x1e0000
  s_mov_b32 s55, 0x20000
  s_waitcnt lgkmcnt(0)
  s_and_b32 s53, s53, 0xffff
  s_sub_u32 s40, s31, 0
  s_lshr_b32 s65, s40, 2
  s_and_b32 s40, s40, 3
  s_mul_i32 s66, s40, 5
  v_lshrrev_b32 v11, 3, v1
  v_mul_u32_u24 v11, 3072, v11
  v_and_b32 v12, 7, v1
  v_lshlrev_b32 v12, 4, v12
  v_add_u32 v11, v11, v12
  s_mul_i32 s45, s66, 98304
  s_lshl_b32 s40, s65, 7
  s_add_u32 s45, s45, s40
  s_mul_i32 s40, s28, 24576
  s_add_u32 s45, s45, s40
  s_lshl_b32 s44, s28, 10
  s_add_u32 m0, s44, 87552
  s_nop 0
  buffer_load_dwordx4 v11, s[52:55], s45 offen lds
  s_add_u32 s45, s45, 98304
  s_add_u32 m0, s44, 91648
  s_nop 0
  buffer_load_dwordx4 v11, s[52:55], s45 offen lds
  s_add_u32 s45, s45, 98304
  s_add_u32 m0, s44, 95744
  s_nop 0
  buffer_load_dwordx4 v11, s[52:55], s45 offen lds
  s_add_u32 s45, s45, 98304
  s_add_u32 m0, s44, 99840
  s_nop 0
  buffer_load_dwordx4 v11, s[52:55], s45 offen lds
  s_add_u32 s45, s45, 98304
  s_add_u32 m0, s44, 103936
  s_nop 0
  buffer_load_dwordx4 v11, s[52:55], s45 offen lds
  s_add_u32 m0, s44, 103936
  s_nop 0
  buffer_load_dwordx4 v11, s[52:55], s45 offen lds
  s_branch PIj_6
PI2_3:
  s_cmp_lt_u32 s31, 176
  s_cbranch_scc0 PIo_4
  s_load_dwordx2 s[52:53], s[0:1], 64
  s_mov_b32 s54, 0x1e0000
  s_mov_b32 s55, 0x20000
  s_waitcnt lgkmcnt(0)
  s_and_b32 s53, s53, 0xffff
  s_sub_u32 s40, s31, 96
  s_lshr_b32 s65, s40, 3
  s_and_b32 s40, s40, 7
  s_mul_i32 s66, s40, 6
  v_lshrrev_b32 v11, 3, v1
  v_mul_u32_u24 v11, 1280, v11
  v_and_b32 v12, 7, v1
  v_lshlrev_b32 v12, 4, v12
  v_add_u32 v11, v11, v12
  s_mul_i32 s45, s66, 40960
  s_lshl_b32 s40, s65, 7
  s_add_u32 s45, s45, s40
  s_mul_i32 s40, s28, 10240
  s_add_u32 s45, s45, s40
  s_lshl_b32 s44, s28, 10
  s_add_u32 m0, s44, 87552
  s_nop 0
  buffer_load_dwordx4 v11, s[52:55], s45 offen lds
  s_add_u32 s45, s45, 40960
  s_add_u32 m0, s44, 91648
  s_nop 0
  buffer_load_dwordx4 v11, s[52:55], s45 offen lds
  s_add_u32 s45, s45, 40960
  s_add_u32 m0, s44, 95744
  s_nop 0
  buffer_load_dwordx4 v11, s[52:55], s45 offen lds
  s_add_u32 s45, s45, 40960
  s_add_u32 m0, s44, 99840
  s_nop 0
  buffer_load_dwordx4 v11, s[52:55], s45 offen lds
  s_add_u32 s45, s45, 40960
  s_add_u32 m0, s44, 103936
  s_nop 0
  buffer_load_dwordx4 v11, s[52:55], s45 offen lds
  s_add_u32 s45, s45, 40960
  s_add_u32 m0, s44, 108032
  s_nop 0
  buffer_load_dwordx4 v11, s[52:55], s45 offen lds
  s_branch PIj_6
PIo_4:
  s_cmp_lt_u32 s31, 216
  s_cbranch_scc0 PIx_7
  s_load_dwordx2 s[52:53], s[0:1], 32
  s_mov_b32 s54, 0xc8000
  s_mov_b32 s55, 0x20000
  s_waitcnt lgkmcnt(0)
  s_and_b32 s53, s53, 0xffff
  s_sub_u32 s40, s31, 176
  s_lshr_b32 s65, s40, 2
  s_and_b32 s40, s40, 3
  s_mul_i32 s66, s40, 5
  v_lshrrev_b32 v11, 3, v1
  v_mul_u32_u24 v11, 1280, v11
  v_and_b32 v12, 7, v1
  v_lshlrev_b32 v12, 4, v12
  v_add_u32 v11, v11, v12
  s_mul_i32 s45, s66, 40960
  s_lshl_b32 s40, s65, 7
  s_add_u32 s45, s45, s40
  s_mul_i32 s40, s28, 10240
  s_add_u32 s45, s45, s40
  s_lshl_b32 s44, s28, 10
  s_add_u32 m0, s44, 87552
  s_nop 0
  buffer_load_dwordx4 v11, s[52:55], s45 offen lds
  s_add_u32 s45, s45, 40960
  s_add_u32 m0, s44, 91648
  s_nop 0
  buffer_load_dwordx4 v11, s[52:55], s45 offen lds
  s_add_u32 s45, s45, 40960
  s_add_u32 m0, s44, 95744
  s_nop 0
  buffer_load_dwordx4 v11, s[52:55], s45 offen lds
  s_add_u32 s45, s45, 40960
  s_add_u32 m0, s44, 99840
  s_nop 0
  buffer_load_dwordx4 v11, s[52:55], s45 offen lds
  s_add_u32 s45, s45, 40960
  s_add_u32 m0, s44, 103936
  s_nop 0
  buffer_load_dwordx4 v11, s[52:55], s45 offen lds
  s_add_u32 m0, s44, 103936
  s_nop 0
  buffer_load_dwordx4 v11, s[52:55], s45 offen lds
  s_branch PIj_6
PIx_7:
  s_load_dwordx2 s[52:53], s[0:1], 32
  s_mov_b32 s54, 0xc8000
  s_mov_b32 s55, 0x20000
  s_waitcnt lgkmcnt(0)
  s_and_b32 s53, s53, 0xffff
  v_mov_b32 v11, 0x40000000
  s_mov_b32 m0, 87552
  s_nop 0
  buffer_load_dwordx4 v11, s[52:55], 0 offen lds
  s_mov_b32 m0, 87552
  s_nop 0
  buffer_load_dwordx4 v11, s[52:55], 0 offen lds
  s_mov_b32 m0, 87552
  s_nop 0
  buffer_load_dwordx4 v11, s[52:55], 0 offen lds
  s_mov_b32 m0, 87552
  s_nop 0
  buffer_load_dwordx4 v11, s[52:55], 0 offen lds
  s_mov_b32 m0, 87552
  s_nop 0
  buffer_load_dwordx4 v11, s[52:55], 0 offen lds
  s_mov_b32 m0, 87552
  s_nop 0
  buffer_load_dwordx4 v11, s[52:55], 0 offen lds
PIj_6:
  s_cmp_eq_u32 s28, 0
  s_cbranch_scc0 S0_dbg_8
  s_waitcnt vmcnt(20)
  v_mov_b32 v11, s31
  v_mov_b32 v12, 1
  s_mov_b64 exec, 1
  buffer_store_byte v12, v11, s[20:23], 0 offen sc1
  s_mov_b64 exec, -1
S0_dbg_8:
  v_mov_b32 v7, 0x3f803f80
  v_lshrrev_b32 v11, 2, v1
  v_and_b32 v11, 3, v11
  v_lshrrev_b32 v12, 5, v1
  v_lshlrev_b32 v12, 3, v12
  v_add_u32 v11, v11, v12
  v_mul_u32_u24 v11, 160, v11
  v_and_b32 v12, 1, v4
  v_lshlrev_b32 v12, 5, v12
  v_add_u32 v11, v11, v12
  v_and_b32 v12, 3, v1
  v_lshlrev_b32 v12, 3, v12
  v_add_u32 v11, v11, v12
  s_mul_i32 s40, s28, 40
  s_add_u32 s40, s40, 82432
  v_add_u32 v11, s40, v11
  s_waitcnt vmcnt(18)
  s_barrier
  ds_read_b64_tr_b16 v[60:61], v11 offset:0
  ds_read_b64_tr_b16 v[62:63], v11 offset:640
  ds_read_b64_tr_b16 v[64:65], v11 offset:2560
  ds_read_b64_tr_b16 v[66:67], v11 offset:3200
  s_lshl_b32 s40, s87, 2
  s_add_u32 s40, s40, s28
  s_mul_i32 s40, s40, 40
  s_lshl_b32 s41, s86, 1
  s_add_u32 s40, s40, s41
  s_lshl_b32 s44, s40, 10
  s_add_u32 s44, s44, 4874240
  v_and_b32 v12, 31, v1
  v_cmp_gt_u32 vcc, 20, v12
  s_waitcnt lgkmcnt(0)
  s_nop 0
  v_cndmask_b32 v60, 0, v60, vcc
  v_cndmask_b32 v61, 0, v61, vcc
  v_cndmask_b32 v62, 0, v62, vcc
  v_cndmask_b32 v63, 0, v63, vcc
  v_cndmask_b32 v64, 0, v64, vcc
  v_cndmask_b32 v65, 0, v65, vcc
  v_cndmask_b32 v66, 0, v66, vcc
  v_cndmask_b32 v67, 0, v67, vcc
  buffer_store_dwordx4 v[60:63], v2, s[8:11], s44 offen sc1
  buffer_store_dwordx4 v[64:67], v2, s[8:11], s44 offen offset:1024 sc1
  v_and_b32 v54, 7, v3
  v_xor_b32 v53, v4, v54
  v_lshlrev_b32 v53, 4, v53
  v_lshlrev_b32 v54, 7, v54
  v_add_u32 v53, v53, v54
  v_lshrrev_b32 v54, 3, v3
  v_lshlrev_b32 v54, 10, v54
  v_add_u32 v53, v53, v54
  s_mul_i32 s41, s28, 5
  s_add_u32 s41, s41, 0
  s_and_b32 s42, s41, 1
  s_lshl_b32 s42, s42, 6
  s_lshr_b32 s41, s41, 1
  s_lshl_b32 s41, s41, 11
  v_xor_b32 v48, s42, v53
  v_add_u32 v48, s41, v48
  s_mul_i32 s41, s28, 5
  s_add_u32 s41, s41, 1
  s_and_b32 s42, s41, 1
  s_lshl_b32 s42, s42, 6
  s_lshr_b32 s41, s41, 1
  s_lshl_b32 s41, s41, 11
  v_xor_b32 v49, s42, v53
  v_add_u32 v49, s41, v49
  s_mul_i32 s41, s28, 5
  s_add_u32 s41, s41, 2
  s_and_b32 s42, s41, 1
  s_lshl_b32 s42, s42, 6
  s_lshr_b32 s41, s41, 1
  s_lshl_b32 s41, s41, 11
  v_xor_b32 v50, s42, v53
  v_add_u32 v50, s41, v50
  s_mul_i32 s41, s28, 5
  s_add_u32 s41, s41, 3
  s_and_b32 s42, s41, 1
  s_lshl_b32 s42, s42, 6
  s_lshr_b32 s41, s41, 1
  s_lshl_b32 s41, s41, 11
  v_xor_b32 v51, s42, v53
  v_add_u32 v51, s41, v51
  s_mul_i32 s41, s28, 5
  s_add_u32 s41, s41, 4
  s_and_b32 s42, s41, 1
  s_lshl_b32 s42, s42, 6
  s_lshr_b32 s41, s41, 1
  s_lshl_b32 s41, s41, 11
  v_xor_b32 v52, s42, v53
  v_add_u32 v52, s41, v52
  s_cmp_eq_u32 s32, 0
  s_mov_b32 s86, 34111488
  s_cselect_b32 s86, s86, 34308096
  s_lshl_b32 s40, s29, 1
  s_lshr_b32 s41, s50, 1
  s_add_u32 s40, s40, s41
  s_mul_i32 s40, s40, 3072
  s_add_u32 s86, s86, s40
  s_cmp_eq_u32 s49, 0
  s_cbranch_scc0 KA_V_9
  s_and_b32 s40, s50, 1
  s_lshl_b32 s40, s40, 4
  v_add_u32 v10, s40, v3
  v_and_b32 v11, 1, v4
  v_lshlrev_b32 v11, 5, v11
  v_add_u32 v11, v11, v10
  v_lshlrev_b32 v11, 4, v11
  v_lshrrev_b32 v12, 1, v4
  v_lshlrev_b32 v12, 3, v12
  v_add_u32 v58, v11, v12
  v_lshlrev_b32 v11, 5, v4
  v_add_u32 v11, v11, v10
  v_lshlrev_b32 v59, 3, v11
  s_cmp_eq_u32 s32, 0
  s_mov_b32 s87, 34504704
  s_cselect_b32 s87, s87, 34508800
  s_lshl_b32 s40, s29, 2
  s_add_u32 s40, s40, s50
  s_lshl_b32 s40, s40, 2
  s_add_u32 s87, s87, s40
  s_branch KA_e_10
KA_V_9:
  s_add_u32 s87, s86, 2880
  s_and_b32 s40, s50, 1
  s_mul_i32 s40, s40, 672
  s_add_u32 s40, s40, 1024
  s_add_u32 s86, s86, s40
  v_and_b32 v11, 1, v4
  v_mul_u32_u24 v11, 21, v11
  v_add_u32 v11, v11, v3
  v_lshlrev_b32 v11, 4, v11
  v_lshrrev_b32 v12, 1, v4
  v_lshlrev_b32 v12, 3, v12
  v_add_u32 v58, v11, v12
  v_mov_b32 v59, 0
  s_nop 1
KA_e_10:
  s_waitcnt vmcnt(8)
  s_barrier
  v_lshrrev_b32 v9, 2, v1
  v_and_b32 v9, 3, v9
  v_lshlrev_b32 v10, 3, v4
  v_add_u32 v9, v9, v10
  s_mul_i32 s40, s28, 160
  v_add_u32 v9, s40, v9
  v_mul_u32_u24 v9, 40, v9
  v_and_b32 v10, 3, v1
  v_lshlrev_b32 v10, 3, v10
  v_add_u32 v9, v9, v10
  v_add_u32 v9, 122880, v9
  ds_read_b64_tr_b16 v[128:129], v9 offset:0
  ds_read_b64_tr_b16 v[130:131], v9 offset:160
  ds_read_b64_tr_b16 v[132:133], v9 offset:32
  ds_read_b64_tr_b16 v[134:135], v9 offset:192
  ds_read_b64_tr_b16 v[136:137], v9 offset:1280
  ds_read_b64_tr_b16 v[138:139], v9 offset:1440
  ds_read_b64_tr_b16 v[140:141], v9 offset:1312
  ds_read_b64_tr_b16 v[142:143], v9 offset:1472
  ds_read_b64_tr_b16 v[144:145], v9 offset:2560
  ds_read_b64_tr_b16 v[146:147], v9 offset:2720
  ds_read_b64_tr_b16 v[148:149], v9 offset:2592
  ds_read_b64_tr_b16 v[150:151], v9 offset:2752
  ds_read_b64_tr_b16 v[152:153], v9 offset:3840
  ds_read_b64_tr_b16 v[154:155], v9 offset:4000
  ds_read_b64_tr_b16 v[156:157], v9 offset:3872
  ds_read_b64_tr_b16 v[158:159], v9 offset:4032
  ds_read_b64_tr_b16 v[160:161], v9 offset:5120
  ds_read_b64_tr_b16 v[162:163], v9 offset:5280
  ds_read_b64_tr_b16 v[164:165], v9 offset:5152
  ds_read_b64_tr_b16 v[166:167], v9 offset:5312
  s_waitcnt lgkmcnt(0)
  s_lshl_b32 s44, s28, 7
  s_add_u32 s44, s44, 159744
  v_mov_b32 v12, 0x3f803f80
  v_mov_b32 v13, 0x3f803f80
  v_mov_b32 v14, 0x3f803f80
  v_mov_b32 v15, 0x3f803f80
  s_cmp_eq_u32 s49, 0
  s_nop 0
  s_cbranch_scc0 S0_V_11
  v_mfma_f32_16x16x32_bf16 v[64:67], v[128:131], v[12:15], 0
  v_mfma_f32_16x16x32_bf16 v[68:71], v[132:135], v[12:15], 0
  v_mfma_f32_16x16x32_bf16 v[64:67], v[136:139], v[12:15], v[64:67]
  v_mfma_f32_16x16x32_bf16 v[68:71], v[140:143], v[12:15], v[68:71]
  v_mfma_f32_16x16x32_bf16 v[64:67], v[144:147], v[12:15], v[64:67]
  v_mfma_f32_16x16x32_bf16 v[68:71], v[148:151], v[12:15], v[68:71]
  v_mfma_f32_16x16x32_bf16 v[64:67], v[152:155], v[12:15], v[64:67]
  v_mfma_f32_16x16x32_bf16 v[68:71], v[156:159], v[12:15], v[68:71]
  v_mfma_f32_16x16x32_bf16 v[64:67], v[160:163], v[12:15], v[64:67]
  v_mfma_f32_16x16x32_bf16 v[68:71], v[164:167], v[12:15], v[68:71]
  v_lshlrev_b32 v10, 5, v4
  v_add_u32 v10, s44, v10
  s_mov_b32 exec_lo, 0x00010001
  s_mov_b32 exec_hi, 0x00010001
  s_nop 2
  ds_write_b128 v10, v[64:67]
  ds_write_b128 v10, v[68:71] offset:16
  s_mov_b64 exec, -1
  s_branch S0_j_12
S0_V_11:
  v_mfma_f32_16x16x32_bf16 v[64:67], v[12:15], v[128:131], 0
  v_mfma_f32_16x16x32_bf16 v[68:71], v[12:15], v[132:135], 0
  v_mfma_f32_16x16x32_bf16 v[64:67], v[12:15], v[136:139], v[64:67]
  v_mfma_f32_16x16x32_bf16 v[68:71], v[12:15], v[140:143], v[68:71]
  v_mfma_f32_16x16x32_bf16 v[64:67], v[12:15], v[144:147], v[64:67]
  v_mfma_f32_16x16x32_bf16 v[68:71], v[12:15], v[148:151], v[68:71]
  v_mfma_f32_16x16x32_bf16 v[64:67], v[12:15], v[152:155], v[64:67]
  v_mfma_f32_16x16x32_bf16 v[68:71], v[12:15], v[156:159], v[68:71]
  v_mfma_f32_16x16x32_bf16 v[64:67], v[12:15], v[160:163], v[64:67]
  v_mfma_f32_16x16x32_bf16 v[68:71], v[12:15], v[164:167], v[68:71]
  v_lshlrev_b32 v10, 3, v3
  v_add_u32 v10, s44, v10
  s_nop 5
  v_mov_b32 v65, v68
  s_mov_b64 exec, 0xffff
  ds_write_b64 v10, v[64:65]
  s_mov_b64 exec, -1
S0_j_12:
L_LAYER:
  s_cmp_eq_u32 s32, 0
  s_cbranch_scc1 QKV_kv_14
  s_cmp_eq_u32 s28, 0
  s_cbranch_scc0 WC_15
  s_mov_b32 s43, 4
  s_mov_b64 exec, 0xff
  v_lshlrev_b32 v254, 2, v1
  s_mov_b32 s42, 400000
  s_nop 0
WCP_16:
  buffer_load_dword v255, v254, s[8:11], s39 offen sc1
  s_waitcnt vmcnt(0)
  v_cmp_gt_u32 vcc, s43, v255
  s_cmp_eq_u64 vcc, 0
  s_nop 3
  s_cbranch_scc1 WCP_done_17
  s_sub_u32 s42, s42, 1
  s_cmp_lg_u32 s42, 0
  s_cbranch_scc1 WCP_16
WCP_done_17:
  s_mov_b64 exec, -1
WC_15:
  s_barrier
  s_mov_b32 s24, s8
  s_mov_b32 s25, s9
  s_mov_b32 s26, s10
  s_mov_b32 s27, s11
  v_mov_b32 v8, v2
  s_mov_b32 s46, 1024
  s_mov_b32 s47, 16809984
  s_lshl_b32 s40, s29, 2
  s_mul_i32 s40, s40, 20480
  s_add_u32 s47, s47, s40
  s_lshr_b32 s49, s30, 2
  s_and_b32 s50, s30, 3
  s_lshl_b32 s51, s30, 2
  s_add_u32 s51, s51, s28
  s_mul_i32 s41, s28, 5
  s_mul_i32 s44, s41, s46
  s_lshl_b32 s52, s41, 10
  s_mul_i32 s40, s50, 20480
  s_add_u32 s45, s47, s40
  s_add_u32 s45, s45, s44
  s_add_u32 m0, s52, 0
  s_nop 0
  buffer_load_dwordx4 v8, s[24:27], s45 offen sc1 lds
  s_add_u32 s45, s45, s46
  s_add_u32 m0, s52, 1024
  s_nop 0
  buffer_load_dwordx4 v8, s[24:27], s45 offen sc1 lds
  s_add_u32 s45, s45, s46
  s_add_u32 m0, s52, 2048
  s_nop 0
  buffer_load_dwordx4 v8, s[24:27], s45 offen sc1 lds
  s_add_u32 s45, s45, s46
  s_add_u32 m0, s52, 3072
  s_nop 0
  buffer_load_dwordx4 v8, s[24:27], s45 offen sc1 lds
  s_add_u32 s45, s45, s46
  s_add_u32 m0, s52, 4096
  s_nop 0
  buffer_load_dwordx4 v8, s[24:27], s45 offen sc1 lds
  s_mul_i32 s40, s28, 5120
  s_add_u32 s41, s40, 0
  v_add_u32 v48, s41, v2
  s_add_u32 s41, s40, 1024
  v_add_u32 v49, s41, v2
  s_add_u32 s41, s40, 2048
  v_add_u32 v50, s41, v2
  s_add_u32 s41, s40, 3072
  v_add_u32 v51, s41, v2
  s_add_u32 s41, s40, 4096
  v_add_u32 v52, s41, v2
  s_cmp_eq_u32 s32, 0
  s_mov_b32 s86, 34111488
  s_cselect_b32 s86, s86, 34308096
  s_lshl_b32 s40, s29, 1
  s_lshr_b32 s41, s50, 1
  s_add_u32 s40, s40, s41
  s_mul_i32 s40, s40, 3072
  s_add_u32 s86, s86, s40
  s_cmp_eq_u32 s49, 0
  s_cbranch_scc0 KA_V_18
  s_and_b32 s40, s50, 1
  s_lshl_b32 s40, s40, 4
  v_add_u32 v10, s40, v3
  v_and_b32 v11, 1, v4
  v_lshlrev_b32 v11, 5, v11
  v_add_u32 v11, v11, v10
  v_lshlrev_b32 v11, 4, v11
  v_lshrrev_b32 v12, 1, v4
  v_lshlrev_b32 v12, 3, v12
  v_add_u32 v58, v11, v12
  v_lshlrev_b32 v11, 5, v4
  v_add_u32 v11, v11, v10
  v_lshlrev_b32 v59, 3, v11
  s_cmp_eq_u32 s32, 0
  s_mov_b32 s87, 34504704
  s_cselect_b32 s87, s87, 34508800
  s_lshl_b32 s40, s29, 2
  s_add_u32 s40, s40, s50
  s_lshl_b32 s40, s40, 2
  s_add_u32 s87, s87, s40
  s_branch KA_e_19
KA_V_18:
  s_add_u32 s87, s86, 2880
  s_and_b32 s40, s50, 1
  s_mul_i32 s40, s40, 672
  s_add_u32 s40, s40, 1024
  s_add_u32 s86, s86, s40
  v_and_b32 v11, 1, v4
  v_mul_u32_u24 v11, 21, v11
  v_add_u32 v11, v11, v3
  v_lshlrev_b32 v11, 4, v11
  v_lshrrev_b32 v12, 1, v4
  v_lshlrev_b32 v12, 3, v12
  v_add_u32 v58, v11, v12
  v_mov_b32 v59, 0
  s_nop 1
KA_e_19:
  s_max_u32 s37, s28, 1
  s_cmp_eq_u32 s28, 1
  s_cbranch_scc1 QKV_w1_20
  s_add_u32 s40, s50, s37
  s_and_b32 s40, s40, 3
  s_mul_i32 s40, s40, 20480
  s_add_u32 s84, s47, s40
  s_mul_i32 s85, s37, 20480
  s_add_u32 m0, s85, 0
  s_nop 0
  buffer_load_dwordx4 v8, s[24:27], s84 offen sc1 lds
  s_add_u32 s84, s84, s46
  s_add_u32 m0, s85, 1024
  s_nop 0
  buffer_load_dwordx4 v8, s[24:27], s84 offen sc1 lds
  s_add_u32 s84, s84, s46
  s_add_u32 m0, s85, 2048
  s_nop 0
  buffer_load_dwordx4 v8, s[24:27], s84 offen sc1 lds
  s_add_u32 s84, s84, s46
  s_add_u32 m0, s85, 3072
  s_nop 0
  buffer_load_dwordx4 v8, s[24:27], s84 offen sc1 lds
  s_add_u32 s84, s84, s46
  s_add_u32 m0, s85, 4096
  s_nop 0
  buffer_load_dwordx4 v8, s[24:27], s84 offen sc1 lds
  s_add_u32 s84, s84, s46
  s_add_u32 m0, s85, 5120
  s_nop 0
  buffer_load_dwordx4 v8, s[24:27], s84 offen sc1 lds
  s_add_u32 s84, s84, s46
  s_add_u32 m0, s85, 6144
  s_nop 0
  buffer_load_dwordx4 v8, s[24:27], s84 offen sc1 lds
  s_add_u32 s84, s84, s46
  s_add_u32 m0, s85, 7168
  s_nop 0
  buffer_load_dwordx4 v8, s[24:27], s84 offen sc1 lds
  s_add_u32 s84, s84, s46
  s_waitcnt vmcnt(8)
  s_branch QKV_j_21
QKV_w1_20:
  s_waitcnt vmcnt(0)
QKV_j_21:
  s_barrier
QKV_kv_14:
  ds_read_b128 v[16:19], v48
  ds_read_b128 v[20:23], v49
  ds_read_b128 v[24:27], v50
  ds_read_b128 v[28:31], v51
  ds_read_b128 v[32:35], v52
  v_mov_b32 v44, 0
  v_mov_b32 v45, 0
  s_lshl_b32 s40, s28, 11
  s_add_u32 s40, s40, 149504
  v_add_u32 v10, s40, v2
  s_lshl_b32 s40, s28, 9
  s_add_u32 s40, s40, 157696
  v_lshlrev_b32 v11, 3, v1
  v_add_u32 v11, s40, v11
  s_waitcnt lgkmcnt(0)
  s_cmp_eq_u32 s49, 0
  s_cbranch_scc0 KV_isV_22
  v_mfma_f32_16x16x32_bf16 v[36:39], v[128:131], v[16:19], 0
  v_mfma_f32_16x16x32_bf16 v[40:43], v[132:135], v[16:19], 0
  v_mfma_f32_16x16x32_bf16 v[36:39], v[136:139], v[20:23], v[36:39]
  v_mfma_f32_16x16x32_bf16 v[40:43], v[140:143], v[20:23], v[40:43]
  v_mfma_f32_16x16x32_bf16 v[36:39], v[144:147], v[24:27], v[36:39]
  v_mfma_f32_16x16x32_bf16 v[40:43], v[148:151], v[24:27], v[40:43]
  v_mfma_f32_16x16x32_bf16 v[36:39], v[152:155], v[28:31], v[36:39]
  v_mfma_f32_16x16x32_bf16 v[40:43], v[156:159], v[28:31], v[40:43]
  v_mfma_f32_16x16x32_bf16 v[36:39], v[160:163], v[32:35], v[36:39]
  v_mfma_f32_16x16x32_bf16 v[40:43], v[164:167], v[32:35], v[40:43]
  s_nop 7
  s_branch KV_red_23
KV_isV_22:
  v_mfma_f32_16x16x32_bf16 v[36:39], v[16:19], v[128:131], 0
  v_mfma_f32_16x16x32_bf16 v[40:43], v[16:19], v[132:135], 0
  v_mfma_f32_16x16x32_bf16 v[36:39], v[20:23], v[136:139], v[36:39]
  v_mfma_f32_16x16x32_bf16 v[40:43], v[20:23], v[140:143], v[40:43]
  v_mfma_f32_16x16x32_bf16 v[36:39], v[24:27], v[144:147], v[36:39]
  v_mfma_f32_16x16x32_bf16 v[40:43], v[24:27], v[148:151], v[40:43]
  v_mfma_f32_16x16x32_bf16 v[36:39], v[28:31], v[152:155], v[36:39]
  v_mfma_f32_16x16x32_bf16 v[40:43], v[28:31], v[156:159], v[40:43]
  v_mfma_f32_16x16x32_bf16 v[36:39], v[32:35], v[160:163], v[36:39]
  v_mfma_f32_16x16x32_bf16 v[40:43], v[32:35], v[164:167], v[40:43]
  s_nop 7
KV_red_23:
  v_dot2_f32_bf16 v44, v16, v7, v44
  v_dot2_f32_bf16 v45, v16, v16, v45
  v_dot2_f32_bf16 v44, v17, v7, v44
  v_dot2_f32_bf16 v45, v17, v17, v45
  v_dot2_f32_bf16 v44, v18, v7, v44
  v_dot2_f32_bf16 v45, v18, v18, v45
  v_dot2_f32_bf16 v44, v19, v7, v44
  v_dot2_f32_bf16 v45, v19, v19, v45
  v_dot2_f32_bf16 v44, v20, v7, v44
  v_dot2_f32_bf16 v45, v20, v20, v45
  v_dot2_f32_bf16 v44, v21, v7, v44
  v_dot2_f32_bf16 v45, v21, v21, v45
  v_dot2_f32_bf16 v44, v22, v7, v44
  v_dot2_f32_bf16 v45, v22, v22, v45
  v_dot2_f32_bf16 v44, v23, v7, v44
  v_dot2_f32_bf16 v45, v23, v23, v45
  v_dot2_f32_bf16 v44, v24, v7, v44
  v_dot2_f32_bf16 v45, v24, v24, v45
  v_dot2_f32_bf16 v44, v25, v7, v44
  v_dot2_f32_bf16 v45, v25, v25, v45
  v_dot2_f32_bf16 v44, v26, v7, v44
  v_dot2_f32_bf16 v45, v26, v26, v45
  v_dot2_f32_bf16 v44, v27, v7, v44
  v_dot2_f32_bf16 v45, v27, v27, v45
  v_dot2_f32_bf16 v44, v28, v7, v44
  v_dot2_f32_bf16 v45, v28, v28, v45
  v_dot2_f32_bf16 v44, v29, v7, v44
  v_dot2_f32_bf16 v45, v29, v29, v45
  v_dot2_f32_bf16 v44, v30, v7, v44
  v_dot2_f32_bf16 v45, v30, v30, v45
  v_dot2_f32_bf16 v44, v31, v7, v44
  v_dot2_f32_bf16 v45, v31, v31, v45
  v_dot2_f32_bf16 v44, v32, v7, v44
  v_dot2_f32_bf16 v45, v32, v32, v45
  v_dot2_f32_bf16 v44, v33, v7, v44
  v_dot2_f32_bf16 v45, v33, v33, v45
  v_dot2_f32_bf16 v44, v34, v7, v44
  v_dot2_f32_bf16 v45, v34, v34, v45
  v_dot2_f32_bf16 v44, v35, v7, v44
  v_dot2_f32_bf16 v45, v35, v35, v45
  s_nop 2
  ds_write_b64 v11, v[44:45]
  ds_write_b128 v10, v[36:39]
  ds_write_b128 v10, v[40:43] offset:1024
  s_cmp_eq_u32 s32, 0
  s_cbranch_scc0 KV_q0_24
  s_waitcnt vmcnt(0)
KV_q0_24:
  s_waitcnt lgkmcnt(0)
  s_barrier
  s_cmp_eq_u32 s32, 0
  s_cbranch_scc0 QKV_bulk0_27
  s_cmp_eq_u32 s28, 0
  s_cbranch_scc0 QKV_wqf_28
  s_and_b32 s40, s2, 7
  s_lshl_b32 s40, s40, 7
  s_lshr_b32 s42, s2, 3
  s_lshl_b32 s42, s42, 2
  s_add_u32 s40, s40, s42
  s_add_u32 s40, s40, 16384
  v_mov_b32 v11, 0
  v_mov_b32 v12, 1
  s_mov_b64 exec, 1
  buffer_store_dword v12, v11, s[8:11], s40 offen sc1
  s_mov_b64 exec, -1
QKV_wqf_28:
  s_lshl_b32 s40, s29, 6
  s_lshl_b32 s41, s28, 4
  s_add_u32 s40, s40, s41
  v_add_u32 v10, s40, v3
  v_mul_u32_u24 v10, 1280, v10
  v_lshlrev_b32 v11, 4, v4
  v_add_u32 v10, v10, v11
  s_lshl_b32 s44, s30, 7
  buffer_load_dwordx4 v[48:51], v10, s[12:15], s44 offen
  buffer_load_dwordx4 v[52:55], v10, s[12:15], s44 offen offset:64
  s_lshr_b32 s44, s30, 1
  s_add_u32 s44, s44, 16
  s_mul_i32 s44, s44, 64
  s_and_b32 s41, s30, 1
  s_lshl_b32 s41, s41, 3
  s_add_u32 s44, s44, s41
  buffer_load_dwordx2 v[56:57], v10, s[12:15], s44 offen
  s_cmp_eq_u32 s28, 1
  s_cbranch_scc1 QKV_xr0_29
  s_max_u32 s37, s28, 1
  s_add_u32 s40, s50, s37
  s_and_b32 s40, s40, 3
  s_mul_i32 s40, s40, 20480
  s_add_u32 s84, s47, s40
  s_mul_i32 s85, s37, 20608
  s_add_u32 m0, s85, 0
  s_add_u32 s45, s84, 0
  buffer_load_dwordx4 v8, s[24:27], s45 offen lds
  s_add_u32 m0, s85, 1024
  s_add_u32 s45, s84, 10240
  buffer_load_dwordx4 v8, s[24:27], s45 offen lds
  s_add_u32 m0, s85, 2048
  s_add_u32 s45, s84, 128
  buffer_load_dwordx4 v8, s[24:27], s45 offen lds
  s_add_u32 m0, s85, 3072
  s_add_u32 s45, s84, 10368
  buffer_load_dwordx4 v8, s[24:27], s45 offen lds
  s_add_u32 m0, s85, 4096
  s_add_u32 s45, s84, 256
  buffer_load_dwordx4 v8, s[24:27], s45 offen lds
  s_add_u32 m0, s85, 5120
  s_add_u32 s45, s84, 10496
  buffer_load_dwordx4 v8, s[24:27], s45 offen lds
  s_add_u32 m0, s85, 6144
  s_add_u32 s45, s84, 384
  buffer_load_dwordx4 v8, s[24:27], s45 offen lds
  s_add_u32 m0, s85, 7168
  s_add_u32 s45, s84, 10624
  buffer_load_dwordx4 v8, s[24:27], s45 offen lds
  s_add_u32 m0, s85, 8192
  s_add_u32 s45, s84, 512
  buffer_load_dwordx4 v8, s[24:27], s45 offen lds
  s_add_u32 m0, s85, 9216
  s_add_u32 s45, s84, 10752
  buffer_load_dwordx4 v8, s[24:27], s45 offen lds
  s_add_u32 m0, s85, 10240
  s_add_u32 s45, s84, 640
  buffer_load_dwordx4 v8, s[24:27], s45 offen lds
  s_add_u32 m0, s85, 11264
  s_add_u32 s45, s84, 10880
  buffer_load_dwordx4 v8, s[24:27], s45 offen lds
  s_add_u32 m0, s85, 12288
  s_add_u32 s45, s84, 768
  buffer_load_dwordx4 v8, s[24:27], s45 offen lds
  s_add_u32 m0, s85, 13312
  s_add_u32 s45, s84, 11008
  buffer_load_dwordx4 v8, s[24:27], s45 offen lds
  s_add_u32 m0, s85, 14336
  s_add_u32 s45, s84, 896
  buffer_load_dwordx4 v8, s[24:27], s45 offen lds
  s_add_u32 m0, s85, 15360
  s_add_u32 s45, s84, 11136
  buffer_load_dwordx4 v8, s[24:27], s45 offen lds
  s_add_u32 m0, s85, 16384
  s_add_u32 s45, s84, 1024
  buffer_load_dwordx4 v8, s[24:27], s45 offen lds
  s_add_u32 m0, s85, 17408
  s_add_u32 s45, s84, 11264
  buffer_load_dwordx4 v8, s[24:27], s45 offen lds
  s_add_u32 m0, s85, 18432
  s_add_u32 s45, s84, 1152
  buffer_load_dwordx4 v8, s[24:27], s45 offen lds
  s_add_u32 m0, s85, 19456
  s_add_u32 s45, s84, 11392
  buffer_load_dwordx4 v8, s[24:27], s45 offen lds
  v_lshrrev_b32 v9, 2, v1
  v_and_b32 v9, 3, v9
  v_lshlrev_b32 v10, 3, v4
  v_add_u32 v9, v9, v10
  v_lshlrev_b32 v9, 7, v9
  v_and_b32 v10, 3, v1
  v_lshlrev_b32 v10, 4, v10
  v_add_u32 v9, v9, v10
  s_lshr_b32 s40, s28, 1
  s_lshl_b32 s40, s40, 6
  s_and_b32 s41, s28, 1
  s_lshl_b32 s41, s41, 3
  s_add_u32 s40, s40, s41
  s_add_u32 s40, s40, 87552
  v_add_u32 v9, s40, v9
  s_cmp_lt_u32 s31, 96
  s_nop 0
  s_cbranch_scc0 PP2_30
  ds_read_b64_tr_b16 v[16:17], v9 offset:0
  ds_read_b64_tr_b16 v[18:19], v9 offset:512
  ds_read_b64_tr_b16 v[20:21], v9 offset:4096
  ds_read_b64_tr_b16 v[22:23], v9 offset:4608
  ds_read_b64_tr_b16 v[24:25], v9 offset:8192
  ds_read_b64_tr_b16 v[26:27], v9 offset:8704
  ds_read_b64_tr_b16 v[28:29], v9 offset:12288
  ds_read_b64_tr_b16 v[30:31], v9 offset:12800
  ds_read_b64_tr_b16 v[32:33], v9 offset:16384
  ds_read_b64_tr_b16 v[34:35], v9 offset:16896
  s_lshl_b32 s43, s65, 2
  s_add_u32 s43, s43, s28
  s_mov_b32 s44, s66
  s_mul_i32 s45, s43, 43
  s_lshr_b32 s45, s45, 9
  s_mul_i32 s48, s45, 12
  s_sub_u32 s48, s43, s48
  s_lshr_b32 s40, s48, 1
  s_and_b32 s41, s48, 1
  s_sub_u32 s42, s48, 8
  s_cmp_lt_u32 s48, 8
  s_cselect_b32 s40, s40, s42
  s_cselect_b32 s41, s41, 2
  s_lshl_b32 s45, s45, 2
  s_add_u32 s45, s45, s40
  s_mul_i32 s45, s45, 20
  s_add_u32 s45, s45, s44
  s_mul_i32 s45, s45, 3
  s_add_u32 s45, s45, s41
  s_lshl_b32 s45, s45, 10
  s_add_u32 s45, s45, 2908160
  s_waitcnt lgkmcnt(0)
  buffer_store_dwordx4 v[16:19], v2, s[8:11], s45 offen sc1
  s_add_u32 s45, s45, 3072
  buffer_store_dwordx4 v[20:23], v2, s[8:11], s45 offen sc1
  s_add_u32 s45, s45, 3072
  buffer_store_dwordx4 v[24:27], v2, s[8:11], s45 offen sc1
  s_add_u32 s45, s45, 3072
  buffer_store_dwordx4 v[28:31], v2, s[8:11], s45 offen sc1
  s_add_u32 s45, s45, 3072
  buffer_store_dwordx4 v[32:35], v2, s[8:11], s45 offen sc1
  buffer_store_dword v5, v5, s[8:11], 0 offen
  s_nop 0
  s_branch PPj_34
PP2_30:
  s_cmp_lt_u32 s31, 176
  s_cbranch_scc0 PPo_31
  ds_read_b64_tr_b16 v[16:17], v9 offset:0
  ds_read_b64_tr_b16 v[18:19], v9 offset:512
  ds_read_b64_tr_b16 v[20:21], v9 offset:4096
  ds_read_b64_tr_b16 v[22:23], v9 offset:4608
  ds_read_b64_tr_b16 v[24:25], v9 offset:8192
  ds_read_b64_tr_b16 v[26:27], v9 offset:8704
  ds_read_b64_tr_b16 v[28:29], v9 offset:12288
  ds_read_b64_tr_b16 v[30:31], v9 offset:12800
  ds_read_b64_tr_b16 v[32:33], v9 offset:16384
  ds_read_b64_tr_b16 v[34:35], v9 offset:16896
  ds_read_b64_tr_b16 v[36:37], v9 offset:20480
  ds_read_b64_tr_b16 v[38:39], v9 offset:20992
  s_lshl_b32 s43, s65, 2
  s_add_u32 s43, s43, s28
  s_mov_b32 s44, s66
  s_lshr_b32 s45, s43, 2
  s_and_b32 s48, s43, 3
  s_sub_u32 s41, s43, 32
  s_cmp_lt_u32 s43, 32
  s_cselect_b32 s45, s45, s41
  s_cselect_b32 s48, s48, 4
  s_mul_i32 s45, s45, 48
  s_add_u32 s45, s45, s44
  s_mul_i32 s45, s45, 5
  s_add_u32 s45, s45, s48
  s_lshl_b32 s45, s45, 10
  s_add_u32 s45, s45, 942080
  s_waitcnt lgkmcnt(0)
  buffer_store_dwordx4 v[16:19], v2, s[8:11], s45 offen sc1
  s_add_u32 s45, s45, 5120
  buffer_store_dwordx4 v[20:23], v2, s[8:11], s45 offen sc1
  s_add_u32 s45, s45, 5120
  buffer_store_dwordx4 v[24:27], v2, s[8:11], s45 offen sc1
  s_add_u32 s45, s45, 5120
  buffer_store_dwordx4 v[28:31], v2, s[8:11], s45 offen sc1
  s_add_u32 s45, s45, 5120
  buffer_store_dwordx4 v[32:35], v2, s[8:11], s45 offen sc1
  s_add_u32 s45, s45, 5120
  buffer_store_dwordx4 v[36:39], v2, s[8:11], s45 offen sc1
  s_nop 1
  s_branch PPj_34
PPo_31:
  s_cmp_lt_u32 s31, 216
  s_cbranch_scc0 PPb_32
  ds_read_b64_tr_b16 v[16:17], v9 offset:0
  ds_read_b64_tr_b16 v[18:19], v9 offset:512
  ds_read_b64_tr_b16 v[20:21], v9 offset:4096
  ds_read_b64_tr_b16 v[22:23], v9 offset:4608
  ds_read_b64_tr_b16 v[24:25], v9 offset:8192
  ds_read_b64_tr_b16 v[26:27], v9 offset:8704
  ds_read_b64_tr_b16 v[28:29], v9 offset:12288
  ds_read_b64_tr_b16 v[30:31], v9 offset:12800
  ds_read_b64_tr_b16 v[32:33], v9 offset:16384
  ds_read_b64_tr_b16 v[34:35], v9 offset:16896
  s_lshl_b32 s43, s65, 2
  s_add_u32 s43, s43, s28
  s_mov_b32 s44, s66
  s_lshr_b32 s45, s43, 2
  s_and_b32 s48, s43, 3
  s_sub_u32 s41, s43, 32
  s_cmp_lt_u32 s43, 32
  s_cselect_b32 s45, s45, s41
  s_cselect_b32 s48, s48, 4
  s_mul_i32 s45, s45, 20
  s_add_u32 s45, s45, s44
  s_mul_i32 s45, s45, 5
  s_add_u32 s45, s45, s48
  s_lshl_b32 s45, s45, 10
  s_add_u32 s45, s45, 122880
  s_waitcnt lgkmcnt(0)
  buffer_store_dwordx4 v[16:19], v2, s[8:11], s45 offen sc1
  s_add_u32 s45, s45, 5120
  buffer_store_dwordx4 v[20:23], v2, s[8:11], s45 offen sc1
  s_add_u32 s45, s45, 5120
  buffer_store_dwordx4 v[24:27], v2, s[8:11], s45 offen sc1
  s_add_u32 s45, s45, 5120
  buffer_store_dwordx4 v[28:31], v2, s[8:11], s45 offen sc1
  s_add_u32 s45, s45, 5120
  buffer_store_dwordx4 v[32:35], v2, s[8:11], s45 offen sc1
  buffer_store_dword v5, v5, s[8:11], 0 offen
  s_nop 0
  s_branch PPj_34
PPb_32:
  s_cmp_lt_u32 s31, 224
  s_cbranch_scc0 PPb2_33
  s_load_dwordx2 s[52:53], s[0:1], 56
  s_mov_b32 s54, 0xc00
  s_mov_b32 s55, 0x20000
  s_waitcnt lgkmcnt(0)
  s_and_b32 s53, s53, 0xffff
  s_sub_u32 s40, s31, 216
  s_lshl_b32 s40, s40, 2
  s_add_u32 s40, s40, s28
  s_lshl_b32 s41, s40, 6
  v_add_u32 v16, s41, v1
  v_lshrrev_b32 v17, 5, v16
  v_lshlrev_b32 v17, 5, v17
  v_lshrrev_b32 v18, 4, v16
  v_and_b32 v18, 1, v18
  v_lshlrev_b32 v18, 2, v18
  v_add_u32 v17, v17, v18
  v_lshrrev_b32 v18, 2, v3
  v_lshlrev_b32 v18, 3, v18
  v_add_u32 v17, v17, v18
  v_and_b32 v18, 3, v3
  v_add_u32 v17, v17, v18
  v_lshlrev_b32 v17, 1, v17
  buffer_load_ushort v19, v17, s[52:55], 0 offen
  v_lshlrev_b32 v16, 2, v16
  v_cmp_gt_u32 vcc, 6144, v16
  s_waitcnt vmcnt(0)
  v_lshlrev_b32 v19, 16, v19
  v_cndmask_b32 v16, v5, v16, vcc
  s_mov_b32 s45, 6291456
  buffer_store_dword v19, v16, s[8:11], s45 offen sc1
  buffer_store_dword v5, v5, s[8:11], 0 offen
  buffer_store_dword v5, v5, s[8:11], 0 offen
  buffer_store_dword v5, v5, s[8:11], 0 offen
  buffer_store_dword v5, v5, s[8:11], 0 offen
  buffer_store_dword v5, v5, s[8:11], 0 offen
  s_branch PPj_34
PPb2_33:
  s_cmp_lt_u32 s31, 232
  s_cbranch_scc0 PPn_35
  s_load_dwordx2 s[52:53], s[0:1], 72
  s_mov_b32 s54, 0x500
  s_mov_b32 s55, 0x20000
  s_waitcnt lgkmcnt(0)
  s_and_b32 s53, s53, 0xffff
  s_sub_u32 s40, s31, 224
  s_lshl_b32 s40, s40, 2
  s_add_u32 s40, s40, s28
  s_lshl_b32 s41, s40, 6
  v_add_u32 v16, s41, v1
  v_lshrrev_b32 v17, 5, v16
  v_lshlrev_b32 v17, 5, v17
  v_lshrrev_b32 v18, 4, v16
  v_and_b32 v18, 1, v18
  v_lshlrev_b32 v18, 2, v18
  v_add_u32 v17, v17, v18
  v_lshrrev_b32 v18, 2, v3
  v_lshlrev_b32 v18, 3, v18
  v_add_u32 v17, v17, v18
  v_and_b32 v18, 3, v3
  v_add_u32 v17, v17, v18
  v_lshlrev_b32 v17, 1, v17
  buffer_load_ushort v19, v17, s[52:55], 0 offen
  v_lshlrev_b32 v16, 2, v16
  v_cmp_gt_u32 vcc, 2560, v16
  s_waitcnt vmcnt(0)
  v_lshlrev_b32 v19, 16, v19
  v_cndmask_b32 v16, v5, v16, vcc
  s_mov_b32 s45, 6299648
  buffer_store_dword v19, v16, s[8:11], s45 offen sc1
  buffer_store_dword v5, v5, s[8:11], 0 offen
  buffer_store_dword v5, v5, s[8:11], 0 offen
  buffer_store_dword v5, v5, s[8:11], 0 offen
  buffer_store_dword v5, v5, s[8:11], 0 offen
  buffer_store_dword v5, v5, s[8:11], 0 offen
  s_branch PPj_34
PPn_35:
  buffer_store_dword v5, v5, s[8:11], 0 offen
  buffer_store_dword v5, v5, s[8:11], 0 offen
  buffer_store_dword v5, v5, s[8:11], 0 offen
  buffer_store_dword v5, v5, s[8:11], 0 offen
  buffer_store_dword v5, v5, s[8:11], 0 offen
  buffer_store_dword v5, v5, s[8:11], 0 offen
PPj_34:
QKV_xr0_29:
  s_branch QKV_bulk_25
QKV_bulk0_27:
  s_cmp_eq_u32 s28, 1
  s_cbranch_scc1 QKV_bulk2_26
  s_add_u32 m0, s85, 8192
  s_nop 0
  buffer_load_dwordx4 v8, s[24:27], s84 offen sc1 lds
  s_add_u32 s84, s84, s46
  s_add_u32 m0, s85, 9216
  s_nop 0
  buffer_load_dwordx4 v8, s[24:27], s84 offen sc1 lds
  s_add_u32 s84, s84, s46
  s_add_u32 m0, s85, 10240
  s_nop 0
  buffer_load_dwordx4 v8, s[24:27], s84 offen sc1 lds
  s_add_u32 s84, s84, s46
  s_add_u32 m0, s85, 11264
  s_nop 0
  buffer_load_dwordx4 v8, s[24:27], s84 offen sc1 lds
  s_add_u32 s84, s84, s46
  s_add_u32 m0, s85, 12288
  s_nop 0
  buffer_load_dwordx4 v8, s[24:27], s84 offen sc1 lds
  s_add_u32 s84, s84, s46
  s_add_u32 m0, s85, 13312
  s_nop 0
  buffer_load_dwordx4 v8, s[24:27], s84 offen sc1 lds
  s_add_u32 s84, s84, s46
  s_add_u32 m0, s85, 14336
  s_nop 0
  buffer_load_dwordx4 v8, s[24:27], s84 offen sc1 lds
  s_add_u32 s84, s84, s46
  s_add_u32 m0, s85, 15360
  s_nop 0
  buffer_load_dwordx4 v8, s[24:27], s84 offen sc1 lds
  s_add_u32 s84, s84, s46
  s_add_u32 m0, s85, 16384
  s_nop 0
  buffer_load_dwordx4 v8, s[24:27], s84 offen sc1 lds
  s_add_u32 s84, s84, s46
  s_add_u32 m0, s85, 17408
  s_nop 0
  buffer_load_dwordx4 v8, s[24:27], s84 offen sc1 lds
  s_add_u32 s84, s84, s46
  s_add_u32 m0, s85, 18432
  s_nop 0
  buffer_load_dwordx4 v8, s[24:27], s84 offen sc1 lds
  s_add_u32 s84, s84, s46
  s_add_u32 m0, s85, 19456
  s_nop 0
  buffer_load_dwordx4 v8, s[24:27], s84 offen sc1 lds
  s_add_u32 s84, s84, s46
QKV_bulk2_26:
  s_lshl_b32 s40, s30, 2
  s_add_u32 s40, s40, s28
  s_mul_i32 s58, s40, 40960
  s_add_u32 s58, s58, 4874240
  v_and_b32 v119, 31, v1
  v_cmp_gt_u32 vcc, 20, v119
  v_mov_b32 v119, 0x40000000
  s_nop 0
  v_cndmask_b32 v119, v119, v2, vcc
  buffer_load_dwordx4 a[0:3], v119, s[8:11], s58 offen offset:0 sc1
  buffer_load_dwordx4 a[4:7], v119, s[8:11], s58 offen offset:1024 sc1
  buffer_load_dwordx4 a[8:11], v119, s[8:11], s58 offen offset:2048 sc1
  buffer_load_dwordx4 a[12:15], v119, s[8:11], s58 offen offset:3072 sc1
  s_add_u32 s58, s58, 4096
  buffer_load_dwordx4 a[16:19], v119, s[8:11], s58 offen offset:0 sc1
  buffer_load_dwordx4 a[20:23], v119, s[8:11], s58 offen offset:1024 sc1
  buffer_load_dwordx4 a[24:27], v119, s[8:11], s58 offen offset:2048 sc1
  buffer_load_dwordx4 a[28:31], v119, s[8:11], s58 offen offset:3072 sc1
  s_add_u32 s58, s58, 4096
  buffer_load_dwordx4 a[32:35], v119, s[8:11], s58 offen offset:0 sc1
  buffer_load_dwordx4 a[36:39], v119, s[8:11], s58 offen offset:1024 sc1
  buffer_load_dwordx4 a[40:43], v119, s[8:11], s58 offen offset:2048 sc1
  buffer_load_dwordx4 a[44:47], v119, s[8:11], s58 offen offset:3072 sc1
QKV_bulk_25:
  s_cmp_eq_u32 s28, 1
  s_cbranch_scc0 KV_skip_36
  s_cmp_eq_u32 s32, 0
  s_cbranch_scc0 KV_cs_37
  s_cmp_eq_u32 s49, 0
  s_cbranch_scc0 CK_V_38
  v_lshlrev_b32 v10, 5, v4
  v_add_u32 v10, 159744, v10
  ds_read_b128 v[176:179], v10 offset:0
  ds_read_b128 v[180:183], v10 offset:16
  ds_read_b128 v[184:187], v10 offset:128
  ds_read_b128 v[188:191], v10 offset:144
  ds_read_b128 v[192:195], v10 offset:256
  ds_read_b128 v[196:199], v10 offset:272
  ds_read_b128 v[200:203], v10 offset:384
  ds_read_b128 v[204:207], v10 offset:400
  s_waitcnt lgkmcnt(0)
  v_add_f32 v176, v176, v184
  v_add_f32 v192, v192, v200
  v_add_f32 v168, v176, v192
  v_add_f32 v177, v177, v185
  v_add_f32 v193, v193, v201
  v_add_f32 v169, v177, v193
  v_add_f32 v178, v178, v186
  v_add_f32 v194, v194, v202
  v_add_f32 v170, v178, v194
  v_add_f32 v179, v179, v187
  v_add_f32 v195, v195, v203
  v_add_f32 v171, v179, v195
  v_add_f32 v180, v180, v188
  v_add_f32 v196, v196, v204
  v_add_f32 v172, v180, v196
  v_add_f32 v181, v181, v189
  v_add_f32 v197, v197, v205
  v_add_f32 v173, v181, v197
  v_add_f32 v182, v182, v190
  v_add_f32 v198, v198, v206
  v_add_f32 v174, v182, v198
  v_add_f32 v183, v183, v191
  v_add_f32 v199, v199, v207
  v_add_f32 v175, v183, v199
  s_nop 1
  s_branch CK_j_39
CK_V_38:
  v_lshlrev_b32 v10, 3, v3
  v_add_u32 v10, 159744, v10
  ds_read_b64 v[176:177], v10 offset:0
  ds_read_b64 v[178:179], v10 offset:128
  ds_read_b64 v[180:181], v10 offset:256
  ds_read_b64 v[182:183], v10 offset:384
  s_waitcnt lgkmcnt(0)
  v_add_f32 v176, v176, v178
  v_add_f32 v180, v180, v182
  v_add_f32 v168, v176, v180
  v_add_f32 v177, v177, v179
  v_add_f32 v181, v181, v183
  v_add_f32 v172, v177, v181
  s_nop 1
CK_j_39:
KV_cs_37:
  v_add_u32 v9, 149504, v2
  ds_read_b128 v[64:67], v9 offset:0
  ds_read_b128 v[68:71], v9 offset:1024
  ds_read_b128 v[72:75], v9 offset:2048
  ds_read_b128 v[76:79], v9 offset:3072
  ds_read_b128 v[80:83], v9 offset:4096
  ds_read_b128 v[84:87], v9 offset:5120
  ds_read_b128 v[88:91], v9 offset:6144
  ds_read_b128 v[92:95], v9 offset:7168
  v_lshlrev_b32 v10, 3, v1
  v_add_u32 v10, 157696, v10
  ds_read_b64 v[96:97], v10 offset:0
  ds_read_b64 v[98:99], v10 offset:512
  ds_read_b64 v[100:101], v10 offset:1024
  ds_read_b64 v[102:103], v10 offset:1536
  s_waitcnt lgkmcnt(0)
  v_add_f32 v96, v96, v98
  v_add_f32 v100, v100, v102
  v_add_f32 v96, v96, v100
  v_add_f32 v97, v97, v99
  v_add_f32 v101, v101, v103
  v_add_f32 v97, v97, v101
  v_add_f32 v64, v64, v72
  v_add_f32 v80, v80, v88
  v_add_f32 v64, v64, v80
  v_add_f32 v65, v65, v73
  v_add_f32 v81, v81, v89
  v_add_f32 v65, v65, v81
  v_add_f32 v66, v66, v74
  v_add_f32 v82, v82, v90
  v_add_f32 v66, v66, v82
  v_add_f32 v67, v67, v75
  v_add_f32 v83, v83, v91
  v_add_f32 v67, v67, v83
  v_add_f32 v68, v68, v76
  v_add_f32 v84, v84, v92
  v_add_f32 v68, v68, v84
  v_add_f32 v69, v69, v77
  v_add_f32 v85, v85, v93
  v_add_f32 v69, v69, v85
  v_add_f32 v70, v70, v78
  v_add_f32 v86, v86, v94
  v_add_f32 v70, v70, v86
  v_add_f32 v71, v71, v79
  v_add_f32 v87, v87, v95
  v_add_f32 v71, v71, v87
  v_mov_b32 v98, v96
  s_nop 1
  v_permlane16_swap_b32 v96, v98
  v_add_f32 v96, v96, v98
  v_mov_b32 v98, v96
  s_nop 1
  v_permlane32_swap_b32 v96, v98
  v_add_f32 v96, v96, v98
  v_mov_b32 v99, v97
  s_nop 1
  v_permlane16_swap_b32 v97, v99
  v_add_f32 v97, v97, v99
  v_mov_b32 v99, v97
  s_nop 1
  v_permlane32_swap_b32 v97, v99
  v_add_f32 v97, v97, v99
  v_mul_f32 v96, 0x3acccccd, v96
  v_mul_f32 v97, 0x3acccccd, v97
  v_fma_f32 v97, -v96, v96, v97
  v_max_f32 v97, 0, v97
  v_add_f32 v97, 0x3727c5ac, v97
  v_rsq_f32 v98, v97
  s_nop 0
  v_mul_f32 v99, v96, v98
  v_sub_f32 v99, 0, v99
  s_add_u32 s40, s50, 0
  s_and_b32 s40, s40, 3
  s_lshl_b32 s40, s40, 7
  s_add_u32 s40, s40, 160384
  v_lshlrev_b32 v10, 3, v3
  v_add_u32 v10, s40, v10
  s_mov_b64 exec, 0xffff
  ds_write_b64 v10, v[98:99]
  s_mov_b64 exec, -1
  s_cmp_eq_u32 s49, 0
  s_cbranch_scc0 KVE_V_40
  v_mul_f32 v72, v99, v168
  v_fma_f32 v64, v64, v98, v72
  v_mul_f32 v73, v99, v169
  v_fma_f32 v65, v65, v98, v73
  v_mul_f32 v74, v99, v170
  v_fma_f32 v66, v66, v98, v74
  v_mul_f32 v75, v99, v171
  v_fma_f32 v67, v67, v98, v75
  v_mul_f32 v76, v99, v172
  v_fma_f32 v68, v68, v98, v76
  v_mul_f32 v77, v99, v173
  v_fma_f32 v69, v69, v98, v77
  v_mul_f32 v78, v99, v174
  v_fma_f32 v70, v70, v98, v78
  v_mul_f32 v79, v99, v175
  v_fma_f32 v71, v71, v98, v79
  v_cvt_pk_bf16_f32 v80, v64, v65
  v_cvt_pk_bf16_f32 v81, v66, v67
  v_cvt_pk_bf16_f32 v82, v68, v69
  v_cvt_pk_bf16_f32 v83, v70, v71
  buffer_store_dwordx2 v[80:81], v58, s[8:11], s86 offen sc1
  v_cmp_eq_u32 vcc, 0, v4
  v_mov_b32 v12, 0x3f803f80
  v_mov_b32 v13, 0x00003f80
  v_cndmask_b32 v82, v12, v82, vcc
  v_cndmask_b32 v83, v13, v83, vcc
  s_mov_b32 exec_hi, 0
  buffer_store_dwordx2 v[82:83], v59, s[8:11], s86 offen offset:2368 sc1
  s_mov_b64 exec, -1
  v_mul_f32 v72, v68, v68
  v_fma_f32 v72, v69, v69, v72
  v_fma_f32 v72, v70, v70, v72
  v_fma_f32 v72, v71, v71, v72
  v_cndmask_b32 v72, 0, v72, vcc
  v_fma_f32 v72, v64, v64, v72
  v_fma_f32 v72, v65, v65, v72
  v_fma_f32 v72, v66, v66, v72
  v_fma_f32 v72, v67, v67, v72
  v_mov_b32 v73, v72
  s_nop 1
  v_permlane16_swap_b32 v72, v73
  v_add_f32 v72, v72, v73
  v_mov_b32 v73, v72
  s_nop 1
  v_permlane32_swap_b32 v72, v73
  v_add_f32 v72, v72, v73
  s_nop 1
  v_max_f32_dpp v72, v72, v72 row_ror:8 row_mask:0xf bank_mask:0xf
  s_nop 1
  v_max_f32_dpp v72, v72, v72 row_ror:4 row_mask:0xf bank_mask:0xf
  s_nop 1
  v_max_f32_dpp v72, v72, v72 row_ror:2 row_mask:0xf bank_mask:0xf
  s_nop 1
  v_max_f32_dpp v72, v72, v72 row_ror:1 row_mask:0xf bank_mask:0xf
  s_mov_b64 exec, 1
  buffer_store_dword v72, off, s[8:11], s87 sc1
  s_mov_b64 exec, -1
  s_branch KVE_end_41
KVE_V_40:
  v_lshlrev_b32 v10, 3, v3
  v_add_u32 v10, 160256, v10
  s_mov_b64 exec, 0xffff
  ds_write_b64 v10, v[98:99]
  s_mov_b64 exec, -1
  v_lshlrev_b32 v10, 5, v4
  v_add_u32 v10, 160256, v10
  s_waitcnt lgkmcnt(0)
  ds_read_b128 v[88:91], v10
  ds_read_b128 v[92:95], v10 offset:16
  s_waitcnt lgkmcnt(0)
  v_mul_f32 v72, v89, v168
  v_fma_f32 v64, v64, v88, v72
  v_mul_f32 v73, v91, v168
  v_fma_f32 v65, v65, v90, v73
  v_mul_f32 v72, v93, v168
  v_fma_f32 v66, v66, v92, v72
  v_mul_f32 v73, v95, v168
  v_fma_f32 v67, v67, v94, v73
  v_mul_f32 v72, v89, v172
  v_fma_f32 v68, v68, v88, v72
  v_mul_f32 v73, v91, v172
  v_fma_f32 v69, v69, v90, v73
  v_mul_f32 v72, v93, v172
  v_fma_f32 v70, v70, v92, v72
  v_mul_f32 v73, v95, v172
  v_fma_f32 v71, v71, v94, v73
  v_cvt_pk_bf16_f32 v80, v64, v65
  v_cvt_pk_bf16_f32 v81, v66, v67
  v_cvt_pk_bf16_f32 v82, v68, v69
  v_cvt_pk_bf16_f32 v83, v70, v71
  buffer_store_dwordx2 v[80:81], v58, s[8:11], s86 offen sc1
  v_cmp_eq_u32 vcc, 4, v3
  v_mov_b32 v12, 0x3f803f80
  s_nop 0
  v_cndmask_b32 v82, v82, v12, vcc
  v_cndmask_b32 v83, v83, v12, vcc
  v_cmp_ge_u32 vcc, 4, v3
  s_and_saveexec_b64 s[40:41], vcc
  buffer_store_dwordx2 v[82:83], v58, s[8:11], s86 offen offset:256 sc1
  s_mov_b64 exec, s[40:41]
  v_mov_b32 v84, 0
  v_mov_b32 v85, 0
  v_mov_b32 v86, 0
  v_mov_b32 v87, 0
  s_mov_b64 exec, 1
  buffer_store_dwordx4 v[84:87], off, s[8:11], s87 sc1
  s_mov_b64 exec, -1
  s_nop 0
KVE_end_41:
KV_skip_36:
  s_cmp_eq_u32 s32, 0
  s_cbranch_scc0 QP_l1_42
  s_cmp_eq_u32 s28, 1
  s_cbranch_scc1 S0_st_44
  s_waitcnt vmcnt(6)
  v_and_b32 v10, 7, v3
  v_xor_b32 v9, v4, v10
  v_lshlrev_b32 v9, 4, v9
  v_lshlrev_b32 v10, 7, v10
  v_add_u32 v9, v9, v10
  v_lshrrev_b32 v10, 3, v3
  v_lshlrev_b32 v10, 10, v10
  v_add_u32 v9, v9, v10
  s_mul_i32 s40, s37, 20608
  v_add_u32 v9, s40, v9
  v_xor_b32 v10, 64, v9
  v_mov_b32 v44, 0
  v_mov_b32 v45, 0
  ds_read_b128 v[64:67], v9 offset:0
  ds_read_b128 v[68:71], v10 offset:0
  ds_read_b128 v[72:75], v9 offset:2048
  ds_read_b128 v[76:79], v10 offset:2048
  ds_read_b128 v[80:83], v9 offset:4096
  ds_read_b128 v[84:87], v10 offset:4096
  ds_read_b128 v[88:91], v9 offset:6144
  ds_read_b128 v[92:95], v10 offset:6144
  ds_read_b128 v[96:99], v9 offset:8192
  ds_read_b128 v[100:103], v10 offset:8192
  s_waitcnt lgkmcnt(9)
  v_dot2_f32_bf16 v44, v64, v7, v44
  v_dot2_f32_bf16 v45, v64, v64, v45
  v_dot2_f32_bf16 v44, v65, v7, v44
  v_dot2_f32_bf16 v45, v65, v65, v45
  v_dot2_f32_bf16 v44, v66, v7, v44
  v_dot2_f32_bf16 v45, v66, v66, v45
  v_dot2_f32_bf16 v44, v67, v7, v44
  v_dot2_f32_bf16 v45, v67, v67, v45
  ds_read_b128 v[64:67], v9 offset:10240
  s_waitcnt lgkmcnt(9)
  v_dot2_f32_bf16 v44, v68, v7, v44
  v_dot2_f32_bf16 v45, v68, v68, v45
  v_dot2_f32_bf16 v44, v69, v7, v44
  v_dot2_f32_bf16 v45, v69, v69, v45
  v_dot2_f32_bf16 v44, v70, v7, v44
  v_dot2_f32_bf16 v45, v70, v70, v45
  v_dot2_f32_bf16 v44, v71, v7, v44
  v_dot2_f32_bf16 v45, v71, v71, v45
  ds_read_b128 v[68:71], v10 offset:10240
  s_waitcnt lgkmcnt(9)
  v_dot2_f32_bf16 v44, v72, v7, v44
  v_dot2_f32_bf16 v45, v72, v72, v45
  v_dot2_f32_bf16 v44, v73, v7, v44
  v_dot2_f32_bf16 v45, v73, v73, v45
  v_dot2_f32_bf16 v44, v74, v7, v44
  v_dot2_f32_bf16 v45, v74, v74, v45
  v_dot2_f32_bf16 v44, v75, v7, v44
  v_dot2_f32_bf16 v45, v75, v75, v45
  ds_read_b128 v[72:75], v9 offset:12288
  s_waitcnt lgkmcnt(9)
  v_dot2_f32_bf16 v44, v76, v7, v44
  v_dot2_f32_bf16 v45, v76, v76, v45
  v_dot2_f32_bf16 v44, v77, v7, v44
  v_dot2_f32_bf16 v45, v77, v77, v45
  v_dot2_f32_bf16 v44, v78, v7, v44
  v_dot2_f32_bf16 v45, v78, v78, v45
  v_dot2_f32_bf16 v44, v79, v7, v44
  v_dot2_f32_bf16 v45, v79, v79, v45
  ds_read_b128 v[76:79], v10 offset:12288
  s_waitcnt lgkmcnt(9)
  v_dot2_f32_bf16 v44, v80, v7, v44
  v_dot2_f32_bf16 v45, v80, v80, v45
  v_dot2_f32_bf16 v44, v81, v7, v44
  v_dot2_f32_bf16 v45, v81, v81, v45
  v_dot2_f32_bf16 v44, v82, v7, v44
  v_dot2_f32_bf16 v45, v82, v82, v45
  v_dot2_f32_bf16 v44, v83, v7, v44
  v_dot2_f32_bf16 v45, v83, v83, v45
  ds_read_b128 v[80:83], v9 offset:14336
  s_waitcnt lgkmcnt(9)
  v_dot2_f32_bf16 v44, v84, v7, v44
  v_dot2_f32_bf16 v45, v84, v84, v45
  v_dot2_f32_bf16 v44, v85, v7, v44
  v_dot2_f32_bf16 v45, v85, v85, v45
  v_dot2_f32_bf16 v44, v86, v7, v44
  v_dot2_f32_bf16 v45, v86, v86, v45
  v_dot2_f32_bf16 v44, v87, v7, v44
  v_dot2_f32_bf16 v45, v87, v87, v45
  ds_read_b128 v[84:87], v10 offset:14336
  s_waitcnt lgkmcnt(9)
  v_dot2_f32_bf16 v44, v88, v7, v44
  v_dot2_f32_bf16 v45, v88, v88, v45
  v_dot2_f32_bf16 v44, v89, v7, v44
  v_dot2_f32_bf16 v45, v89, v89, v45
  v_dot2_f32_bf16 v44, v90, v7, v44
  v_dot2_f32_bf16 v45, v90, v90, v45
  v_dot2_f32_bf16 v44, v91, v7, v44
  v_dot2_f32_bf16 v45, v91, v91, v45
  ds_read_b128 v[88:91], v9 offset:16384
  s_waitcnt lgkmcnt(9)
  v_dot2_f32_bf16 v44, v92, v7, v44
  v_dot2_f32_bf16 v45, v92, v92, v45
  v_dot2_f32_bf16 v44, v93, v7, v44
  v_dot2_f32_bf16 v45, v93, v93, v45
  v_dot2_f32_bf16 v44, v94, v7, v44
  v_dot2_f32_bf16 v45, v94, v94, v45
  v_dot2_f32_bf16 v44, v95, v7, v44
  v_dot2_f32_bf16 v45, v95, v95, v45
  ds_read_b128 v[92:95], v10 offset:16384
  s_waitcnt lgkmcnt(9)
  v_dot2_f32_bf16 v44, v96, v7, v44
  v_dot2_f32_bf16 v45, v96, v96, v45
  v_dot2_f32_bf16 v44, v97, v7, v44
  v_dot2_f32_bf16 v45, v97, v97, v45
  v_dot2_f32_bf16 v44, v98, v7, v44
  v_dot2_f32_bf16 v45, v98, v98, v45
  v_dot2_f32_bf16 v44, v99, v7, v44
  v_dot2_f32_bf16 v45, v99, v99, v45
  ds_read_b128 v[96:99], v9 offset:18432
  s_waitcnt lgkmcnt(9)
  v_dot2_f32_bf16 v44, v100, v7, v44
  v_dot2_f32_bf16 v45, v100, v100, v45
  v_dot2_f32_bf16 v44, v101, v7, v44
  v_dot2_f32_bf16 v45, v101, v101, v45
  v_dot2_f32_bf16 v44, v102, v7, v44
  v_dot2_f32_bf16 v45, v102, v102, v45
  v_dot2_f32_bf16 v44, v103, v7, v44
  v_dot2_f32_bf16 v45, v103, v103, v45
  ds_read_b128 v[100:103], v10 offset:18432
  s_waitcnt lgkmcnt(9)
  v_dot2_f32_bf16 v44, v64, v7, v44
  v_dot2_f32_bf16 v45, v64, v64, v45
  v_dot2_f32_bf16 v44, v65, v7, v44
  v_dot2_f32_bf16 v45, v65, v65, v45
  v_dot2_f32_bf16 v44, v66, v7, v44
  v_dot2_f32_bf16 v45, v66, v66, v45
  v_dot2_f32_bf16 v44, v67, v7, v44
  v_dot2_f32_bf16 v45, v67, v67, v45
  s_waitcnt lgkmcnt(8)
  v_dot2_f32_bf16 v44, v68, v7, v44
  v_dot2_f32_bf16 v45, v68, v68, v45
  v_dot2_f32_bf16 v44, v69, v7, v44
  v_dot2_f32_bf16 v45, v69, v69, v45
  v_dot2_f32_bf16 v44, v70, v7, v44
  v_dot2_f32_bf16 v45, v70, v70, v45
  v_dot2_f32_bf16 v44, v71, v7, v44
  v_dot2_f32_bf16 v45, v71, v71, v45
  s_waitcnt lgkmcnt(7)
  v_dot2_f32_bf16 v44, v72, v7, v44
  v_dot2_f32_bf16 v45, v72, v72, v45
  v_dot2_f32_bf16 v44, v73, v7, v44
  v_dot2_f32_bf16 v45, v73, v73, v45
  v_dot2_f32_bf16 v44, v74, v7, v44
  v_dot2_f32_bf16 v45, v74, v74, v45
  v_dot2_f32_bf16 v44, v75, v7, v44
  v_dot2_f32_bf16 v45, v75, v75, v45
  s_waitcnt lgkmcnt(6)
  v_dot2_f32_bf16 v44, v76, v7, v44
  v_dot2_f32_bf16 v45, v76, v76, v45
  v_dot2_f32_bf16 v44, v77, v7, v44
  v_dot2_f32_bf16 v45, v77, v77, v45
  v_dot2_f32_bf16 v44, v78, v7, v44
  v_dot2_f32_bf16 v45, v78, v78, v45
  v_dot2_f32_bf16 v44, v79, v7, v44
  v_dot2_f32_bf16 v45, v79, v79, v45
  s_waitcnt lgkmcnt(5)
  v_dot2_f32_bf16 v44, v80, v7, v44
  v_dot2_f32_bf16 v45, v80, v80, v45
  v_dot2_f32_bf16 v44, v81, v7, v44
  v_dot2_f32_bf16 v45, v81, v81, v45
  v_dot2_f32_bf16 v44, v82, v7, v44
  v_dot2_f32_bf16 v45, v82, v82, v45
  v_dot2_f32_bf16 v44, v83, v7, v44
  v_dot2_f32_bf16 v45, v83, v83, v45
  s_waitcnt lgkmcnt(4)
  v_dot2_f32_bf16 v44, v84, v7, v44
  v_dot2_f32_bf16 v45, v84, v84, v45
  v_dot2_f32_bf16 v44, v85, v7, v44
  v_dot2_f32_bf16 v45, v85, v85, v45
  v_dot2_f32_bf16 v44, v86, v7, v44
  v_dot2_f32_bf16 v45, v86, v86, v45
  v_dot2_f32_bf16 v44, v87, v7, v44
  v_dot2_f32_bf16 v45, v87, v87, v45
  s_waitcnt lgkmcnt(3)
  v_dot2_f32_bf16 v44, v88, v7, v44
  v_dot2_f32_bf16 v45, v88, v88, v45
  v_dot2_f32_bf16 v44, v89, v7, v44
  v_dot2_f32_bf16 v45, v89, v89, v45
  v_dot2_f32_bf16 v44, v90, v7, v44
  v_dot2_f32_bf16 v45, v90, v90, v45
  v_dot2_f32_bf16 v44, v91, v7, v44
  v_dot2_f32_bf16 v45, v91, v91, v45
  s_waitcnt lgkmcnt(2)
  v_dot2_f32_bf16 v44, v92, v7, v44
  v_dot2_f32_bf16 v45, v92, v92, v45
  v_dot2_f32_bf16 v44, v93, v7, v44
  v_dot2_f32_bf16 v45, v93, v93, v45
  v_dot2_f32_bf16 v44, v94, v7, v44
  v_dot2_f32_bf16 v45, v94, v94, v45
  v_dot2_f32_bf16 v44, v95, v7, v44
  v_dot2_f32_bf16 v45, v95, v95, v45
  s_waitcnt lgkmcnt(1)
  v_dot2_f32_bf16 v44, v96, v7, v44
  v_dot2_f32_bf16 v45, v96, v96, v45
  v_dot2_f32_bf16 v44, v97, v7, v44
  v_dot2_f32_bf16 v45, v97, v97, v45
  v_dot2_f32_bf16 v44, v98, v7, v44
  v_dot2_f32_bf16 v45, v98, v98, v45
  v_dot2_f32_bf16 v44, v99, v7, v44
  v_dot2_f32_bf16 v45, v99, v99, v45
  s_waitcnt lgkmcnt(0)
  v_dot2_f32_bf16 v44, v100, v7, v44
  v_dot2_f32_bf16 v45, v100, v100, v45
  v_dot2_f32_bf16 v44, v101, v7, v44
  v_dot2_f32_bf16 v45, v101, v101, v45
  v_dot2_f32_bf16 v44, v102, v7, v44
  v_dot2_f32_bf16 v45, v102, v102, v45
  v_dot2_f32_bf16 v44, v103, v7, v44
  v_dot2_f32_bf16 v45, v103, v103, v45
  s_nop 1
  v_mov_b32 v46, v44
  s_nop 1
  v_permlane16_swap_b32 v44, v46
  v_add_f32 v44, v44, v46
  v_mov_b32 v46, v44
  s_nop 1
  v_permlane32_swap_b32 v44, v46
  v_add_f32 v44, v44, v46
  v_mov_b32 v47, v45
  s_nop 1
  v_permlane16_swap_b32 v45, v47
  v_add_f32 v45, v45, v47
  v_mov_b32 v47, v45
  s_nop 1
  v_permlane32_swap_b32 v45, v47
  v_add_f32 v45, v45, v47
  v_mul_f32 v44, 0x3acccccd, v44
  v_mul_f32 v45, 0x3acccccd, v45
  v_fma_f32 v45, -v44, v44, v45
  v_max_f32 v45, 0, v45
  v_add_f32 v45, 0x3727c5ac, v45
  v_rsq_f32 v46, v45
  s_nop 0
  v_mul_f32 v47, v44, v46
  v_sub_f32 v47, 0, v47
  s_add_u32 s40, s50, s37
  s_and_b32 s40, s40, 3
  s_lshl_b32 s40, s40, 7
  s_add_u32 s40, s40, 160384
  v_lshlrev_b32 v10, 3, v3
  v_add_u32 v10, s40, v10
  s_mov_b64 exec, 0xffff
  ds_write_b64 v10, v[46:47]
  s_mov_b64 exec, -1
  s_waitcnt lgkmcnt(0)
S0_st_44:
  s_cmp_eq_u32 s28, 1
  s_cbranch_scc0 S0_poll_45
  v_lshlrev_b32 v10, 2, v1
  s_mov_b32 s42, 400000
  s_nop 0
DBGP_46:
  buffer_load_dword v9, v10, s[20:23], 0 offen sc1
  s_waitcnt vmcnt(0)
  v_and_b32 v9, 0x01010101, v9
  v_cmp_ne_u32 vcc, 0x01010101, v9
  s_cmp_eq_u64 vcc, 0
  s_nop 3
  s_cbranch_scc1 DBGP_done_47
  s_sleep 1
  s_sub_u32 s42, s42, 1
  s_cmp_lg_u32 s42, 0
  s_cbranch_scc1 DBGP_46
DBGP_done_47:
  s_waitcnt vmcnt(0)
  s_cmp_eq_u32 s28, 1
  s_cbranch_scc0 KVF_48
  s_lshl_b32 s40, s31, 2
  s_add_u32 s40, s40, 4096
  s_add_u32 s43, s32, 1
  v_mov_b32 v11, 0
  v_mov_b32 v12, s43
  s_mov_b64 exec, 1
  buffer_store_dword v12, v11, s[8:11], s40 offen sc1
  s_mov_b64 exec, -1
KVF_48:
  v_lshrrev_b32 v9, 2, v1
  v_and_b32 v9, 3, v9
  v_lshlrev_b32 v10, 3, v4
  v_add_u32 v9, v9, v10
  v_lshlrev_b32 v9, 7, v9
  v_and_b32 v10, 3, v1
  v_lshlrev_b32 v10, 4, v10
  v_add_u32 v9, v9, v10
  s_lshr_b32 s40, s28, 1
  s_lshl_b32 s40, s40, 6
  s_and_b32 s41, s28, 1
  s_lshl_b32 s41, s41, 3
  s_add_u32 s40, s40, s41
  s_add_u32 s40, s40, 87552
  v_add_u32 v9, s40, v9
  s_cmp_lt_u32 s31, 96
  s_nop 0
  s_cbranch_scc0 PP2_49
  ds_read_b64_tr_b16 v[16:17], v9 offset:0
  ds_read_b64_tr_b16 v[18:19], v9 offset:512
  ds_read_b64_tr_b16 v[20:21], v9 offset:4096
  ds_read_b64_tr_b16 v[22:23], v9 offset:4608
  ds_read_b64_tr_b16 v[24:25], v9 offset:8192
  ds_read_b64_tr_b16 v[26:27], v9 offset:8704
  ds_read_b64_tr_b16 v[28:29], v9 offset:12288
  ds_read_b64_tr_b16 v[30:31], v9 offset:12800
  ds_read_b64_tr_b16 v[32:33], v9 offset:16384
  ds_read_b64_tr_b16 v[34:35], v9 offset:16896
  s_lshl_b32 s43, s65, 2
  s_add_u32 s43, s43, s28
  s_mov_b32 s44, s66
  s_mul_i32 s45, s43, 43
  s_lshr_b32 s45, s45, 9
  s_mul_i32 s48, s45, 12
  s_sub_u32 s48, s43, s48
  s_lshr_b32 s40, s48, 1
  s_and_b32 s41, s48, 1
  s_sub_u32 s42, s48, 8
  s_cmp_lt_u32 s48, 8
  s_cselect_b32 s40, s40, s42
  s_cselect_b32 s41, s41, 2
  s_lshl_b32 s45, s45, 2
  s_add_u32 s45, s45, s40
  s_mul_i32 s45, s45, 20
  s_add_u32 s45, s45, s44
  s_mul_i32 s45, s45, 3
  s_add_u32 s45, s45, s41
  s_lshl_b32 s45, s45, 10
  s_add_u32 s45, s45, 2908160
  s_waitcnt lgkmcnt(0)
  buffer_store_dwordx4 v[16:19], v2, s[8:11], s45 offen sc1
  s_add_u32 s45, s45, 3072
  buffer_store_dwordx4 v[20:23], v2, s[8:11], s45 offen sc1
  s_add_u32 s45, s45, 3072
  buffer_store_dwordx4 v[24:27], v2, s[8:11], s45 offen sc1
  s_add_u32 s45, s45, 3072
  buffer_store_dwordx4 v[28:31], v2, s[8:11], s45 offen sc1
  s_add_u32 s45, s45, 3072
  buffer_store_dwordx4 v[32:35], v2, s[8:11], s45 offen sc1
  buffer_store_dword v5, v5, s[8:11], 0 offen
  s_nop 0
  s_branch PPj_53
PP2_49:
  s_cmp_lt_u32 s31, 176
  s_cbranch_scc0 PPo_50
  ds_read_b64_tr_b16 v[16:17], v9 offset:0
  ds_read_b64_tr_b16 v[18:19], v9 offset:512
  ds_read_b64_tr_b16 v[20:21], v9 offset:4096
  ds_read_b64_tr_b16 v[22:23], v9 offset:4608
  ds_read_b64_tr_b16 v[24:25], v9 offset:8192
  ds_read_b64_tr_b16 v[26:27], v9 offset:8704
  ds_read_b64_tr_b16 v[28:29], v9 offset:12288
  ds_read_b64_tr_b16 v[30:31], v9 offset:12800
  ds_read_b64_tr_b16 v[32:33], v9 offset:16384
  ds_read_b64_tr_b16 v[34:35], v9 offset:16896
  ds_read_b64_tr_b16 v[36:37], v9 offset:20480
  ds_read_b64_tr_b16 v[38:39], v9 offset:20992
  s_lshl_b32 s43, s65, 2
  s_add_u32 s43, s43, s28
  s_mov_b32 s44, s66
  s_lshr_b32 s45, s43, 2
  s_and_b32 s48, s43, 3
  s_sub_u32 s41, s43, 32
  s_cmp_lt_u32 s43, 32
  s_cselect_b32 s45, s45, s41
  s_cselect_b32 s48, s48, 4
  s_mul_i32 s45, s45, 48
  s_add_u32 s45, s45, s44
  s_mul_i32 s45, s45, 5
  s_add_u32 s45, s45, s48
  s_lshl_b32 s45, s45, 10
  s_add_u32 s45, s45, 942080
  s_waitcnt lgkmcnt(0)
  buffer_store_dwordx4 v[16:19], v2, s[8:11], s45 offen sc1
  s_add_u32 s45, s45, 5120
  buffer_store_dwordx4 v[20:23], v2, s[8:11], s45 offen sc1
  s_add_u32 s45, s45, 5120
  buffer_store_dwordx4 v[24:27], v2, s[8:11], s45 offen sc1
  s_add_u32 s45, s45, 5120
  buffer_store_dwordx4 v[28:31], v2, s[8:11], s45 offen sc1
  s_add_u32 s45, s45, 5120
  buffer_store_dwordx4 v[32:35], v2, s[8:11], s45 offen sc1
  s_add_u32 s45, s45, 5120
  buffer_store_dwordx4 v[36:39], v2, s[8:11], s45 offen sc1
  s_nop 1
  s_branch PPj_53
PPo_50:
  s_cmp_lt_u32 s31, 216
  s_cbranch_scc0 PPb_51
  ds_read_b64_tr_b16 v[16:17], v9 offset:0
  ds_read_b64_tr_b16 v[18:19], v9 offset:512
  ds_read_b64_tr_b16 v[20:21], v9 offset:4096
  ds_read_b64_tr_b16 v[22:23], v9 offset:4608
  ds_read_b64_tr_b16 v[24:25], v9 offset:8192
  ds_read_b64_tr_b16 v[26:27], v9 offset:8704
  ds_read_b64_tr_b16 v[28:29], v9 offset:12288
  ds_read_b64_tr_b16 v[30:31], v9 offset:12800
  ds_read_b64_tr_b16 v[32:33], v9 offset:16384
  ds_read_b64_tr_b16 v[34:35], v9 offset:16896
  s_lshl_b32 s43, s65, 2
  s_add_u32 s43, s43, s28
  s_mov_b32 s44, s66
  s_lshr_b32 s45, s43, 2
  s_and_b32 s48, s43, 3
  s_sub_u32 s41, s43, 32
  s_cmp_lt_u32 s43, 32
  s_cselect_b32 s45, s45, s41
  s_cselect_b32 s48, s48, 4
  s_mul_i32 s45, s45, 20
  s_add_u32 s45, s45, s44
  s_mul_i32 s45, s45, 5
  s_add_u32 s45, s45, s48
  s_lshl_b32 s45, s45, 10
  s_add_u32 s45, s45, 122880
  s_waitcnt lgkmcnt(0)
  buffer_store_dwordx4 v[16:19], v2, s[8:11], s45 offen sc1
  s_add_u32 s45, s45, 5120
  buffer_store_dwordx4 v[20:23], v2, s[8:11], s45 offen sc1
  s_add_u32 s45, s45, 5120
  buffer_store_dwordx4 v[24:27], v2, s[8:11], s45 offen sc1
  s_add_u32 s45, s45, 5120
  buffer_store_dwordx4 v[28:31], v2, s[8:11], s45 offen sc1
  s_add_u32 s45, s45, 5120
  buffer_store_dwordx4 v[32:35], v2, s[8:11], s45 offen sc1
  buffer_store_dword v5, v5, s[8:11], 0 offen
  s_nop 0
  s_branch PPj_53
PPb_51:
  s_cmp_lt_u32 s31, 224
  s_cbranch_scc0 PPb2_52
  s_load_dwordx2 s[52:53], s[0:1], 56
  s_mov_b32 s54, 0xc00
  s_mov_b32 s55, 0x20000
  s_waitcnt lgkmcnt(0)
  s_and_b32 s53, s53, 0xffff
  s_sub_u32 s40, s31, 216
  s_lshl_b32 s40, s40, 2
  s_add_u32 s40, s40, s28
  s_lshl_b32 s41, s40, 6
  v_add_u32 v16, s41, v1
  v_lshrrev_b32 v17, 5, v16
  v_lshlrev_b32 v17, 5, v17
  v_lshrrev_b32 v18, 4, v16
  v_and_b32 v18, 1, v18
  v_lshlrev_b32 v18, 2, v18
  v_add_u32 v17, v17, v18
  v_lshrrev_b32 v18, 2, v3
  v_lshlrev_b32 v18, 3, v18
  v_add_u32 v17, v17, v18
  v_and_b32 v18, 3, v3
  v_add_u32 v17, v17, v18
  v_lshlrev_b32 v17, 1, v17
  buffer_load_ushort v19, v17, s[52:55], 0 offen
  v_lshlrev_b32 v16, 2, v16
  v_cmp_gt_u32 vcc, 6144, v16
  s_waitcnt vmcnt(0)
  v_lshlrev_b32 v19, 16, v19
  v_cndmask_b32 v16, v5, v16, vcc
  s_mov_b32 s45, 6291456
  buffer_store_dword v19, v16, s[8:11], s45 offen sc1
  buffer_store_dword v5, v5, s[8:11], 0 offen
  buffer_store_dword v5, v5, s[8:11], 0 offen
  buffer_store_dword v5, v5, s[8:11], 0 offen
  buffer_store_dword v5, v5, s[8:11], 0 offen
  buffer_store_dword v5, v5, s[8:11], 0 offen
  s_branch PPj_53
PPb2_52:
  s_cmp_lt_u32 s31, 232
  s_cbranch_scc0 PPn_54
  s_load_dwordx2 s[52:53], s[0:1], 72
  s_mov_b32 s54, 0x500
  s_mov_b32 s55, 0x20000
  s_waitcnt lgkmcnt(0)
  s_and_b32 s53, s53, 0xffff
  s_sub_u32 s40, s31, 224
  s_lshl_b32 s40, s40, 2
  s_add_u32 s40, s40, s28
  s_lshl_b32 s41, s40, 6
  v_add_u32 v16, s41, v1
  v_lshrrev_b32 v17, 5, v16
  v_lshlrev_b32 v17, 5, v17
  v_lshrrev_b32 v18, 4, v16
  v_and_b32 v18, 1, v18
  v_lshlrev_b32 v18, 2, v18
  v_add_u32 v17, v17, v18
  v_lshrrev_b32 v18, 2, v3
  v_lshlrev_b32 v18, 3, v18
  v_add_u32 v17, v17, v18
  v_and_b32 v18, 3, v3
  v_add_u32 v17, v17, v18
  v_lshlrev_b32 v17, 1, v17
  buffer_load_ushort v19, v17, s[52:55], 0 offen
  v_lshlrev_b32 v16, 2, v16
  v_cmp_gt_u32 vcc, 2560, v16
  s_waitcnt vmcnt(0)
  v_lshlrev_b32 v19, 16, v19
  v_cndmask_b32 v16, v5, v16, vcc
  s_mov_b32 s45, 6299648
  buffer_store_dword v19, v16, s[8:11], s45 offen sc1
  buffer_store_dword v5, v5, s[8:11], 0 offen
  buffer_store_dword v5, v5, s[8:11], 0 offen
  buffer_store_dword v5, v5, s[8:11], 0 offen
  buffer_store_dword v5, v5, s[8:11], 0 offen
  buffer_store_dword v5, v5, s[8:11], 0 offen
  s_branch PPj_53
PPn_54:
  buffer_store_dword v5, v5, s[8:11], 0 offen
  buffer_store_dword v5, v5, s[8:11], 0 offen
  buffer_store_dword v5, v5, s[8:11], 0 offen
  buffer_store_dword v5, v5, s[8:11], 0 offen
  buffer_store_dword v5, v5, s[8:11], 0 offen
  buffer_store_dword v5, v5, s[8:11], 0 offen
PPj_53:
  v_lshlrev_b32 v10, 2, v1
  s_lshl_b32 s44, s30, 7
  s_add_u32 s44, s44, 16384
  s_mov_b64 exec, 0xfffff
  s_mov_b32 s42, 400000
WQP_55:
  buffer_load_dword v9, v10, s[8:11], s44 offen sc1
  s_waitcnt vmcnt(0)
  v_cmp_ne_u32 vcc, 1, v9
  s_cmp_eq_u64 vcc, 0
  s_nop 3
  s_cbranch_scc1 WQP_done_56
  s_sleep 1
  s_sub_u32 s42, s42, 1
  s_cmp_lg_u32 s42, 0
  s_cbranch_scc1 WQP_55
WQP_done_56:
  s_mov_b64 exec, -1
S0_poll_45:
  s_waitcnt lgkmcnt(0)
  s_barrier
  v_accvgpr_write_b32 a246, v48
  v_accvgpr_write_b32 a247, v49
  v_accvgpr_write_b32 a248, v50
  v_accvgpr_write_b32 a249, v51
  v_accvgpr_write_b32 a250, v52
  v_accvgpr_write_b32 a251, v53
  v_accvgpr_write_b32 a252, v54
  v_accvgpr_write_b32 a253, v55
  v_accvgpr_write_b32 a254, v56
  v_accvgpr_write_b32 a255, v57
  s_cmp_eq_u32 s29, 21
  s_nop 0
  s_cbranch_scc0 PW3_57
  s_and_b32 s40, s30, 3
  s_cmp_eq_u32 s40, 0
  s_cbranch_scc0 PW3_57
  s_lshl_b32 s40, s49, 2
  s_add_u32 s40, s40, s28
  s_mul_i32 s44, s40, 10240
  s_add_u32 s44, s44, 6184960
  buffer_store_dwordx4 v[128:131], v2, s[8:11], s44 offen offset:0 sc1
  buffer_store_dwordx4 v[132:135], v2, s[8:11], s44 offen offset:1024 sc1
  buffer_store_dwordx4 v[136:139], v2, s[8:11], s44 offen offset:2048 sc1
  buffer_store_dwordx4 v[140:143], v2, s[8:11], s44 offen offset:3072 sc1
  s_add_u32 s44, s44, 4096
  buffer_store_dwordx4 v[144:147], v2, s[8:11], s44 offen offset:0 sc1
  buffer_store_dwordx4 v[148:151], v2, s[8:11], s44 offen offset:1024 sc1
  buffer_store_dwordx4 v[152:155], v2, s[8:11], s44 offen offset:2048 sc1
  buffer_store_dwordx4 v[156:159], v2, s[8:11], s44 offen offset:3072 sc1
  s_add_u32 s44, s44, 4096
  buffer_store_dwordx4 v[160:163], v2, s[8:11], s44 offen offset:0 sc1
  buffer_store_dwordx4 v[164:167], v2, s[8:11], s44 offen offset:1024 sc1
  s_cmp_eq_u32 s28, 1
  s_nop 0
  s_cbranch_scc0 PW3_57
  s_lshl_b32 s44, s49, 11
  s_add_u32 s44, s44, 118784
  buffer_store_dwordx4 v[168:171], v2, s[8:11], s44 offen offset:0 sc1
  buffer_store_dwordx4 v[172:175], v2, s[8:11], s44 offen offset:1024 sc1
  s_nop 1
PW3_57:
  s_lshl_b32 s40, s30, 2
  s_add_u32 s40, s40, s28
  s_mul_i32 s58, s40, 40960
  s_add_u32 s58, s58, 4874240
  v_and_b32 v119, 31, v1
  v_cmp_gt_u32 vcc, 20, v119
  v_mov_b32 v119, 0x40000000
  s_nop 0
  v_cndmask_b32 v119, v119, v2, vcc
  buffer_load_dwordx4 a[0:3], v119, s[8:11], s58 offen offset:0 sc1
  buffer_load_dwordx4 a[4:7], v119, s[8:11], s58 offen offset:1024 sc1
  buffer_load_dwordx4 a[8:11], v119, s[8:11], s58 offen offset:2048 sc1
  buffer_load_dwordx4 a[12:15], v119, s[8:11], s58 offen offset:3072 sc1
  s_add_u32 s58, s58, 4096
  buffer_load_dwordx4 a[16:19], v119, s[8:11], s58 offen offset:0 sc1
  buffer_load_dwordx4 a[20:23], v119, s[8:11], s58 offen offset:1024 sc1
  buffer_load_dwordx4 a[24:27], v119, s[8:11], s58 offen offset:2048 sc1
  buffer_load_dwordx4 a[28:31], v119, s[8:11], s58 offen offset:3072 sc1
  s_add_u32 s58, s58, 4096
  buffer_load_dwordx4 a[32:35], v119, s[8:11], s58 offen offset:0 sc1
  buffer_load_dwordx4 a[36:39], v119, s[8:11], s58 offen offset:1024 sc1
  buffer_load_dwordx4 a[40:43], v119, s[8:11], s58 offen offset:2048 sc1
  buffer_load_dwordx4 a[44:47], v119, s[8:11], s58 offen offset:3072 sc1
  v_and_b32 v9, 7, v3
  v_lshrrev_b32 v10, 5, v1
  v_xor_b32 v10, v10, v9
  v_lshlrev_b32 v10, 4, v10
  v_lshlrev_b32 v9, 7, v9
  v_add_u32 v10, v10, v9
  v_lshrrev_b32 v9, 3, v3
  v_lshlrev_b32 v9, 10, v9
  v_add_u32 v10, v10, v9
  v_lshrrev_b32 v9, 4, v1
  v_and_b32 v9, 1, v9
  s_sub_u32 s40, 4, s50
  v_add_u32 v11, s40, v9
  v_add_u32 v11, 0, v11
  v_and_b32 v11, 3, v11
  v_mul_u32_u24 v11, 20608, v11
  v_add_u32 v96, v11, v10
  v_xor_b32 v97, 32, v96
  v_xor_b32 v98, 64, v96
  v_xor_b32 v99, 96, v96
  v_add_u32 v11, s40, v9
  v_add_u32 v11, 2, v11
  v_and_b32 v11, 3, v11
  v_mul_u32_u24 v11, 20608, v11
  v_add_u32 v100, v11, v10
  v_xor_b32 v101, 32, v100
  v_xor_b32 v102, 64, v100
  v_xor_b32 v103, 96, v100
  v_mov_b32 v12, 0x3f803f80
  v_mov_b32 v13, 0x3f803f80
  v_mov_b32 v14, 0x3f803f80
  v_mov_b32 v15, 0x3f803f80
  ds_read_b128 v[16:19], v96 offset:0
  ds_read_b128 v[20:23], v100 offset:0
  ds_read_b128 v[24:27], v97 offset:0
  ds_read_b128 v[28:31], v101 offset:0
  s_waitcnt vmcnt(10)
  s_waitcnt lgkmcnt(2)
  v_mfma_f32_32x32x16_bf16 v[64:79], a[0:3], v[16:19], 0
  ds_read_b128 v[32:35], v98 offset:0
  v_add_u32 v224, 102400, v2
  v_lshlrev_b32 v225, 3, v1
  v_add_u32 v225, 104768, v225
  v_lshrrev_b32 v40, 5, v1
  v_mfma_f32_32x32x16_bf16 v[80:95], a[0:3], v[20:23], 0
  ds_read_b128 v[36:39], v102 offset:0
  s_add_u32 s58, s58, 4096
  buffer_load_dwordx4 a[48:51], v119, s[8:11], s58 offen offset:0 sc1
  v_mul_u32_u24 v40, 21, v40
  v_and_b32 v41, 31, v1
  v_add_u32 v40, v40, v41
  v_lshlrev_b32 v40, 4, v40
  v_mfma_f32_32x32x16_bf16 v[192:207], a[0:3], v[12:15], 0
  s_waitcnt lgkmcnt(2)
  v_mfma_f32_32x32x16_bf16 v[64:79], a[4:7], v[24:27], v[64:79]
  ds_read_b128 v[16:19], v99 offset:0
  v_add_u32 v226, 103424, v40
  v_add_u32 v253, 104096, v40
  v_mov_b32 v40, 105280
  v_cmp_lt_u32 vcc, 20, v41
  s_nop 1
  v_cndmask_b32 v226, v226, v40, vcc
  v_cndmask_b32 v253, v253, v40, vcc
  v_mfma_f32_32x32x16_bf16 v[80:95], a[4:7], v[28:31], v[80:95]
  ds_read_b128 v[20:23], v103 offset:0
  buffer_load_dwordx4 a[52:55], v119, s[8:11], s58 offen offset:1024 sc1
  v_mov_b32 v144, 0
  v_mov_b32 v160, 0
  v_mov_b32 v145, 0
  v_mov_b32 v161, 0
  v_mfma_f32_32x32x16_bf16 v[192:207], a[4:7], v[12:15], v[192:207]
  s_waitcnt vmcnt(10)
  s_waitcnt lgkmcnt(2)
  v_mfma_f32_32x32x16_bf16 v[64:79], a[8:11], v[32:35], v[64:79]
  ds_read_b128 v[24:27], v96 offset:2048
  v_mov_b32 v146, 0
  v_mov_b32 v162, 0
  v_mov_b32 v147, 0
  v_mov_b32 v163, 0
  v_mfma_f32_32x32x16_bf16 v[80:95], a[8:11], v[36:39], v[80:95]
  ds_read_b128 v[28:31], v100 offset:2048
  buffer_load_dwordx4 a[56:59], v119, s[8:11], s58 offen offset:2048 sc1
  v_mov_b32 v148, 0
  v_mov_b32 v164, 0
  v_mov_b32 v149, 0
  v_mov_b32 v165, 0
  v_mfma_f32_32x32x16_bf16 v[192:207], a[8:11], v[12:15], v[192:207]
  s_waitcnt lgkmcnt(2)
  v_mfma_f32_32x32x16_bf16 v[64:79], a[12:15], v[16:19], v[64:79]
  ds_read_b128 v[32:35], v97 offset:2048
  v_mov_b32 v150, 0
  v_mov_b32 v166, 0
  v_mov_b32 v151, 0
  v_mov_b32 v167, 0
  v_mfma_f32_32x32x16_bf16 v[80:95], a[12:15], v[20:23], v[80:95]
  ds_read_b128 v[36:39], v101 offset:2048
  buffer_load_dwordx4 a[60:63], v119, s[8:11], s58 offen offset:3072 sc1
  v_mov_b32 v152, 0
  v_mov_b32 v168, 0
  v_mov_b32 v153, 0
  v_mov_b32 v169, 0
  v_mfma_f32_32x32x16_bf16 v[192:207], a[12:15], v[12:15], v[192:207]
  s_waitcnt vmcnt(10)
  s_waitcnt lgkmcnt(2)
  v_mfma_f32_32x32x16_bf16 v[64:79], a[16:19], v[24:27], v[64:79]
  ds_read_b128 v[16:19], v98 offset:2048
  v_mov_b32 v154, 0
  v_mov_b32 v170, 0
  v_mov_b32 v155, 0
  v_mov_b32 v171, 0
  v_mfma_f32_32x32x16_bf16 v[80:95], a[16:19], v[28:31], v[80:95]
  ds_read_b128 v[20:23], v102 offset:2048
  s_add_u32 s58, s58, 4096
  buffer_load_dwordx4 a[64:67], v119, s[8:11], s58 offen offset:0 sc1
  v_mov_b32 v156, 0
  v_mov_b32 v172, 0
  v_mov_b32 v157, 0
  v_mov_b32 v173, 0
  v_mfma_f32_32x32x16_bf16 v[192:207], a[16:19], v[12:15], v[192:207]
  s_waitcnt lgkmcnt(2)
  v_mfma_f32_32x32x16_bf16 v[64:79], a[20:23], v[32:35], v[64:79]
  ds_read_b128 v[24:27], v99 offset:2048
  v_mov_b32 v158, 0
  v_mov_b32 v174, 0
  v_mov_b32 v159, 0
  v_mov_b32 v175, 0
  v_mfma_f32_32x32x16_bf16 v[80:95], a[20:23], v[36:39], v[80:95]
  ds_read_b128 v[28:31], v103 offset:2048
  buffer_load_dwordx4 a[68:71], v119, s[8:11], s58 offen offset:1024 sc1
  v_mov_b32 v136, 0
  v_mov_b32 v137, 0
  v_mov_b32 v138, 0
  v_mov_b32 v139, 0
  v_mfma_f32_32x32x16_bf16 v[192:207], a[20:23], v[12:15], v[192:207]
  s_waitcnt vmcnt(10)
  s_waitcnt lgkmcnt(2)
  v_mfma_f32_32x32x16_bf16 v[64:79], a[24:27], v[16:19], v[64:79]
  ds_read_b128 v[32:35], v96 offset:4096
  v_mov_b32 v140, 0
  v_mov_b32 v141, 0
  v_mov_b32 v142, 0
  v_mov_b32 v143, 0
  v_mfma_f32_32x32x16_bf16 v[80:95], a[24:27], v[20:23], v[80:95]
  ds_read_b128 v[36:39], v100 offset:4096
  buffer_load_dwordx4 a[72:75], v119, s[8:11], s58 offen offset:2048 sc1
  v_mov_b32 v220, 0
  v_mov_b32 v221, 0
  v_mov_b32 v222, 0
  v_mov_b32 v223, 0
  v_mfma_f32_32x32x16_bf16 v[192:207], a[24:27], v[12:15], v[192:207]
  s_waitcnt lgkmcnt(2)
  v_mfma_f32_32x32x16_bf16 v[64:79], a[28:31], v[24:27], v[64:79]
  ds_read_b128 v[16:19], v97 offset:4096
  s_mul_i32 s59, s30, 102400
  s_mul_i32 s60, s28, 25600
  s_add_u32 s59, s59, s60
  s_add_u32 s59, s59, 122880
  v_mfma_f32_32x32x16_bf16 v[80:95], a[28:31], v[28:31], v[80:95]
  ds_read_b128 v[20:23], v101 offset:4096
  buffer_load_dwordx4 a[76:79], v119, s[8:11], s58 offen offset:3072 sc1
  s_lshl_b32 s61, s30, 2
  s_add_u32 s61, s61, s28
  s_mul_i32 s61, s61, 61440
  s_add_u32 s61, s61, 2908160
  v_mfma_f32_32x32x16_bf16 v[192:207], a[28:31], v[12:15], v[192:207]
  s_waitcnt vmcnt(10)
  s_waitcnt lgkmcnt(2)
  v_mfma_f32_32x32x16_bf16 v[64:79], a[32:35], v[32:35], v[64:79]
  ds_read_b128 v[24:27], v98 offset:4096
  s_mul_i32 s40, s30, 12
  s_lshl_b32 s41, s28, 1
  s_add_u32 s66, s40, s41
  s_lshl_b32 s66, s66, 6
  v_mfma_f32_32x32x16_bf16 v[80:95], a[32:35], v[36:39], v[80:95]
  ds_read_b128 v[28:31], v102 offset:4096
  s_add_u32 s58, s58, 4096
  buffer_load_dwordx4 a[80:83], v119, s[8:11], s58 offen offset:0 sc1
  s_add_u32 s66, s66, 6291456
  s_add_u32 s67, s40, s28
  s_add_u32 s67, s67, 8
  s_lshl_b32 s67, s67, 6
  v_mfma_f32_32x32x16_bf16 v[192:207], a[32:35], v[12:15], v[192:207]
  s_waitcnt lgkmcnt(2)
  v_mfma_f32_32x32x16_bf16 v[64:79], a[36:39], v[16:19], v[64:79]
  ds_read_b128 v[32:35], v99 offset:4096
  s_add_u32 s67, s67, 6291456
  v_lshlrev_b32 v252, 4, v4
  s_cmp_eq_u32 s32, 0
  s_mov_b32 s88, 6324224
  s_cselect_b32 s88, s88, 8945664
  v_mfma_f32_32x32x16_bf16 v[80:95], a[36:39], v[20:23], v[80:95]
  ds_read_b128 v[36:39], v103 offset:4096
  buffer_load_dwordx4 a[84:87], v119, s[8:11], s58 offen offset:1024 sc1
  s_lshl_b32 s40, s29, 3
  s_add_u32 s40, s40, s30
  s_lshl_b32 s40, s40, 2
  s_add_u32 s40, s40, s28
  v_mfma_f32_32x32x16_bf16 v[192:207], a[36:39], v[12:15], v[192:207]
  s_waitcnt vmcnt(10)
  s_waitcnt lgkmcnt(2)
  v_mfma_f32_32x32x16_bf16 v[64:79], a[40:43], v[24:27], v[64:79]
  ds_read_b128 v[16:19], v96 offset:6144
  s_mul_i32 s40, s40, 2560
  s_add_u32 s88, s88, s40
  v_min_u32 v56, 19, v1
  v_lshlrev_b32 v56, 7, v56
  v_mfma_f32_32x32x16_bf16 v[80:95], a[40:43], v[28:31], v[80:95]
  ds_read_b128 v[20:23], v100 offset:6144
  buffer_load_dwordx4 a[88:91], v119, s[8:11], s58 offen offset:2048 sc1
  s_cmp_eq_u32 s32, 0
  s_mov_b32 s89, 11567104
  s_cselect_b32 s89, s89, 14188544
  s_lshl_b32 s40, s29, 3
  v_mfma_f32_32x32x16_bf16 v[192:207], a[40:43], v[12:15], v[192:207]
  s_waitcnt lgkmcnt(2)
  v_mfma_f32_32x32x16_bf16 v[64:79], a[44:47], v[32:35], v[64:79]
  ds_read_b128 v[24:27], v97 offset:6144
  s_add_u32 s40, s40, s30
  s_lshl_b32 s40, s40, 2
  s_add_u32 s40, s40, s28
  s_mul_i32 s40, s40, 2560
  v_mfma_f32_32x32x16_bf16 v[80:95], a[44:47], v[36:39], v[80:95]
  ds_read_b128 v[28:31], v101 offset:6144
  buffer_load_dwordx4 a[92:95], v119, s[8:11], s58 offen offset:3072 sc1
  s_add_u32 s89, s89, s40
  v_min_u32 v57, 19, v1
  v_lshlrev_b32 v57, 7, v57
  s_cmp_eq_u32 s32, 0
  s_mov_b32 s74, 19431424
  s_cselect_b32 s74, s74, 25722880
  v_mfma_f32_32x32x16_bf16 v[192:207], a[44:47], v[12:15], v[192:207]
  s_waitcnt vmcnt(10)
  s_waitcnt lgkmcnt(2)
  v_mfma_f32_32x32x16_bf16 v[64:79], a[48:51], v[16:19], v[64:79]
  ds_read_b128 v[32:35], v98 offset:6144
  s_lshl_b32 s40, s29, 3
  s_add_u32 s40, s40, s30
  s_lshl_b32 s40, s40, 2
  s_add_u32 s40, s40, s28
  v_mfma_f32_32x32x16_bf16 v[80:95], a[48:51], v[20:23], v[80:95]
  ds_read_b128 v[36:39], v102 offset:6144
  s_add_u32 s58, s58, 4096
  buffer_load_dwordx4 a[96:99], v119, s[8:11], s58 offen offset:0 sc1
  s_mul_i32 s40, s40, 6144
  s_add_u32 s74, s74, s40
  v_min_u32 v58, 47, v1
  v_lshlrev_b32 v58, 7, v58
  v_mfma_f32_32x32x16_bf16 v[192:207], a[48:51], v[12:15], v[192:207]
  s_waitcnt lgkmcnt(2)
  v_mfma_f32_32x32x16_bf16 v[64:79], a[52:55], v[24:27], v[64:79]
  ds_read_b128 v[16:19], v99 offset:6144
  s_and_b32 s40, s29, 3
  s_lshl_b32 s40, s40, 2
  s_add_u32 s40, s40, s28
  s_mul_i32 s40, s40, 10624
  v_mfma_f32_32x32x16_bf16 v[80:95], a[52:55], v[28:31], v[80:95]
  ds_read_b128 v[20:23], v103 offset:6144
  buffer_load_dwordx4 a[100:103], v119, s[8:11], s58 offen offset:1024 sc1
  s_mul_i32 s75, s30, 245760
  s_add_u32 s75, s75, s40
  s_add_u32 s75, s75, 1018880
  v_add_u32 v59, 0, v1
  v_mfma_f32_32x32x16_bf16 v[192:207], a[52:55], v[12:15], v[192:207]
  s_waitcnt vmcnt(10)
  s_waitcnt lgkmcnt(2)
  v_mfma_f32_32x32x16_bf16 v[64:79], a[56:59], v[32:35], v[64:79]
  ds_read_b128 v[24:27], v96 offset:8192
  v_min_u32 v59, 82, v59
  v_lshlrev_b32 v59, 7, v59
  v_add_u32 v60, 64, v1
  v_min_u32 v60, 82, v60
  v_mfma_f32_32x32x16_bf16 v[80:95], a[56:59], v[36:39], v[80:95]
  ds_read_b128 v[28:31], v100 offset:8192
  buffer_load_dwordx4 a[104:107], v119, s[8:11], s58 offen offset:2048 sc1
  v_lshlrev_b32 v60, 7, v60
  s_cmp_eq_u32 s32, 0
  s_mov_b32 s77, 6324224
  s_cselect_b32 s77, s77, 8945664
  v_mfma_f32_32x32x16_bf16 v[192:207], a[56:59], v[12:15], v[192:207]
  s_waitcnt lgkmcnt(2)
  v_mfma_f32_32x32x16_bf16 v[64:79], a[60:63], v[16:19], v[64:79]
  ds_read_b128 v[32:35], v97 offset:8192
  s_add_u32 s78, s77, 40960
  s_mul_i32 s41, s30, 80
  s_mul_i32 s40, s28, 20
  s_add_u32 s41, s41, s40
  v_mfma_f32_32x32x16_bf16 v[80:95], a[60:63], v[20:23], v[80:95]
  ds_read_b128 v[36:39], v101 offset:8192
  buffer_load_dwordx4 a[108:111], v119, s[8:11], s58 offen offset:3072 sc1
  v_lshrrev_b32 v40, 5, v1
  v_lshlrev_b32 v40, 2, v40
  v_add_u32 v40, s41, v40
  v_lshrrev_b32 v41, 4, v1
  v_mfma_f32_32x32x16_bf16 v[192:207], a[60:63], v[12:15], v[192:207]
  s_waitcnt vmcnt(10)
  s_waitcnt lgkmcnt(2)
  v_mfma_f32_32x32x16_bf16 v[64:79], a[64:67], v[24:27], v[64:79]
  ds_read_b128 v[16:19], v98 offset:8192
  v_and_b32 v41, 1, v41
  s_lshl_b32 s40, s29, 2
  v_add_u32 v41, s40, v41
  v_mul_u32_u24 v41, 20480, v41
  v_mfma_f32_32x32x16_bf16 v[80:95], a[64:67], v[28:31], v[80:95]
  ds_read_b128 v[20:23], v102 offset:8192
  s_add_u32 s58, s58, 4096
  buffer_load_dwordx4 a[112:115], v119, s[8:11], s58 offen offset:0 sc1
  v_lshlrev_b32 v42, 4, v3
  v_add_u32 v41, v41, v42
  v_add_u32 v42, 0, v40
  v_lshrrev_b32 v43, 5, v42
  v_mfma_f32_32x32x16_bf16 v[192:207], a[64:67], v[12:15], v[192:207]
  s_waitcnt lgkmcnt(2)
  v_mfma_f32_32x32x16_bf16 v[64:79], a[68:71], v[32:35], v[64:79]
  ds_read_b128 v[24:27], v99 offset:8192
  v_lshlrev_b32 v43, 10, v43
  v_add_u32 v61, v41, v43
  v_bfe_u32 v43, v42, 3, 2
  v_lshlrev_b32 v43, 8, v43
  v_mfma_f32_32x32x16_bf16 v[80:95], a[68:71], v[36:39], v[80:95]
  ds_read_b128 v[28:31], v103 offset:8192
  buffer_load_dwordx4 a[116:119], v119, s[8:11], s58 offen offset:1024 sc1
  v_add_u32 v61, v61, v43
  v_bfe_u32 v43, v42, 2, 1
  v_lshlrev_b32 v43, 3, v43
  v_add_u32 v61, v61, v43
  v_mfma_f32_32x32x16_bf16 v[192:207], a[68:71], v[12:15], v[192:207]
  s_waitcnt vmcnt(10)
  s_waitcnt lgkmcnt(2)
  v_mfma_f32_32x32x16_bf16 v[64:79], a[72:75], v[16:19], v[64:79]
  ds_read_b128 v[32:35], v96 offset:10240
  v_add_u32 v42, 8, v40
  v_lshrrev_b32 v43, 5, v42
  v_lshlrev_b32 v43, 10, v43
  v_add_u32 v62, v41, v43
  v_mfma_f32_32x32x16_bf16 v[80:95], a[72:75], v[20:23], v[80:95]
  ds_read_b128 v[36:39], v100 offset:10240
  buffer_load_dwordx4 a[120:123], v119, s[8:11], s58 offen offset:2048 sc1
  v_bfe_u32 v43, v42, 3, 2
  v_lshlrev_b32 v43, 8, v43
  v_add_u32 v62, v62, v43
  v_bfe_u32 v43, v42, 2, 1
  v_mfma_f32_32x32x16_bf16 v[192:207], a[72:75], v[12:15], v[192:207]
  s_waitcnt lgkmcnt(2)
  v_mfma_f32_32x32x16_bf16 v[64:79], a[76:79], v[24:27], v[64:79]
  ds_read_b128 v[16:19], v97 offset:10240
  v_lshlrev_b32 v43, 3, v43
  v_add_u32 v62, v62, v43
  v_add_u32 v42, 16, v40
  v_lshrrev_b32 v43, 5, v42
  v_mfma_f32_32x32x16_bf16 v[80:95], a[76:79], v[28:31], v[80:95]
  ds_read_b128 v[20:23], v101 offset:10240
  buffer_load_dwordx4 a[124:127], v119, s[8:11], s58 offen offset:3072 sc1
  v_lshlrev_b32 v43, 10, v43
  v_add_u32 v63, v41, v43
  v_bfe_u32 v43, v42, 3, 2
  v_lshlrev_b32 v43, 8, v43
  v_mfma_f32_32x32x16_bf16 v[192:207], a[76:79], v[12:15], v[192:207]
  s_cmp_eq_u32 s28, 0
  s_nop 10
  s_cbranch_scc0 KVL_58
  s_mov_b32 s40, 4096
  buffer_load_dwordx4 v[44:47], v2, s[8:11], s40 offen sc1
KVL_58:
  s_waitcnt vmcnt(10)
  s_waitcnt lgkmcnt(2)
  v_mfma_f32_32x32x16_bf16 v[64:79], a[80:83], v[32:35], v[64:79]
  ds_read_b128 v[24:27], v98 offset:10240
  v_add_u32 v63, v63, v43
  v_bfe_u32 v43, v42, 2, 1
  v_lshlrev_b32 v43, 3, v43
  v_add_u32 v63, v63, v43
  v_mfma_f32_32x32x16_bf16 v[80:95], a[80:83], v[36:39], v[80:95]
  ds_read_b128 v[28:31], v102 offset:10240
  s_add_u32 s58, s58, 4096
  buffer_load_dwordx4 a[128:131], v119, s[8:11], s58 offen offset:0 sc1
  v_mfma_f32_32x32x16_bf16 v[192:207], a[80:83], v[12:15], v[192:207]
  s_waitcnt lgkmcnt(2)
  v_mfma_f32_32x32x16_bf16 v[64:79], a[84:87], v[16:19], v[64:79]
  ds_read_b128 v[32:35], v99 offset:10240
  v_mfma_f32_32x32x16_bf16 v[80:95], a[84:87], v[20:23], v[80:95]
  ds_read_b128 v[36:39], v103 offset:10240
  buffer_load_dwordx4 a[132:135], v119, s[8:11], s58 offen offset:1024 sc1
  v_mfma_f32_32x32x16_bf16 v[192:207], a[84:87], v[12:15], v[192:207]
  s_waitcnt vmcnt(10)
  s_waitcnt lgkmcnt(2)
  v_mfma_f32_32x32x16_bf16 v[64:79], a[88:91], v[24:27], v[64:79]
  ds_read_b128 v[16:19], v96 offset:12288
  v_mfma_f32_32x32x16_bf16 v[80:95], a[88:91], v[28:31], v[80:95]
  ds_read_b128 v[20:23], v100 offset:12288
  buffer_load_dwordx4 a[136:139], v119, s[8:11], s58 offen offset:2048 sc1
  v_mfma_f32_32x32x16_bf16 v[192:207], a[88:91], v[12:15], v[192:207]
  s_waitcnt lgkmcnt(2)
  v_mfma_f32_32x32x16_bf16 v[64:79], a[92:95], v[32:35], v[64:79]
  ds_read_b128 v[24:27], v97 offset:12288
  v_mfma_f32_32x32x16_bf16 v[80:95], a[92:95], v[36:39], v[80:95]
  ds_read_b128 v[28:31], v101 offset:12288
  buffer_load_dwordx4 a[140:143], v119, s[8:11], s58 offen offset:3072 sc1
  v_mfma_f32_32x32x16_bf16 v[192:207], a[92:95], v[12:15], v[192:207]
  s_waitcnt vmcnt(10)
  s_waitcnt lgkmcnt(2)
  v_mfma_f32_32x32x16_bf16 v[64:79], a[96:99], v[16:19], v[64:79]
  ds_read_b128 v[32:35], v98 offset:12288
  v_mfma_f32_32x32x16_bf16 v[80:95], a[96:99], v[20:23], v[80:95]
  ds_read_b128 v[36:39], v102 offset:12288
  s_add_u32 s58, s58, 4096
  buffer_load_dwordx4 a[144:147], v119, s[8:11], s58 offen offset:0 sc1
  v_mfma_f32_32x32x16_bf16 v[192:207], a[96:99], v[12:15], v[192:207]
  s_waitcnt lgkmcnt(2)
  v_mfma_f32_32x32x16_bf16 v[64:79], a[100:103], v[24:27], v[64:79]
  ds_read_b128 v[16:19], v99 offset:12288
  v_mfma_f32_32x32x16_bf16 v[80:95], a[100:103], v[28:31], v[80:95]
  ds_read_b128 v[20:23], v103 offset:12288
  buffer_load_dwordx4 a[148:151], v119, s[8:11], s58 offen offset:1024 sc1
  v_mfma_f32_32x32x16_bf16 v[192:207], a[100:103], v[12:15], v[192:207]
  s_cmp_eq_u32 s28, 0
  s_nop 10
  s_cbranch_scc0 KVW_59
  s_add_u32 s43, s32, 1
  s_waitcnt vmcnt(6)
  v_min_u32 v44, v44, v45
  v_min_u32 v46, v46, v47
  v_min_u32 v44, v44, v46
  v_cmp_gt_u32 vcc, s43, v44
  s_cmp_eq_u64 vcc, 0
  s_nop 3
  s_cbranch_scc1 KVW_59
  s_add_u32 s43, s32, 1
  s_mov_b32 s40, 4096
  s_mov_b32 s42, 400000
KVP_60:
  buffer_load_dwordx4 v[44:47], v2, s[8:11], s40 offen sc1
  s_waitcnt vmcnt(0)
  v_min_u32 v44, v44, v45
  v_min_u32 v46, v46, v47
  v_min_u32 v44, v44, v46
  v_cmp_gt_u32 vcc, s43, v44
  s_cmp_eq_u64 vcc, 0
  s_nop 3
  s_cbranch_scc1 KVP_done_61
  s_sleep 1
  s_sub_u32 s42, s42, 1
  s_cmp_lg_u32 s42, 0
  s_cbranch_scc1 KVP_60
KVP_done_61:
KVW_59:
  s_barrier
  s_cmp_eq_u32 s32, 0
  s_mov_b32 s53, 34111488
  s_cselect_b32 s53, s53, 34308096
  s_mul_i32 s54, s28, 3072
  s_add_u32 s55, s53, s54
  s_add_u32 m0, s54, 102400
  s_nop 0
  buffer_load_dwordx4 v2, s[8:11], s55 offen offset:0 sc1 lds
  buffer_load_dwordx4 v2, s[8:11], s55 offen offset:1024 sc1 lds
  buffer_load_dwordx4 v2, s[8:11], s55 offen offset:2048 sc1 lds
  s_add_u32 s55, s55, 12288
  s_add_u32 m0, s54, 114688
  s_nop 0
  buffer_load_dwordx4 v2, s[8:11], s55 offen offset:0 sc1 lds
  buffer_load_dwordx4 v2, s[8:11], s55 offen offset:1024 sc1 lds
  buffer_load_dwordx4 v2, s[8:11], s55 offen offset:2048 sc1 lds
  s_add_u32 s55, s55, 12288
  s_add_u32 m0, s54, 126976
  s_nop 0
  buffer_load_dwordx4 v2, s[8:11], s55 offen offset:0 sc1 lds
  buffer_load_dwordx4 v2, s[8:11], s55 offen offset:1024 sc1 lds
  buffer_load_dwordx4 v2, s[8:11], s55 offen offset:2048 sc1 lds
  s_add_u32 s55, s55, 12288
  s_cmp_eq_u32 s32, 0
  s_mov_b32 s45, 34504704
  s_cselect_b32 s45, s45, 34508800
  v_lshlrev_b32 v48, 3, v1
  s_lshl_b32 s40, s29, 5
  s_add_u32 s40, s40, 8192
  v_and_b32 v49, 7, v1
  v_lshlrev_b32 v49, 2, v49
  buffer_load_dword v227, v49, s[8:11], s40 offen sc1
  buffer_load_dwordx2 v[50:51], v48, s[8:11], s45 offen sc1
  s_waitcnt vmcnt(21)
  s_waitcnt lgkmcnt(2)
  v_mfma_f32_32x32x16_bf16 v[64:79], a[104:107], v[32:35], v[64:79]
  ds_read_b128 v[24:27], v96 offset:14336
  v_mfma_f32_32x32x16_bf16 v[80:95], a[104:107], v[36:39], v[80:95]
  ds_read_b128 v[28:31], v100 offset:14336
  buffer_load_dwordx4 a[152:155], v119, s[8:11], s58 offen offset:2048 sc1
  v_mfma_f32_32x32x16_bf16 v[192:207], a[104:107], v[12:15], v[192:207]
  s_waitcnt lgkmcnt(2)
  v_mfma_f32_32x32x16_bf16 v[64:79], a[108:111], v[16:19], v[64:79]
  ds_read_b128 v[32:35], v97 offset:14336
  v_mfma_f32_32x32x16_bf16 v[80:95], a[108:111], v[20:23], v[80:95]
  ds_read_b128 v[36:39], v101 offset:14336
  buffer_load_dwordx4 a[156:159], v119, s[8:11], s58 offen offset:3072 sc1
  v_mfma_f32_32x32x16_bf16 v[192:207], a[108:111], v[12:15], v[192:207]
  s_waitcnt vmcnt(21)
  s_waitcnt lgkmcnt(2)
  v_mfma_f32_32x32x16_bf16 v[64:79], a[112:115], v[24:27], v[64:79]
  ds_read_b128 v[16:19], v98 offset:14336
  v_mfma_f32_32x32x16_bf16 v[80:95], a[112:115], v[28:31], v[80:95]
  ds_read_b128 v[20:23], v102 offset:14336
  v_mfma_f32_32x32x16_bf16 v[192:207], a[112:115], v[12:15], v[192:207]
  s_waitcnt lgkmcnt(2)
  v_mfma_f32_32x32x16_bf16 v[64:79], a[116:119], v[32:35], v[64:79]
  ds_read_b128 v[24:27], v99 offset:14336
  v_mfma_f32_32x32x16_bf16 v[80:95], a[116:119], v[36:39], v[80:95]
  ds_read_b128 v[28:31], v103 offset:14336
  v_mfma_f32_32x32x16_bf16 v[192:207], a[116:119], v[12:15], v[192:207]
  s_waitcnt vmcnt(19)
  s_waitcnt lgkmcnt(2)
  v_mfma_f32_32x32x16_bf16 v[64:79], a[120:123], v[16:19], v[64:79]
  ds_read_b128 v[32:35], v96 offset:16384
  v_mfma_f32_32x32x16_bf16 v[80:95], a[120:123], v[20:23], v[80:95]
  ds_read_b128 v[36:39], v100 offset:16384
  v_mfma_f32_32x32x16_bf16 v[192:207], a[120:123], v[12:15], v[192:207]
  s_waitcnt lgkmcnt(2)
  v_mfma_f32_32x32x16_bf16 v[64:79], a[124:127], v[24:27], v[64:79]
  ds_read_b128 v[16:19], v97 offset:16384
  v_mfma_f32_32x32x16_bf16 v[80:95], a[124:127], v[28:31], v[80:95]
  ds_read_b128 v[20:23], v101 offset:16384
  v_mfma_f32_32x32x16_bf16 v[192:207], a[124:127], v[12:15], v[192:207]
  s_waitcnt vmcnt(17)
  s_waitcnt lgkmcnt(2)
  v_mfma_f32_32x32x16_bf16 v[64:79], a[128:131], v[32:35], v[64:79]
  ds_read_b128 v[24:27], v98 offset:16384
  v_mfma_f32_32x32x16_bf16 v[80:95], a[128:131], v[36:39], v[80:95]
  ds_read_b128 v[28:31], v102 offset:16384
  v_mfma_f32_32x32x16_bf16 v[192:207], a[128:131], v[12:15], v[192:207]
  s_waitcnt lgkmcnt(2)
  v_mfma_f32_32x32x16_bf16 v[64:79], a[132:135], v[16:19], v[64:79]
  ds_read_b128 v[32:35], v99 offset:16384
  v_mfma_f32_32x32x16_bf16 v[80:95], a[132:135], v[20:23], v[80:95]
  ds_read_b128 v[36:39], v103 offset:16384
  v_mfma_f32_32x32x16_bf16 v[192:207], a[132:135], v[12:15], v[192:207]
  s_waitcnt vmcnt(15)
  s_waitcnt lgkmcnt(2)
  v_mfma_f32_32x32x16_bf16 v[64:79], a[136:139], v[24:27], v[64:79]
  ds_read_b128 v[16:19], v96 offset:18432
  v_mfma_f32_32x32x16_bf16 v[80:95], a[136:139], v[28:31], v[80:95]
  ds_read_b128 v[20:23], v100 offset:18432
  v_mfma_f32_32x32x16_bf16 v[192:207], a[136:139], v[12:15], v[192:207]
  s_waitcnt lgkmcnt(2)
  v_mfma_f32_32x32x16_bf16 v[64:79], a[140:143], v[32:35], v[64:79]
  ds_read_b128 v[24:27], v97 offset:18432
  v_mfma_f32_32x32x16_bf16 v[80:95], a[140:143], v[36:39], v[80:95]
  ds_read_b128 v[28:31], v101 offset:18432
  v_mfma_f32_32x32x16_bf16 v[192:207], a[140:143], v[12:15], v[192:207]
  s_waitcnt vmcnt(13)
  s_waitcnt lgkmcnt(2)
  v_mfma_f32_32x32x16_bf16 v[64:79], a[144:147], v[16:19], v[64:79]
  ds_read_b128 v[32:35], v98 offset:18432
  v_mfma_f32_32x32x16_bf16 v[80:95], a[144:147], v[20:23], v[80:95]
  ds_read_b128 v[36:39], v102 offset:18432
  v_mfma_f32_32x32x16_bf16 v[192:207], a[144:147], v[12:15], v[192:207]
  s_waitcnt lgkmcnt(2)
  v_mfma_f32_32x32x16_bf16 v[64:79], a[148:151], v[24:27], v[64:79]
  ds_read_b128 v[16:19], v99 offset:18432
  v_mfma_f32_32x32x16_bf16 v[80:95], a[148:151], v[28:31], v[80:95]
  ds_read_b128 v[20:23], v103 offset:18432
  v_mfma_f32_32x32x16_bf16 v[192:207], a[148:151], v[12:15], v[192:207]
  s_waitcnt vmcnt(0)
  s_waitcnt lgkmcnt(2)
  v_mfma_f32_32x32x16_bf16 v[64:79], a[152:155], v[32:35], v[64:79]
  v_mfma_f32_32x32x16_bf16 v[80:95], a[152:155], v[36:39], v[80:95]
  v_mfma_f32_32x32x16_bf16 v[192:207], a[152:155], v[12:15], v[192:207]
  s_waitcnt lgkmcnt(0)
  v_mfma_f32_32x32x16_bf16 v[64:79], a[156:159], v[16:19], v[64:79]
  v_mfma_f32_32x32x16_bf16 v[80:95], a[156:159], v[20:23], v[80:95]
  v_mfma_f32_32x32x16_bf16 v[192:207], a[156:159], v[12:15], v[192:207]
  s_nop 11
  v_mov_b32 v208, v192
  v_mov_b32 v209, v193
  v_mov_b32 v210, v194
  v_mov_b32 v211, v195
  v_mov_b32 v212, v196
  v_mov_b32 v213, v197
  v_mov_b32 v214, v198
  v_mov_b32 v215, v199
  v_mov_b32 v216, v200
  v_mov_b32 v217, v201
  v_mov_b32 v218, v202
  v_mov_b32 v219, v203
  s_nop 1
  s_branch QP_go_43
QP_l1_42:
  s_cmp_eq_u32 s28, 1
  s_cbranch_scc1 QP_w1_62
  s_waitcnt vmcnt(12)
  s_mul_i32 s40, s37, 20480
  v_add_u32 v9, s40, v2
  v_mov_b32 v44, 0
  v_mov_b32 v45, 0
  ds_read_b128 v[64:67], v9 offset:0
  ds_read_b128 v[68:71], v9 offset:1024
  ds_read_b128 v[72:75], v9 offset:2048
  ds_read_b128 v[76:79], v9 offset:3072
  ds_read_b128 v[80:83], v9 offset:4096
  ds_read_b128 v[84:87], v9 offset:5120
  ds_read_b128 v[88:91], v9 offset:6144
  ds_read_b128 v[92:95], v9 offset:7168
  ds_read_b128 v[96:99], v9 offset:8192
  ds_read_b128 v[100:103], v9 offset:9216
  s_waitcnt lgkmcnt(9)
  v_dot2_f32_bf16 v44, v64, v7, v44
  v_dot2_f32_bf16 v45, v64, v64, v45
  v_dot2_f32_bf16 v44, v65, v7, v44
  v_dot2_f32_bf16 v45, v65, v65, v45
  v_dot2_f32_bf16 v44, v66, v7, v44
  v_dot2_f32_bf16 v45, v66, v66, v45
  v_dot2_f32_bf16 v44, v67, v7, v44
  v_dot2_f32_bf16 v45, v67, v67, v45
  ds_read_b128 v[64:67], v9 offset:10240
  s_waitcnt lgkmcnt(9)
  v_dot2_f32_bf16 v44, v68, v7, v44
  v_dot2_f32_bf16 v45, v68, v68, v45
  v_dot2_f32_bf16 v44, v69, v7, v44
  v_dot2_f32_bf16 v45, v69, v69, v45
  v_dot2_f32_bf16 v44, v70, v7, v44
  v_dot2_f32_bf16 v45, v70, v70, v45
  v_dot2_f32_bf16 v44, v71, v7, v44
  v_dot2_f32_bf16 v45, v71, v71, v45
  ds_read_b128 v[68:71], v9 offset:11264
  s_waitcnt lgkmcnt(9)
  v_dot2_f32_bf16 v44, v72, v7, v44
  v_dot2_f32_bf16 v45, v72, v72, v45
  v_dot2_f32_bf16 v44, v73, v7, v44
  v_dot2_f32_bf16 v45, v73, v73, v45
  v_dot2_f32_bf16 v44, v74, v7, v44
  v_dot2_f32_bf16 v45, v74, v74, v45
  v_dot2_f32_bf16 v44, v75, v7, v44
  v_dot2_f32_bf16 v45, v75, v75, v45
  ds_read_b128 v[72:75], v9 offset:12288
  s_waitcnt lgkmcnt(9)
  v_dot2_f32_bf16 v44, v76, v7, v44
  v_dot2_f32_bf16 v45, v76, v76, v45
  v_dot2_f32_bf16 v44, v77, v7, v44
  v_dot2_f32_bf16 v45, v77, v77, v45
  v_dot2_f32_bf16 v44, v78, v7, v44
  v_dot2_f32_bf16 v45, v78, v78, v45
  v_dot2_f32_bf16 v44, v79, v7, v44
  v_dot2_f32_bf16 v45, v79, v79, v45
  ds_read_b128 v[76:79], v9 offset:13312
  s_waitcnt lgkmcnt(9)
  v_dot2_f32_bf16 v44, v80, v7, v44
  v_dot2_f32_bf16 v45, v80, v80, v45
  v_dot2_f32_bf16 v44, v81, v7, v44
  v_dot2_f32_bf16 v45, v81, v81, v45
  v_dot2_f32_bf16 v44, v82, v7, v44
  v_dot2_f32_bf16 v45, v82, v82, v45
  v_dot2_f32_bf16 v44, v83, v7, v44
  v_dot2_f32_bf16 v45, v83, v83, v45
  ds_read_b128 v[80:83], v9 offset:14336
  s_waitcnt lgkmcnt(9)
  v_dot2_f32_bf16 v44, v84, v7, v44
  v_dot2_f32_bf16 v45, v84, v84, v45
  v_dot2_f32_bf16 v44, v85, v7, v44
  v_dot2_f32_bf16 v45, v85, v85, v45
  v_dot2_f32_bf16 v44, v86, v7, v44
  v_dot2_f32_bf16 v45, v86, v86, v45
  v_dot2_f32_bf16 v44, v87, v7, v44
  v_dot2_f32_bf16 v45, v87, v87, v45
  ds_read_b128 v[84:87], v9 offset:15360
  s_waitcnt lgkmcnt(9)
  v_dot2_f32_bf16 v44, v88, v7, v44
  v_dot2_f32_bf16 v45, v88, v88, v45
  v_dot2_f32_bf16 v44, v89, v7, v44
  v_dot2_f32_bf16 v45, v89, v89, v45
  v_dot2_f32_bf16 v44, v90, v7, v44
  v_dot2_f32_bf16 v45, v90, v90, v45
  v_dot2_f32_bf16 v44, v91, v7, v44
  v_dot2_f32_bf16 v45, v91, v91, v45
  ds_read_b128 v[88:91], v9 offset:16384
  s_waitcnt lgkmcnt(9)
  v_dot2_f32_bf16 v44, v92, v7, v44
  v_dot2_f32_bf16 v45, v92, v92, v45
  v_dot2_f32_bf16 v44, v93, v7, v44
  v_dot2_f32_bf16 v45, v93, v93, v45
  v_dot2_f32_bf16 v44, v94, v7, v44
  v_dot2_f32_bf16 v45, v94, v94, v45
  v_dot2_f32_bf16 v44, v95, v7, v44
  v_dot2_f32_bf16 v45, v95, v95, v45
  ds_read_b128 v[92:95], v9 offset:17408
  s_waitcnt lgkmcnt(9)
  v_dot2_f32_bf16 v44, v96, v7, v44
  v_dot2_f32_bf16 v45, v96, v96, v45
  v_dot2_f32_bf16 v44, v97, v7, v44
  v_dot2_f32_bf16 v45, v97, v97, v45
  v_dot2_f32_bf16 v44, v98, v7, v44
  v_dot2_f32_bf16 v45, v98, v98, v45
  v_dot2_f32_bf16 v44, v99, v7, v44
  v_dot2_f32_bf16 v45, v99, v99, v45
  ds_read_b128 v[96:99], v9 offset:18432
  s_waitcnt lgkmcnt(9)
  v_dot2_f32_bf16 v44, v100, v7, v44
  v_dot2_f32_bf16 v45, v100, v100, v45
  v_dot2_f32_bf16 v44, v101, v7, v44
  v_dot2_f32_bf16 v45, v101, v101, v45
  v_dot2_f32_bf16 v44, v102, v7, v44
  v_dot2_f32_bf16 v45, v102, v102, v45
  v_dot2_f32_bf16 v44, v103, v7, v44
  v_dot2_f32_bf16 v45, v103, v103, v45
  ds_read_b128 v[100:103], v9 offset:19456
  s_waitcnt lgkmcnt(9)
  v_dot2_f32_bf16 v44, v64, v7, v44
  v_dot2_f32_bf16 v45, v64, v64, v45
  v_dot2_f32_bf16 v44, v65, v7, v44
  v_dot2_f32_bf16 v45, v65, v65, v45
  v_dot2_f32_bf16 v44, v66, v7, v44
  v_dot2_f32_bf16 v45, v66, v66, v45
  v_dot2_f32_bf16 v44, v67, v7, v44
  v_dot2_f32_bf16 v45, v67, v67, v45
  s_waitcnt lgkmcnt(8)
  v_dot2_f32_bf16 v44, v68, v7, v44
  v_dot2_f32_bf16 v45, v68, v68, v45
  v_dot2_f32_bf16 v44, v69, v7, v44
  v_dot2_f32_bf16 v45, v69, v69, v45
  v_dot2_f32_bf16 v44, v70, v7, v44
  v_dot2_f32_bf16 v45, v70, v70, v45
  v_dot2_f32_bf16 v44, v71, v7, v44
  v_dot2_f32_bf16 v45, v71, v71, v45
  s_waitcnt lgkmcnt(7)
  v_dot2_f32_bf16 v44, v72, v7, v44
  v_dot2_f32_bf16 v45, v72, v72, v45
  v_dot2_f32_bf16 v44, v73, v7, v44
  v_dot2_f32_bf16 v45, v73, v73, v45
  v_dot2_f32_bf16 v44, v74, v7, v44
  v_dot2_f32_bf16 v45, v74, v74, v45
  v_dot2_f32_bf16 v44, v75, v7, v44
  v_dot2_f32_bf16 v45, v75, v75, v45
  s_waitcnt lgkmcnt(6)
  v_dot2_f32_bf16 v44, v76, v7, v44
  v_dot2_f32_bf16 v45, v76, v76, v45
  v_dot2_f32_bf16 v44, v77, v7, v44
  v_dot2_f32_bf16 v45, v77, v77, v45
  v_dot2_f32_bf16 v44, v78, v7, v44
  v_dot2_f32_bf16 v45, v78, v78, v45
  v_dot2_f32_bf16 v44, v79, v7, v44
  v_dot2_f32_bf16 v45, v79, v79, v45
  s_waitcnt lgkmcnt(5)
  v_dot2_f32_bf16 v44, v80, v7, v44
  v_dot2_f32_bf16 v45, v80, v80, v45
  v_dot2_f32_bf16 v44, v81, v7, v44
  v_dot2_f32_bf16 v45, v81, v81, v45
  v_dot2_f32_bf16 v44, v82, v7, v44
  v_dot2_f32_bf16 v45, v82, v82, v45
  v_dot2_f32_bf16 v44, v83, v7, v44
  v_dot2_f32_bf16 v45, v83, v83, v45
  s_waitcnt lgkmcnt(4)
  v_dot2_f32_bf16 v44, v84, v7, v44
  v_dot2_f32_bf16 v45, v84, v84, v45
  v_dot2_f32_bf16 v44, v85, v7, v44
  v_dot2_f32_bf16 v45, v85, v85, v45
  v_dot2_f32_bf16 v44, v86, v7, v44
  v_dot2_f32_bf16 v45, v86, v86, v45
  v_dot2_f32_bf16 v44, v87, v7, v44
  v_dot2_f32_bf16 v45, v87, v87, v45
  s_waitcnt lgkmcnt(3)
  v_dot2_f32_bf16 v44, v88, v7, v44
  v_dot2_f32_bf16 v45, v88, v88, v45
  v_dot2_f32_bf16 v44, v89, v7, v44
  v_dot2_f32_bf16 v45, v89, v89, v45
  v_dot2_f32_bf16 v44, v90, v7, v44
  v_dot2_f32_bf16 v45, v90, v90, v45
  v_dot2_f32_bf16 v44, v91, v7, v44
  v_dot2_f32_bf16 v45, v91, v91, v45
  s_waitcnt lgkmcnt(2)
  v_dot2_f32_bf16 v44, v92, v7, v44
  v_dot2_f32_bf16 v45, v92, v92, v45
  v_dot2_f32_bf16 v44, v93, v7, v44
  v_dot2_f32_bf16 v45, v93, v93, v45
  v_dot2_f32_bf16 v44, v94, v7, v44
  v_dot2_f32_bf16 v45, v94, v94, v45
  v_dot2_f32_bf16 v44, v95, v7, v44
  v_dot2_f32_bf16 v45, v95, v95, v45
  s_waitcnt lgkmcnt(1)
  v_dot2_f32_bf16 v44, v96, v7, v44
  v_dot2_f32_bf16 v45, v96, v96, v45
  v_dot2_f32_bf16 v44, v97, v7, v44
  v_dot2_f32_bf16 v45, v97, v97, v45
  v_dot2_f32_bf16 v44, v98, v7, v44
  v_dot2_f32_bf16 v45, v98, v98, v45
  v_dot2_f32_bf16 v44, v99, v7, v44
  v_dot2_f32_bf16 v45, v99, v99, v45
  s_waitcnt lgkmcnt(0)
  v_dot2_f32_bf16 v44, v100, v7, v44
  v_dot2_f32_bf16 v45, v100, v100, v45
  v_dot2_f32_bf16 v44, v101, v7, v44
  v_dot2_f32_bf16 v45, v101, v101, v45
  v_dot2_f32_bf16 v44, v102, v7, v44
  v_dot2_f32_bf16 v45, v102, v102, v45
  v_dot2_f32_bf16 v44, v103, v7, v44
  v_dot2_f32_bf16 v45, v103, v103, v45
  s_nop 1
  v_mov_b32 v46, v44
  s_nop 1
  v_permlane16_swap_b32 v44, v46
  v_add_f32 v44, v44, v46
  v_mov_b32 v46, v44
  s_nop 1
  v_permlane32_swap_b32 v44, v46
  v_add_f32 v44, v44, v46
  v_mov_b32 v47, v45
  s_nop 1
  v_permlane16_swap_b32 v45, v47
  v_add_f32 v45, v45, v47
  v_mov_b32 v47, v45
  s_nop 1
  v_permlane32_swap_b32 v45, v47
  v_add_f32 v45, v45, v47
  v_mul_f32 v44, 0x3acccccd, v44
  v_mul_f32 v45, 0x3acccccd, v45
  v_fma_f32 v45, -v44, v44, v45
  v_max_f32 v45, 0, v45
  v_add_f32 v45, 0x3727c5ac, v45
  v_rsq_f32 v46, v45
  s_nop 0
  v_mul_f32 v47, v44, v46
  v_sub_f32 v47, 0, v47
  s_add_u32 s40, s50, s37
  s_and_b32 s40, s40, 3
  s_lshl_b32 s40, s40, 7
  s_add_u32 s40, s40, 160384
  v_lshlrev_b32 v10, 3, v3
  v_add_u32 v10, s40, v10
  s_mov_b64 exec, 0xffff
  ds_write_b64 v10, v[46:47]
  s_mov_b64 exec, -1
  s_waitcnt lgkmcnt(0)
  s_branch QP_w2_63
QP_w1_62:
  s_waitcnt vmcnt(0)
  s_cmp_eq_u32 s28, 1
  s_cbranch_scc0 KVF_64
  s_lshl_b32 s40, s31, 2
  s_add_u32 s40, s40, 4096
  s_add_u32 s43, s32, 1
  v_mov_b32 v11, 0
  v_mov_b32 v12, s43
  s_mov_b64 exec, 1
  buffer_store_dword v12, v11, s[8:11], s40 offen sc1
  s_mov_b64 exec, -1
KVF_64:
QP_w2_63:
  s_waitcnt lgkmcnt(0)
  s_barrier
  v_lshrrev_b32 v9, 4, v1
  v_and_b32 v9, 1, v9
  v_lshrrev_b32 v12, 5, v1
  v_lshlrev_b32 v12, 4, v12
  v_add_u32 v12, v12, v3
  v_lshlrev_b32 v12, 4, v12
  s_sub_u32 s40, 4, s50
  v_add_u32 v11, s40, v9
  v_add_u32 v11, 2, v11
  v_and_b32 v11, 3, v11
  v_mul_u32_u24 v11, 20480, v11
  v_add_u32 v10, v11, v12
  v_add_u32 v11, s40, v9
  v_add_u32 v11, 0, v11
  v_and_b32 v11, 3, v11
  v_mul_u32_u24 v11, 20480, v11
  v_add_u32 v9, v11, v12
  ds_read_b128 v[16:19], v9 offset:0
  ds_read_b128 v[20:23], v10 offset:0
  ds_read_b128 v[24:27], v9 offset:512
  ds_read_b128 v[28:31], v10 offset:512
  s_waitcnt vmcnt(10)
  s_waitcnt lgkmcnt(2)
  v_mfma_f32_32x32x16_bf16 v[64:79], a[0:3], v[16:19], 0
  ds_read_b128 v[32:35], v9 offset:1024
  v_add_u32 v224, 102400, v2
  v_lshlrev_b32 v225, 3, v1
  v_add_u32 v225, 104768, v225
  v_lshrrev_b32 v40, 5, v1
  v_mfma_f32_32x32x16_bf16 v[80:95], a[0:3], v[20:23], 0
  ds_read_b128 v[36:39], v10 offset:1024
  s_add_u32 s58, s58, 4096
  buffer_load_dwordx4 a[48:51], v119, s[8:11], s58 offen offset:0 sc1
  v_mul_u32_u24 v40, 21, v40
  v_and_b32 v41, 31, v1
  v_add_u32 v40, v40, v41
  v_lshlrev_b32 v40, 4, v40
  s_waitcnt lgkmcnt(2)
  v_mfma_f32_32x32x16_bf16 v[64:79], a[4:7], v[24:27], v[64:79]
  ds_read_b128 v[16:19], v9 offset:1536
  v_add_u32 v226, 103424, v40
  v_add_u32 v253, 104096, v40
  v_mov_b32 v40, 105280
  v_cmp_lt_u32 vcc, 20, v41
  s_nop 1
  v_cndmask_b32 v226, v226, v40, vcc
  v_cndmask_b32 v253, v253, v40, vcc
  v_mfma_f32_32x32x16_bf16 v[80:95], a[4:7], v[28:31], v[80:95]
  ds_read_b128 v[20:23], v10 offset:1536
  buffer_load_dwordx4 a[52:55], v119, s[8:11], s58 offen offset:1024 sc1
  v_mov_b32 v144, 0
  v_mov_b32 v160, 0
  v_mov_b32 v145, 0
  v_mov_b32 v161, 0
  s_waitcnt vmcnt(10)
  s_waitcnt lgkmcnt(2)
  v_mfma_f32_32x32x16_bf16 v[64:79], a[8:11], v[32:35], v[64:79]
  ds_read_b128 v[24:27], v9 offset:2048
  v_mov_b32 v146, 0
  v_mov_b32 v162, 0
  v_mov_b32 v147, 0
  v_mov_b32 v163, 0
  v_mfma_f32_32x32x16_bf16 v[80:95], a[8:11], v[36:39], v[80:95]
  ds_read_b128 v[28:31], v10 offset:2048
  buffer_load_dwordx4 a[56:59], v119, s[8:11], s58 offen offset:2048 sc1
  v_mov_b32 v148, 0
  v_mov_b32 v164, 0
  v_mov_b32 v149, 0
  v_mov_b32 v165, 0
  s_waitcnt lgkmcnt(2)
  v_mfma_f32_32x32x16_bf16 v[64:79], a[12:15], v[16:19], v[64:79]
  ds_read_b128 v[32:35], v9 offset:2560
  v_mov_b32 v150, 0
  v_mov_b32 v166, 0
  v_mov_b32 v151, 0
  v_mov_b32 v167, 0
  v_mfma_f32_32x32x16_bf16 v[80:95], a[12:15], v[20:23], v[80:95]
  ds_read_b128 v[36:39], v10 offset:2560
  buffer_load_dwordx4 a[60:63], v119, s[8:11], s58 offen offset:3072 sc1
  v_mov_b32 v152, 0
  v_mov_b32 v168, 0
  v_mov_b32 v153, 0
  v_mov_b32 v169, 0
  s_waitcnt vmcnt(10)
  s_waitcnt lgkmcnt(2)
  v_mfma_f32_32x32x16_bf16 v[64:79], a[16:19], v[24:27], v[64:79]
  ds_read_b128 v[16:19], v9 offset:3072
  v_mov_b32 v154, 0
  v_mov_b32 v170, 0
  v_mov_b32 v155, 0
  v_mov_b32 v171, 0
  v_mfma_f32_32x32x16_bf16 v[80:95], a[16:19], v[28:31], v[80:95]
  ds_read_b128 v[20:23], v10 offset:3072
  s_add_u32 s58, s58, 4096
  buffer_load_dwordx4 a[64:67], v119, s[8:11], s58 offen offset:0 sc1
  v_mov_b32 v156, 0
  v_mov_b32 v172, 0
  v_mov_b32 v157, 0
  v_mov_b32 v173, 0
  s_waitcnt lgkmcnt(2)
  v_mfma_f32_32x32x16_bf16 v[64:79], a[20:23], v[32:35], v[64:79]
  ds_read_b128 v[24:27], v9 offset:3584
  v_mov_b32 v158, 0
  v_mov_b32 v174, 0
  v_mov_b32 v159, 0
  v_mov_b32 v175, 0
  v_mfma_f32_32x32x16_bf16 v[80:95], a[20:23], v[36:39], v[80:95]
  ds_read_b128 v[28:31], v10 offset:3584
  buffer_load_dwordx4 a[68:71], v119, s[8:11], s58 offen offset:1024 sc1
  v_mov_b32 v136, 0
  v_mov_b32 v137, 0
  v_mov_b32 v138, 0
  v_mov_b32 v139, 0
  s_waitcnt vmcnt(10)
  s_waitcnt lgkmcnt(2)
  v_mfma_f32_32x32x16_bf16 v[64:79], a[24:27], v[16:19], v[64:79]
  ds_read_b128 v[32:35], v9 offset:4096
  v_mov_b32 v140, 0
  v_mov_b32 v141, 0
  v_mov_b32 v142, 0
  v_mov_b32 v143, 0
  v_mfma_f32_32x32x16_bf16 v[80:95], a[24:27], v[20:23], v[80:95]
  ds_read_b128 v[36:39], v10 offset:4096
  buffer_load_dwordx4 a[72:75], v119, s[8:11], s58 offen offset:2048 sc1
  v_mov_b32 v220, 0
  v_mov_b32 v221, 0
  v_mov_b32 v222, 0
  v_mov_b32 v223, 0
  s_waitcnt lgkmcnt(2)
  v_mfma_f32_32x32x16_bf16 v[64:79], a[28:31], v[24:27], v[64:79]
  ds_read_b128 v[16:19], v9 offset:4608
  s_mul_i32 s59, s30, 102400
  s_mul_i32 s60, s28, 25600
  s_add_u32 s59, s59, s60
  s_add_u32 s59, s59, 122880
  v_mfma_f32_32x32x16_bf16 v[80:95], a[28:31], v[28:31], v[80:95]
  ds_read_b128 v[20:23], v10 offset:4608
  buffer_load_dwordx4 a[76:79], v119, s[8:11], s58 offen offset:3072 sc1
  s_lshl_b32 s61, s30, 2
  s_add_u32 s61, s61, s28
  s_mul_i32 s61, s61, 61440
  s_add_u32 s61, s61, 2908160
  s_waitcnt vmcnt(10)
  s_waitcnt lgkmcnt(2)
  v_mfma_f32_32x32x16_bf16 v[64:79], a[32:35], v[32:35], v[64:79]
  ds_read_b128 v[24:27], v9 offset:5120
  s_mul_i32 s40, s30, 12
  s_lshl_b32 s41, s28, 1
  s_add_u32 s66, s40, s41
  s_lshl_b32 s66, s66, 6
  v_mfma_f32_32x32x16_bf16 v[80:95], a[32:35], v[36:39], v[80:95]
  ds_read_b128 v[28:31], v10 offset:5120
  s_add_u32 s58, s58, 4096
  buffer_load_dwordx4 a[80:83], v119, s[8:11], s58 offen offset:0 sc1
  s_add_u32 s66, s66, 6291456
  s_add_u32 s67, s40, s28
  s_add_u32 s67, s67, 8
  s_lshl_b32 s67, s67, 6
  s_waitcnt lgkmcnt(2)
  v_mfma_f32_32x32x16_bf16 v[64:79], a[36:39], v[16:19], v[64:79]
  ds_read_b128 v[32:35], v9 offset:5632
  s_add_u32 s67, s67, 6291456
  v_lshlrev_b32 v252, 4, v4
  s_cmp_eq_u32 s32, 0
  s_mov_b32 s88, 6324224
  s_cselect_b32 s88, s88, 8945664
  v_mfma_f32_32x32x16_bf16 v[80:95], a[36:39], v[20:23], v[80:95]
  ds_read_b128 v[36:39], v10 offset:5632
  buffer_load_dwordx4 a[84:87], v119, s[8:11], s58 offen offset:1024 sc1
  s_lshl_b32 s40, s29, 3
  s_add_u32 s40, s40, s30
  s_lshl_b32 s40, s40, 2
  s_add_u32 s40, s40, s28
  s_waitcnt vmcnt(10)
  s_waitcnt lgkmcnt(2)
  v_mfma_f32_32x32x16_bf16 v[64:79], a[40:43], v[24:27], v[64:79]
  ds_read_b128 v[16:19], v9 offset:6144
  s_mul_i32 s40, s40, 2560
  s_add_u32 s88, s88, s40
  v_min_u32 v56, 19, v1
  v_lshlrev_b32 v56, 7, v56
  v_mfma_f32_32x32x16_bf16 v[80:95], a[40:43], v[28:31], v[80:95]
  ds_read_b128 v[20:23], v10 offset:6144
  buffer_load_dwordx4 a[88:91], v119, s[8:11], s58 offen offset:2048 sc1
  s_cmp_eq_u32 s32, 0
  s_mov_b32 s89, 11567104
  s_cselect_b32 s89, s89, 14188544
  s_lshl_b32 s40, s29, 3
  s_waitcnt lgkmcnt(2)
  v_mfma_f32_32x32x16_bf16 v[64:79], a[44:47], v[32:35], v[64:79]
  ds_read_b128 v[24:27], v9 offset:6656
  s_add_u32 s40, s40, s30
  s_lshl_b32 s40, s40, 2
  s_add_u32 s40, s40, s28
  s_mul_i32 s40, s40, 2560
  v_mfma_f32_32x32x16_bf16 v[80:95], a[44:47], v[36:39], v[80:95]
  ds_read_b128 v[28:31], v10 offset:6656
  buffer_load_dwordx4 a[92:95], v119, s[8:11], s58 offen offset:3072 sc1
  s_add_u32 s89, s89, s40
  v_min_u32 v57, 19, v1
  v_lshlrev_b32 v57, 7, v57
  s_cmp_eq_u32 s32, 0
  s_mov_b32 s74, 19431424
  s_cselect_b32 s74, s74, 25722880
  s_waitcnt vmcnt(10)
  s_waitcnt lgkmcnt(2)
  v_mfma_f32_32x32x16_bf16 v[64:79], a[48:51], v[16:19], v[64:79]
  ds_read_b128 v[32:35], v9 offset:7168
  s_lshl_b32 s40, s29, 3
  s_add_u32 s40, s40, s30
  s_lshl_b32 s40, s40, 2
  s_add_u32 s40, s40, s28
  v_mfma_f32_32x32x16_bf16 v[80:95], a[48:51], v[20:23], v[80:95]
  ds_read_b128 v[36:39], v10 offset:7168
  s_add_u32 s58, s58, 4096
  buffer_load_dwordx4 a[96:99], v119, s[8:11], s58 offen offset:0 sc1
  s_mul_i32 s40, s40, 6144
  s_add_u32 s74, s74, s40
  v_min_u32 v58, 47, v1
  v_lshlrev_b32 v58, 7, v58
  s_waitcnt lgkmcnt(2)
  v_mfma_f32_32x32x16_bf16 v[64:79], a[52:55], v[24:27], v[64:79]
  ds_read_b128 v[16:19], v9 offset:7680
  s_and_b32 s40, s29, 3
  s_lshl_b32 s40, s40, 2
  s_add_u32 s40, s40, s28
  s_mul_i32 s40, s40, 10624
  v_mfma_f32_32x32x16_bf16 v[80:95], a[52:55], v[28:31], v[80:95]
  ds_read_b128 v[20:23], v10 offset:7680
  buffer_load_dwordx4 a[100:103], v119, s[8:11], s58 offen offset:1024 sc1
  s_mul_i32 s75, s30, 245760
  s_add_u32 s75, s75, s40
  s_add_u32 s75, s75, 1018880
  v_add_u32 v59, 0, v1
  s_waitcnt vmcnt(10)
  s_waitcnt lgkmcnt(2)
  v_mfma_f32_32x32x16_bf16 v[64:79], a[56:59], v[32:35], v[64:79]
  ds_read_b128 v[24:27], v9 offset:8192
  v_min_u32 v59, 82, v59
  v_lshlrev_b32 v59, 7, v59
  v_add_u32 v60, 64, v1
  v_min_u32 v60, 82, v60
  v_mfma_f32_32x32x16_bf16 v[80:95], a[56:59], v[36:39], v[80:95]
  ds_read_b128 v[28:31], v10 offset:8192
  buffer_load_dwordx4 a[104:107], v119, s[8:11], s58 offen offset:2048 sc1
  v_lshlrev_b32 v60, 7, v60
  s_cmp_eq_u32 s32, 0
  s_mov_b32 s77, 6324224
  s_cselect_b32 s77, s77, 8945664
  s_waitcnt lgkmcnt(2)
  v_mfma_f32_32x32x16_bf16 v[64:79], a[60:63], v[16:19], v[64:79]
  ds_read_b128 v[32:35], v9 offset:8704
  s_add_u32 s78, s77, 40960
  s_mul_i32 s41, s30, 80
  s_mul_i32 s40, s28, 20
  s_add_u32 s41, s41, s40
  v_mfma_f32_32x32x16_bf16 v[80:95], a[60:63], v[20:23], v[80:95]
  ds_read_b128 v[36:39], v10 offset:8704
  buffer_load_dwordx4 a[108:111], v119, s[8:11], s58 offen offset:3072 sc1
  v_lshrrev_b32 v40, 5, v1
  v_lshlrev_b32 v40, 2, v40
  v_add_u32 v40, s41, v40
  v_lshrrev_b32 v41, 4, v1
  s_waitcnt vmcnt(10)
  s_waitcnt lgkmcnt(2)
  v_mfma_f32_32x32x16_bf16 v[64:79], a[64:67], v[24:27], v[64:79]
  ds_read_b128 v[16:19], v9 offset:9216
  v_and_b32 v41, 1, v41
  s_lshl_b32 s40, s29, 2
  v_add_u32 v41, s40, v41
  v_mul_u32_u24 v41, 20480, v41
  v_mfma_f32_32x32x16_bf16 v[80:95], a[64:67], v[28:31], v[80:95]
  ds_read_b128 v[20:23], v10 offset:9216
  s_add_u32 s58, s58, 4096
  buffer_load_dwordx4 a[112:115], v119, s[8:11], s58 offen offset:0 sc1
  v_lshlrev_b32 v42, 4, v3
  v_add_u32 v41, v41, v42
  v_add_u32 v42, 0, v40
  v_lshrrev_b32 v43, 5, v42
  s_waitcnt lgkmcnt(2)
  v_mfma_f32_32x32x16_bf16 v[64:79], a[68:71], v[32:35], v[64:79]
  ds_read_b128 v[24:27], v9 offset:9728
  v_lshlrev_b32 v43, 10, v43
  v_add_u32 v61, v41, v43
  v_bfe_u32 v43, v42, 3, 2
  v_lshlrev_b32 v43, 8, v43
  v_mfma_f32_32x32x16_bf16 v[80:95], a[68:71], v[36:39], v[80:95]
  ds_read_b128 v[28:31], v10 offset:9728
  buffer_load_dwordx4 a[116:119], v119, s[8:11], s58 offen offset:1024 sc1
  v_add_u32 v61, v61, v43
  v_bfe_u32 v43, v42, 2, 1
  v_lshlrev_b32 v43, 3, v43
  v_add_u32 v61, v61, v43
  s_waitcnt vmcnt(10)
  s_waitcnt lgkmcnt(2)
  v_mfma_f32_32x32x16_bf16 v[64:79], a[72:75], v[16:19], v[64:79]
  ds_read_b128 v[32:35], v9 offset:10240
  v_add_u32 v42, 8, v40
  v_lshrrev_b32 v43, 5, v42
  v_lshlrev_b32 v43, 10, v43
  v_add_u32 v62, v41, v43
  v_mfma_f32_32x32x16_bf16 v[80:95], a[72:75], v[20:23], v[80:95]
  ds_read_b128 v[36:39], v10 offset:10240
  buffer_load_dwordx4 a[120:123], v119, s[8:11], s58 offen offset:2048 sc1
  v_bfe_u32 v43, v42, 3, 2
  v_lshlrev_b32 v43, 8, v43
  v_add_u32 v62, v62, v43
  v_bfe_u32 v43, v42, 2, 1
  s_waitcnt lgkmcnt(2)
  v_mfma_f32_32x32x16_bf16 v[64:79], a[76:79], v[24:27], v[64:79]
  ds_read_b128 v[16:19], v9 offset:10752
  v_lshlrev_b32 v43, 3, v43
  v_add_u32 v62, v62, v43
  v_add_u32 v42, 16, v40
  v_lshrrev_b32 v43, 5, v42
  v_mfma_f32_32x32x16_bf16 v[80:95], a[76:79], v[28:31], v[80:95]
  ds_read_b128 v[20:23], v10 offset:10752
  buffer_load_dwordx4 a[124:127], v119, s[8:11], s58 offen offset:3072 sc1
  v_lshlrev_b32 v43, 10, v43
  v_add_u32 v63, v41, v43
  v_bfe_u32 v43, v42, 3, 2
  v_lshlrev_b32 v43, 8, v43
  s_cmp_eq_u32 s28, 0
  s_nop 4
  s_cbranch_scc0 KVL_65
  s_mov_b32 s40, 4096
  buffer_load_dwordx4 v[44:47], v2, s[8:11], s40 offen sc1
KVL_65:
  s_waitcnt vmcnt(10)
  s_waitcnt lgkmcnt(2)
  v_mfma_f32_32x32x16_bf16 v[64:79], a[80:83], v[32:35], v[64:79]
  ds_read_b128 v[24:27], v9 offset:11264
  v_add_u32 v63, v63, v43
  v_bfe_u32 v43, v42, 2, 1
  v_lshlrev_b32 v43, 3, v43
  v_add_u32 v63, v63, v43
  v_mfma_f32_32x32x16_bf16 v[80:95], a[80:83], v[36:39], v[80:95]
  ds_read_b128 v[28:31], v10 offset:11264
  s_add_u32 s58, s58, 4096
  buffer_load_dwordx4 a[128:131], v119, s[8:11], s58 offen offset:0 sc1
  s_waitcnt lgkmcnt(2)
  v_mfma_f32_32x32x16_bf16 v[64:79], a[84:87], v[16:19], v[64:79]
  ds_read_b128 v[32:35], v9 offset:11776
  v_mfma_f32_32x32x16_bf16 v[80:95], a[84:87], v[20:23], v[80:95]
  ds_read_b128 v[36:39], v10 offset:11776
  buffer_load_dwordx4 a[132:135], v119, s[8:11], s58 offen offset:1024 sc1
  s_waitcnt vmcnt(10)
  s_waitcnt lgkmcnt(2)
  v_mfma_f32_32x32x16_bf16 v[64:79], a[88:91], v[24:27], v[64:79]
  ds_read_b128 v[16:19], v9 offset:12288
  v_mfma_f32_32x32x16_bf16 v[80:95], a[88:91], v[28:31], v[80:95]
  ds_read_b128 v[20:23], v10 offset:12288
  buffer_load_dwordx4 a[136:139], v119, s[8:11], s58 offen offset:2048 sc1
  s_waitcnt lgkmcnt(2)
  v_mfma_f32_32x32x16_bf16 v[64:79], a[92:95], v[32:35], v[64:79]
  ds_read_b128 v[24:27], v9 offset:12800
  v_mfma_f32_32x32x16_bf16 v[80:95], a[92:95], v[36:39], v[80:95]
  ds_read_b128 v[28:31], v10 offset:12800
  buffer_load_dwordx4 a[140:143], v119, s[8:11], s58 offen offset:3072 sc1
  s_waitcnt vmcnt(10)
  s_waitcnt lgkmcnt(2)
  v_mfma_f32_32x32x16_bf16 v[64:79], a[96:99], v[16:19], v[64:79]
  ds_read_b128 v[32:35], v9 offset:13312
  v_mfma_f32_32x32x16_bf16 v[80:95], a[96:99], v[20:23], v[80:95]
  ds_read_b128 v[36:39], v10 offset:13312
  s_add_u32 s58, s58, 4096
  buffer_load_dwordx4 a[144:147], v119, s[8:11], s58 offen offset:0 sc1
  s_waitcnt lgkmcnt(2)
  v_mfma_f32_32x32x16_bf16 v[64:79], a[100:103], v[24:27], v[64:79]
  ds_read_b128 v[16:19], v9 offset:13824
  v_mfma_f32_32x32x16_bf16 v[80:95], a[100:103], v[28:31], v[80:95]
  ds_read_b128 v[20:23], v10 offset:13824
  buffer_load_dwordx4 a[148:151], v119, s[8:11], s58 offen offset:1024 sc1
  s_cmp_eq_u32 s28, 0
  s_nop 8
  s_cbranch_scc0 KVW_66
  s_add_u32 s43, s32, 1
  s_waitcnt vmcnt(6)
  v_min_u32 v44, v44, v45
  v_min_u32 v46, v46, v47
  v_min_u32 v44, v44, v46
  v_cmp_gt_u32 vcc, s43, v44
  s_cmp_eq_u64 vcc, 0
  s_nop 3
  s_cbranch_scc1 KVW_66
  s_add_u32 s43, s32, 1
  s_mov_b32 s40, 4096
  s_mov_b32 s42, 400000
KVP_67:
  buffer_load_dwordx4 v[44:47], v2, s[8:11], s40 offen sc1
  s_waitcnt vmcnt(0)
  v_min_u32 v44, v44, v45
  v_min_u32 v46, v46, v47
  v_min_u32 v44, v44, v46
  v_cmp_gt_u32 vcc, s43, v44
  s_cmp_eq_u64 vcc, 0
  s_nop 3
  s_cbranch_scc1 KVP_done_68
  s_sleep 1
  s_sub_u32 s42, s42, 1
  s_cmp_lg_u32 s42, 0
  s_cbranch_scc1 KVP_67
KVP_done_68:
KVW_66:
  s_barrier
  s_cmp_eq_u32 s32, 0
  s_mov_b32 s53, 34111488
  s_cselect_b32 s53, s53, 34308096
  s_mul_i32 s54, s28, 3072
  s_add_u32 s55, s53, s54
  s_add_u32 m0, s54, 102400
  s_nop 0
  buffer_load_dwordx4 v2, s[8:11], s55 offen offset:0 sc1 lds
  buffer_load_dwordx4 v2, s[8:11], s55 offen offset:1024 sc1 lds
  buffer_load_dwordx4 v2, s[8:11], s55 offen offset:2048 sc1 lds
  s_add_u32 s55, s55, 12288
  s_add_u32 m0, s54, 114688
  s_nop 0
  buffer_load_dwordx4 v2, s[8:11], s55 offen offset:0 sc1 lds
  buffer_load_dwordx4 v2, s[8:11], s55 offen offset:1024 sc1 lds
  buffer_load_dwordx4 v2, s[8:11], s55 offen offset:2048 sc1 lds
  s_add_u32 s55, s55, 12288
  s_add_u32 m0, s54, 126976
  s_nop 0
  buffer_load_dwordx4 v2, s[8:11], s55 offen offset:0 sc1 lds
  buffer_load_dwordx4 v2, s[8:11], s55 offen offset:1024 sc1 lds
  buffer_load_dwordx4 v2, s[8:11], s55 offen offset:2048 sc1 lds
  s_add_u32 s55, s55, 12288
  s_cmp_eq_u32 s32, 0
  s_mov_b32 s45, 34504704
  s_cselect_b32 s45, s45, 34508800
  v_lshlrev_b32 v48, 3, v1
  s_lshl_b32 s40, s29, 5
  s_add_u32 s40, s40, 8192
  v_and_b32 v49, 7, v1
  v_lshlrev_b32 v49, 2, v49
  buffer_load_dword v227, v49, s[8:11], s40 offen sc1
  buffer_load_dwordx2 v[50:51], v48, s[8:11], s45 offen sc1
  s_waitcnt vmcnt(21)
  s_waitcnt lgkmcnt(2)
  v_mfma_f32_32x32x16_bf16 v[64:79], a[104:107], v[32:35], v[64:79]
  ds_read_b128 v[24:27], v9 offset:14336
  v_mfma_f32_32x32x16_bf16 v[80:95], a[104:107], v[36:39], v[80:95]
  ds_read_b128 v[28:31], v10 offset:14336
  buffer_load_dwordx4 a[152:155], v119, s[8:11], s58 offen offset:2048 sc1
  s_waitcnt lgkmcnt(2)
  v_mfma_f32_32x32x16_bf16 v[64:79], a[108:111], v[16:19], v[64:79]
  ds_read_b128 v[32:35], v9 offset:14848
  v_mfma_f32_32x32x16_bf16 v[80:95], a[108:111], v[20:23], v[80:95]
  ds_read_b128 v[36:39], v10 offset:14848
  buffer_load_dwordx4 a[156:159], v119, s[8:11], s58 offen offset:3072 sc1
  s_waitcnt vmcnt(21)
  s_waitcnt lgkmcnt(2)
  v_mfma_f32_32x32x16_bf16 v[64:79], a[112:115], v[24:27], v[64:79]
  ds_read_b128 v[16:19], v9 offset:15360
  v_mfma_f32_32x32x16_bf16 v[80:95], a[112:115], v[28:31], v[80:95]
  ds_read_b128 v[20:23], v10 offset:15360
  s_waitcnt lgkmcnt(2)
  v_mfma_f32_32x32x16_bf16 v[64:79], a[116:119], v[32:35], v[64:79]
  ds_read_b128 v[24:27], v9 offset:15872
  v_mfma_f32_32x32x16_bf16 v[80:95], a[116:119], v[36:39], v[80:95]
  ds_read_b128 v[28:31], v10 offset:15872
  s_waitcnt vmcnt(19)
  s_waitcnt lgkmcnt(2)
  v_mfma_f32_32x32x16_bf16 v[64:79], a[120:123], v[16:19], v[64:79]
  ds_read_b128 v[32:35], v9 offset:16384
  v_mfma_f32_32x32x16_bf16 v[80:95], a[120:123], v[20:23], v[80:95]
  ds_read_b128 v[36:39], v10 offset:16384
  s_waitcnt lgkmcnt(2)
  v_mfma_f32_32x32x16_bf16 v[64:79], a[124:127], v[24:27], v[64:79]
  ds_read_b128 v[16:19], v9 offset:16896
  v_mfma_f32_32x32x16_bf16 v[80:95], a[124:127], v[28:31], v[80:95]
  ds_read_b128 v[20:23], v10 offset:16896
  s_waitcnt vmcnt(17)
  s_waitcnt lgkmcnt(2)
  v_mfma_f32_32x32x16_bf16 v[64:79], a[128:131], v[32:35], v[64:79]
  ds_read_b128 v[24:27], v9 offset:17408
  v_mfma_f32_32x32x16_bf16 v[80:95], a[128:131], v[36:39], v[80:95]
  ds_read_b128 v[28:31], v10 offset:17408
  s_waitcnt lgkmcnt(2)
  v_mfma_f32_32x32x16_bf16 v[64:79], a[132:135], v[16:19], v[64:79]
  ds_read_b128 v[32:35], v9 offset:17920
  v_mfma_f32_32x32x16_bf16 v[80:95], a[132:135], v[20:23], v[80:95]
  ds_read_b128 v[36:39], v10 offset:17920
  s_waitcnt vmcnt(15)
  s_waitcnt lgkmcnt(2)
  v_mfma_f32_32x32x16_bf16 v[64:79], a[136:139], v[24:27], v[64:79]
  ds_read_b128 v[16:19], v9 offset:18432
  v_mfma_f32_32x32x16_bf16 v[80:95], a[136:139], v[28:31], v[80:95]
  ds_read_b128 v[20:23], v10 offset:18432
  s_waitcnt lgkmcnt(2)
  v_mfma_f32_32x32x16_bf16 v[64:79], a[140:143], v[32:35], v[64:79]
  ds_read_b128 v[24:27], v9 offset:18944
  v_mfma_f32_32x32x16_bf16 v[80:95], a[140:143], v[36:39], v[80:95]
  ds_read_b128 v[28:31], v10 offset:18944
  s_waitcnt vmcnt(13)
  s_waitcnt lgkmcnt(2)
  v_mfma_f32_32x32x16_bf16 v[64:79], a[144:147], v[16:19], v[64:79]
  ds_read_b128 v[32:35], v9 offset:19456
  v_mfma_f32_32x32x16_bf16 v[80:95], a[144:147], v[20:23], v[80:95]
  ds_read_b128 v[36:39], v10 offset:19456
  s_waitcnt lgkmcnt(2)
  v_mfma_f32_32x32x16_bf16 v[64:79], a[148:151], v[24:27], v[64:79]
  ds_read_b128 v[16:19], v9 offset:19968
  v_mfma_f32_32x32x16_bf16 v[80:95], a[148:151], v[28:31], v[80:95]
  ds_read_b128 v[20:23], v10 offset:19968
  s_waitcnt vmcnt(0)
  s_waitcnt lgkmcnt(2)
  v_mfma_f32_32x32x16_bf16 v[64:79], a[152:155], v[32:35], v[64:79]
  v_mfma_f32_32x32x16_bf16 v[80:95], a[152:155], v[36:39], v[80:95]
  s_waitcnt lgkmcnt(0)
  v_mfma_f32_32x32x16_bf16 v[64:79], a[156:159], v[16:19], v[64:79]
  v_mfma_f32_32x32x16_bf16 v[80:95], a[156:159], v[20:23], v[80:95]
  s_nop 11
QP_go_43:
  s_cmp_eq_u32 s32, 0
  s_cbranch_scc0 ATT_l0_69
  s_cmp_eq_u32 s29, 20
  s_cbranch_scc0 PW2_70
  s_lshl_b32 s40, s30, 2
  s_add_u32 s40, s40, s28
  s_mul_i32 s44, s40, 3072
  s_add_u32 s44, s44, 20480
  buffer_store_dwordx4 v[208:211], v2, s[8:11], s44 offen offset:0 sc1
  buffer_store_dwordx4 v[212:215], v2, s[8:11], s44 offen offset:1024 sc1
  buffer_store_dwordx4 v[216:219], v2, s[8:11], s44 offen offset:2048 sc1
  s_nop 1
PW2_70:
ATT_l0_69:
  v_and_b32 v16, 31, v1
  v_lshlrev_b32 v16, 3, v16
  v_add_u32 v16, 160384, v16
  ds_read_b64 v[18:19], v16
  ds_read_b64 v[20:21], v16 offset:256
  s_waitcnt lgkmcnt(0)
  v_mul_f32 v18, 0x3ea52b5c, v18
  v_mul_f32 v19, 0x3ea52b5c, v19
  v_mul_f32 v20, 0x3ea52b5c, v20
  v_mul_f32 v21, 0x3ea52b5c, v21
  v_cmp_gt_u32 vcc, 32, v1
  v_pk_mul_f32 v[22:23], v[18:19], v[208:209] op_sel:[1,0] op_sel_hi:[1,1]
  v_pk_fma_f32 v[64:65], v[64:65], v[18:19], v[22:23] op_sel_hi:[1,0,1]
  v_pk_mul_f32 v[24:25], v[18:19], v[210:211] op_sel:[1,0] op_sel_hi:[1,1]
  v_pk_fma_f32 v[66:67], v[66:67], v[18:19], v[24:25] op_sel_hi:[1,0,1]
  v_pk_mul_f32 v[22:23], v[18:19], v[212:213] op_sel:[1,0] op_sel_hi:[1,1]
  v_pk_fma_f32 v[68:69], v[68:69], v[18:19], v[22:23] op_sel_hi:[1,0,1]
  v_pk_mul_f32 v[24:25], v[18:19], v[214:215] op_sel:[1,0] op_sel_hi:[1,1]
  v_pk_fma_f32 v[70:71], v[70:71], v[18:19], v[24:25] op_sel_hi:[1,0,1]
  v_pk_mul_f32 v[22:23], v[18:19], v[216:217] op_sel:[1,0] op_sel_hi:[1,1]
  v_pk_fma_f32 v[72:73], v[72:73], v[18:19], v[22:23] op_sel_hi:[1,0,1]
  v_pk_mul_f32 v[24:25], v[18:19], v[218:219] op_sel:[1,0] op_sel_hi:[1,1]
  v_pk_fma_f32 v[74:75], v[74:75], v[18:19], v[24:25] op_sel_hi:[1,0,1]
  v_cndmask_b32 v72, 0, v72, vcc
  v_cndmask_b32 v73, 0, v73, vcc
  v_cndmask_b32 v74, 0, v74, vcc
  v_cndmask_b32 v75, 0, v75, vcc
  v_cvt_pk_bf16_f32 v176, v64, v65
  v_cvt_pk_bf16_f32 v177, v66, v67
  v_cvt_pk_bf16_f32 v178, v68, v69
  v_cvt_pk_bf16_f32 v179, v70, v71
  v_cvt_pk_bf16_f32 v180, v72, v73
  v_cvt_pk_bf16_f32 v181, v74, v75
  v_pk_mul_f32 v[26:27], v[64:65], v[64:65]
  v_pk_fma_f32 v[26:27], v[66:67], v[66:67], v[26:27]
  v_pk_fma_f32 v[26:27], v[68:69], v[68:69], v[26:27]
  v_pk_fma_f32 v[26:27], v[70:71], v[70:71], v[26:27]
  v_pk_fma_f32 v[26:27], v[72:73], v[72:73], v[26:27]
  v_pk_fma_f32 v[26:27], v[74:75], v[74:75], v[26:27]
  v_add_f32 v116, v26, v27
  v_pk_mul_f32 v[22:23], v[20:21], v[208:209] op_sel:[1,0] op_sel_hi:[1,1]
  v_pk_fma_f32 v[80:81], v[80:81], v[20:21], v[22:23] op_sel_hi:[1,0,1]
  v_pk_mul_f32 v[24:25], v[20:21], v[210:211] op_sel:[1,0] op_sel_hi:[1,1]
  v_pk_fma_f32 v[82:83], v[82:83], v[20:21], v[24:25] op_sel_hi:[1,0,1]
  v_pk_mul_f32 v[22:23], v[20:21], v[212:213] op_sel:[1,0] op_sel_hi:[1,1]
  v_pk_fma_f32 v[84:85], v[84:85], v[20:21], v[22:23] op_sel_hi:[1,0,1]
  v_pk_mul_f32 v[24:25], v[20:21], v[214:215] op_sel:[1,0] op_sel_hi:[1,1]
  v_pk_fma_f32 v[86:87], v[86:87], v[20:21], v[24:25] op_sel_hi:[1,0,1]
  v_pk_mul_f32 v[22:23], v[20:21], v[216:217] op_sel:[1,0] op_sel_hi:[1,1]
  v_pk_fma_f32 v[88:89], v[88:89], v[20:21], v[22:23] op_sel_hi:[1,0,1]
  v_pk_mul_f32 v[24:25], v[20:21], v[218:219] op_sel:[1,0] op_sel_hi:[1,1]
  v_pk_fma_f32 v[90:91], v[90:91], v[20:21], v[24:25] op_sel_hi:[1,0,1]
  v_cndmask_b32 v88, 0, v88, vcc
  v_cndmask_b32 v89, 0, v89, vcc
  v_cndmask_b32 v90, 0, v90, vcc
  v_cndmask_b32 v91, 0, v91, vcc
  v_cvt_pk_bf16_f32 v184, v80, v81
  v_cvt_pk_bf16_f32 v185, v82, v83
  v_cvt_pk_bf16_f32 v186, v84, v85
  v_cvt_pk_bf16_f32 v187, v86, v87
  v_cvt_pk_bf16_f32 v188, v88, v89
  v_cvt_pk_bf16_f32 v189, v90, v91
  v_pk_mul_f32 v[26:27], v[80:81], v[80:81]
  v_pk_fma_f32 v[26:27], v[82:83], v[82:83], v[26:27]
  v_pk_fma_f32 v[26:27], v[84:85], v[84:85], v[26:27]
  v_pk_fma_f32 v[26:27], v[86:87], v[86:87], v[26:27]
  v_pk_fma_f32 v[26:27], v[88:89], v[88:89], v[26:27]
  v_pk_fma_f32 v[26:27], v[90:91], v[90:91], v[26:27]
  v_add_f32 v117, v26, v27
  v_mov_b32 v118, v116
  s_nop 1
  v_permlane32_swap_b32 v116, v118
  v_add_f32 v116, v116, v118
  v_mov_b32 v118, v117
  s_nop 1
  v_permlane32_swap_b32 v117, v118
  v_add_f32 v117, v117, v118
  v_max_f32 v116, v116, v117
  s_nop 1
  v_max_f32_dpp v116, v116, v116 row_ror:8 row_mask:0xf bank_mask:0xf
  s_nop 1
  v_max_f32_dpp v116, v116, v116 row_ror:4 row_mask:0xf bank_mask:0xf
  s_nop 1
  v_max_f32_dpp v116, v116, v116 row_ror:2 row_mask:0xf bank_mask:0xf
  s_nop 1
  v_max_f32_dpp v116, v116, v116 row_ror:1 row_mask:0xf bank_mask:0xf
  v_mov_b32 v118, v116
  s_nop 1
  v_permlane16_swap_b32 v116, v118
  v_max_f32 v116, v116, v118
  v_mov_b32 v118, v116
  s_nop 1
  v_permlane32_swap_b32 v116, v118
  v_max_f32 v116, v116, v118
  s_nop 0
  v_readfirstlane_b32 s52, v116
  s_cmp_eq_u32 s32, 0
  s_nop 3
  s_cbranch_scc0 DF_71
  v_cmp_ne_u32 vcc, s35, v227
  s_cmp_eq_u64 vcc, 0
  s_cselect_b32 s34, 1, 0
  s_cmp_eq_u32 s34, 0
  s_cselect_b64 s[40:41], 0, -1
  v_mov_b32 v8, 0x40000000
  v_cndmask_b32 v5, v8, v2, s[40:41]
  v_cndmask_b32 v6, v2, v8, s[40:41]
  s_nop 1
DF_71:
  s_cmp_eq_u32 s34, 0
  s_cselect_b32 s38, 0x40000000, 0
  v_add_u32 v56, s38, v56
  v_add_u32 v57, s38, v57
  v_add_u32 v58, s38, v58
  v_max_f32 v10, v50, v51
  s_nop 1
  v_max_f32_dpp v10, v10, v10 row_ror:8 row_mask:0xf bank_mask:0xf
  s_nop 1
  v_max_f32_dpp v10, v10, v10 row_ror:4 row_mask:0xf bank_mask:0xf
  s_nop 1
  v_max_f32_dpp v10, v10, v10 row_ror:2 row_mask:0xf bank_mask:0xf
  s_nop 1
  v_max_f32_dpp v10, v10, v10 row_ror:1 row_mask:0xf bank_mask:0xf
  v_mov_b32 v11, v10
  s_nop 1
  v_permlane16_swap_b32 v10, v11
  v_max_f32 v10, v10, v11
  v_mov_b32 v11, v10
  s_nop 1
  v_permlane32_swap_b32 v10, v11
  v_max_f32 v10, v10, v11
  v_mul_f32 v10, s52, v10
  v_cmp_nge_f32 vcc, 0x45800000, v10
  s_cmp_eq_u64 vcc, 0
  s_nop 3
  s_cbranch_scc1 ATT_fast_72
  v_lshlrev_b32 v8, 3, v1
  v_mov_b32 v12, 0xff800000
  v_mov_b32 v13, 0xff800000
  s_mov_b32 s40, s53
  s_mov_b32 s41, 64
MAXP_73:
  buffer_load_dwordx4 v[16:19], v2, s[8:11], s40 offen sc1
  buffer_load_dwordx2 v[20:21], v8, s[8:11], s40 offen offset:2368 sc1
  s_waitcnt vmcnt(0)
  v_mfma_f32_32x32x16_bf16 v[64:79], v[16:19], v[176:179], 0
  v_mfma_f32_32x32x16_bf16 v[80:95], v[16:19], v[184:187], 0
  v_mfma_f32_32x32x8bf16_1k v[64:79], v[20:21], v[180:181], v[64:79]
  v_mfma_f32_32x32x8bf16_1k v[80:95], v[20:21], v[188:189], v[80:95]
  s_nop 10
  v_max_f32 v12, v12, v64
  v_max_f32 v12, v12, v65
  v_max_f32 v12, v12, v66
  v_max_f32 v12, v12, v67
  v_max_f32 v12, v12, v68
  v_max_f32 v12, v12, v69
  v_max_f32 v12, v12, v70
  v_max_f32 v12, v12, v71
  v_max_f32 v12, v12, v72
  v_max_f32 v12, v12, v73
  v_max_f32 v12, v12, v74
  v_max_f32 v12, v12, v75
  v_max_f32 v12, v12, v76
  v_max_f32 v12, v12, v77
  v_max_f32 v12, v12, v78
  v_max_f32 v12, v12, v79
  v_max_f32 v13, v13, v80
  v_max_f32 v13, v13, v81
  v_max_f32 v13, v13, v82
  v_max_f32 v13, v13, v83
  v_max_f32 v13, v13, v84
  v_max_f32 v13, v13, v85
  v_max_f32 v13, v13, v86
  v_max_f32 v13, v13, v87
  v_max_f32 v13, v13, v88
  v_max_f32 v13, v13, v89
  v_max_f32 v13, v13, v90
  v_max_f32 v13, v13, v91
  v_max_f32 v13, v13, v92
  v_max_f32 v13, v13, v93
  v_max_f32 v13, v13, v94
  v_max_f32 v13, v13, v95
  s_add_u32 s40, s40, 3072
  s_sub_u32 s41, s41, 1
  s_cmp_lg_u32 s41, 0
  s_cbranch_scc1 MAXP_73
  v_mov_b32 v14, v12
  s_nop 1
  v_permlane32_swap_b32 v12, v14
  v_max_f32 v12, v12, v14
  v_sub_f32 v14, 0, v12
  v_and_b32 v15, 0xffff0000, v14
  v_sub_f32 v14, v14, v15
  v_and_b32 v16, 0xffff0000, v14
  v_sub_f32 v14, v14, v16
  v_lshrrev_b32 v15, 16, v15
  v_or_b32 v15, v15, v16
  v_lshrrev_b32 v14, 16, v14
  s_mov_b32 s40, 0
  s_mov_b32 s41, -1
  v_cndmask_b32 v180, v180, v15, s[40:41]
  v_cndmask_b32 v181, v181, v14, s[40:41]
  v_mov_b32 v14, v13
  s_nop 1
  v_permlane32_swap_b32 v13, v14
  v_max_f32 v13, v13, v14
  v_sub_f32 v14, 0, v13
  v_and_b32 v15, 0xffff0000, v14
  v_sub_f32 v14, v14, v15
  v_and_b32 v16, 0xffff0000, v14
  v_sub_f32 v14, v14, v16
  v_lshrrev_b32 v15, 16, v15
  v_or_b32 v15, v15, v16
  v_lshrrev_b32 v14, 16, v14
  s_mov_b32 s40, 0
  s_mov_b32 s41, -1
  v_cndmask_b32 v188, v188, v15, s[40:41]
  v_cndmask_b32 v189, v189, v14, s[40:41]
  s_nop 1
ATT_fast_72:
  s_waitcnt vmcnt(0)
  s_barrier
  s_cmp_eq_u32 s32, 0
  s_cbranch_scc0 PFLAG_74
  s_cmp_eq_u32 s28, 0
  s_cbranch_scc0 PFLAG_74
  s_lshl_b32 s40, s31, 2
  s_add_u32 s40, s40, 12288
  v_mov_b32 v8, 0
  v_mov_b32 v9, 1
  s_mov_b64 exec, 1
  buffer_store_dword v9, v8, s[8:11], s40 offen sc1
  s_mov_b64 exec, -1
PFLAG_74:
  ds_read_b128 v[192:195], v224 offset:0
  ds_read_b64 v[196:197], v225 offset:0
  ds_read_b128 v[208:211], v224 offset:3072
  ds_read_b64 v[212:213], v225 offset:3072
  ds_read_b128 v[200:203], v226 offset:0
  ds_read_b128 v[204:207], v253 offset:0
  s_waitcnt lgkmcnt(0)
  v_mfma_f32_32x32x16_bf16 v[64:79], v[192:195], v[176:179], 0
  v_mfma_f32_32x32x16_bf16 v[80:95], v[192:195], v[184:187], 0
  v_mfma_f32_32x32x8bf16_1k v[64:79], v[196:197], v[180:181], v[64:79]
  v_mfma_f32_32x32x8bf16_1k v[80:95], v[196:197], v[188:189], v[80:95]
  v_mfma_f32_32x32x16_bf16 v[96:111], v[208:211], v[176:179], 0
  ds_read_b128 v[192:195], v224 offset:6144
  s_nop 8
  v_exp_f32 v64, v64
  v_exp_f32 v65, v65
  v_exp_f32 v66, v66
  v_exp_f32 v67, v67
  v_cvt_pk_bf16_f32 v128, v64, v65
  v_cvt_pk_bf16_f32 v129, v66, v67
  v_mfma_f32_32x32x8bf16_1k v[96:111], v[212:213], v[180:181], v[96:111]
  ds_read_b64 v[196:197], v225 offset:6144
  v_exp_f32 v68, v68
  v_exp_f32 v69, v69
  v_exp_f32 v70, v70
  v_exp_f32 v71, v71
  v_cvt_pk_bf16_f32 v130, v68, v69
  v_cvt_pk_bf16_f32 v131, v70, v71
  v_mfma_f32_32x32x16_bf16 v[160:175], v[220:223], v[140:143], v[160:175]
  v_exp_f32 v72, v72
  v_exp_f32 v73, v73
  v_exp_f32 v74, v74
  v_exp_f32 v75, v75
  v_cvt_pk_bf16_f32 v132, v72, v73
  v_cvt_pk_bf16_f32 v133, v74, v75
  v_mfma_f32_32x32x16_bf16 v[144:159], v[200:203], v[128:131], v[144:159]
  ds_read_b128 v[216:219], v226 offset:3072
  v_exp_f32 v76, v76
  v_exp_f32 v77, v77
  v_exp_f32 v78, v78
  v_exp_f32 v79, v79
  v_cvt_pk_bf16_f32 v134, v76, v77
  v_cvt_pk_bf16_f32 v135, v78, v79
  v_mfma_f32_32x32x16_bf16 v[112:127], v[208:211], v[184:187], 0
  ds_read_b128 v[220:223], v253 offset:3072
  v_exp_f32 v80, v80
  v_exp_f32 v81, v81
  v_exp_f32 v82, v82
  v_exp_f32 v83, v83
  v_cvt_pk_bf16_f32 v136, v80, v81
  v_cvt_pk_bf16_f32 v137, v82, v83
  v_mfma_f32_32x32x8bf16_1k v[112:127], v[212:213], v[188:189], v[112:127]
  v_exp_f32 v84, v84
  v_exp_f32 v85, v85
  v_exp_f32 v86, v86
  v_exp_f32 v87, v87
  v_cvt_pk_bf16_f32 v138, v84, v85
  v_cvt_pk_bf16_f32 v139, v86, v87
  v_mfma_f32_32x32x16_bf16 v[144:159], v[204:207], v[132:135], v[144:159]
  v_exp_f32 v88, v88
  v_exp_f32 v89, v89
  v_exp_f32 v90, v90
  v_exp_f32 v91, v91
  v_cvt_pk_bf16_f32 v140, v88, v89
  v_cvt_pk_bf16_f32 v141, v90, v91
  v_mfma_f32_32x32x16_bf16 v[160:175], v[200:203], v[136:139], v[160:175]
  s_waitcnt lgkmcnt(0)
  v_exp_f32 v92, v92
  v_exp_f32 v93, v93
  v_exp_f32 v94, v94
  v_exp_f32 v95, v95
  v_cvt_pk_bf16_f32 v142, v92, v93
  v_cvt_pk_bf16_f32 v143, v94, v95
  v_mfma_f32_32x32x16_bf16 v[64:79], v[192:195], v[176:179], 0
  ds_read_b128 v[208:211], v224 offset:9216
  v_exp_f32 v96, v96
  v_exp_f32 v97, v97
  v_exp_f32 v98, v98
  v_exp_f32 v99, v99
  v_cvt_pk_bf16_f32 v128, v96, v97
  v_cvt_pk_bf16_f32 v129, v98, v99
  v_mfma_f32_32x32x8bf16_1k v[64:79], v[196:197], v[180:181], v[64:79]
  ds_read_b64 v[212:213], v225 offset:9216
  v_exp_f32 v100, v100
  v_exp_f32 v101, v101
  v_exp_f32 v102, v102
  v_exp_f32 v103, v103
  v_cvt_pk_bf16_f32 v130, v100, v101
  v_cvt_pk_bf16_f32 v131, v102, v103
  v_mfma_f32_32x32x16_bf16 v[160:175], v[204:207], v[140:143], v[160:175]
  v_exp_f32 v104, v104
  v_exp_f32 v105, v105
  v_exp_f32 v106, v106
  v_exp_f32 v107, v107
  v_cvt_pk_bf16_f32 v132, v104, v105
  v_cvt_pk_bf16_f32 v133, v106, v107
  v_mfma_f32_32x32x16_bf16 v[144:159], v[216:219], v[128:131], v[144:159]
  ds_read_b128 v[200:203], v226 offset:6144
  v_exp_f32 v108, v108
  v_exp_f32 v109, v109
  v_exp_f32 v110, v110
  v_exp_f32 v111, v111
  v_cvt_pk_bf16_f32 v134, v108, v109
  v_cvt_pk_bf16_f32 v135, v110, v111
  v_mfma_f32_32x32x16_bf16 v[80:95], v[192:195], v[184:187], 0
  ds_read_b128 v[204:207], v253 offset:6144
  v_exp_f32 v112, v112
  v_exp_f32 v113, v113
  v_exp_f32 v114, v114
  v_exp_f32 v115, v115
  v_cvt_pk_bf16_f32 v136, v112, v113
  v_cvt_pk_bf16_f32 v137, v114, v115
  v_mfma_f32_32x32x8bf16_1k v[80:95], v[196:197], v[188:189], v[80:95]
  v_exp_f32 v116, v116
  v_exp_f32 v117, v117
  v_exp_f32 v118, v118
  v_exp_f32 v119, v119
  v_cvt_pk_bf16_f32 v138, v116, v117
  v_cvt_pk_bf16_f32 v139, v118, v119
  v_mfma_f32_32x32x16_bf16 v[144:159], v[220:223], v[132:135], v[144:159]
  v_exp_f32 v120, v120
  v_exp_f32 v121, v121
  v_exp_f32 v122, v122
  v_exp_f32 v123, v123
  v_cvt_pk_bf16_f32 v140, v120, v121
  v_cvt_pk_bf16_f32 v141, v122, v123
  v_mfma_f32_32x32x16_bf16 v[160:175], v[216:219], v[136:139], v[160:175]
  s_waitcnt lgkmcnt(0)
  v_exp_f32 v124, v124
  v_exp_f32 v125, v125
  v_exp_f32 v126, v126
  v_exp_f32 v127, v127
  v_cvt_pk_bf16_f32 v142, v124, v125
  v_cvt_pk_bf16_f32 v143, v126, v127
  s_barrier
  v_mfma_f32_32x32x16_bf16 v[96:111], v[208:211], v[176:179], 0
  ds_read_b128 v[192:195], v224 offset:12288
  v_exp_f32 v64, v64
  v_exp_f32 v65, v65
  v_exp_f32 v66, v66
  v_exp_f32 v67, v67
  v_cvt_pk_bf16_f32 v128, v64, v65
  v_cvt_pk_bf16_f32 v129, v66, v67
  v_mfma_f32_32x32x8bf16_1k v[96:111], v[212:213], v[180:181], v[96:111]
  ds_read_b64 v[196:197], v225 offset:12288
  v_exp_f32 v68, v68
  v_exp_f32 v69, v69
  v_exp_f32 v70, v70
  v_exp_f32 v71, v71
  v_cvt_pk_bf16_f32 v130, v68, v69
  v_cvt_pk_bf16_f32 v131, v70, v71
  v_mfma_f32_32x32x16_bf16 v[160:175], v[220:223], v[140:143], v[160:175]
  s_add_u32 m0, s54, 139264
  s_nop 0
  buffer_load_dwordx4 v2, s[8:11], s55 offen offset:0 sc1 lds
  v_exp_f32 v72, v72
  v_exp_f32 v73, v73
  v_exp_f32 v74, v74
  v_exp_f32 v75, v75
  v_cvt_pk_bf16_f32 v132, v72, v73
  v_cvt_pk_bf16_f32 v133, v74, v75
  v_mfma_f32_32x32x16_bf16 v[144:159], v[200:203], v[128:131], v[144:159]
  ds_read_b128 v[216:219], v226 offset:9216
  v_exp_f32 v76, v76
  v_exp_f32 v77, v77
  v_exp_f32 v78, v78
  v_exp_f32 v79, v79
  v_cvt_pk_bf16_f32 v134, v76, v77
  v_cvt_pk_bf16_f32 v135, v78, v79
  v_mfma_f32_32x32x16_bf16 v[112:127], v[208:211], v[184:187], 0
  ds_read_b128 v[220:223], v253 offset:9216
  v_exp_f32 v80, v80
  v_exp_f32 v81, v81
  v_exp_f32 v82, v82
  v_exp_f32 v83, v83
  v_cvt_pk_bf16_f32 v136, v80, v81
  v_cvt_pk_bf16_f32 v137, v82, v83
  v_mfma_f32_32x32x8bf16_1k v[112:127], v[212:213], v[188:189], v[112:127]
  buffer_load_dwordx4 v2, s[8:11], s55 offen offset:1024 sc1 lds
  v_exp_f32 v84, v84
  v_exp_f32 v85, v85
  v_exp_f32 v86, v86
  v_exp_f32 v87, v87
  v_cvt_pk_bf16_f32 v138, v84, v85
  v_cvt_pk_bf16_f32 v139, v86, v87
  v_mfma_f32_32x32x16_bf16 v[144:159], v[204:207], v[132:135], v[144:159]
  buffer_load_dwordx4 v2, s[8:11], s55 offen offset:2048 sc1 lds
  s_add_u32 s55, s55, 12288
  v_exp_f32 v88, v88
  v_exp_f32 v89, v89
  v_exp_f32 v90, v90
  v_exp_f32 v91, v91
  v_cvt_pk_bf16_f32 v140, v88, v89
  v_cvt_pk_bf16_f32 v141, v90, v91
  v_mfma_f32_32x32x16_bf16 v[160:175], v[200:203], v[136:139], v[160:175]
  s_waitcnt lgkmcnt(0)
  v_exp_f32 v92, v92
  v_exp_f32 v93, v93
  v_exp_f32 v94, v94
  v_exp_f32 v95, v95
  v_cvt_pk_bf16_f32 v142, v92, v93
  v_cvt_pk_bf16_f32 v143, v94, v95
  v_mfma_f32_32x32x16_bf16 v[64:79], v[192:195], v[176:179], 0
  ds_read_b128 v[208:211], v224 offset:15360
  v_exp_f32 v96, v96
  v_exp_f32 v97, v97
  v_exp_f32 v98, v98
  v_exp_f32 v99, v99
  v_cvt_pk_bf16_f32 v128, v96, v97
  v_cvt_pk_bf16_f32 v129, v98, v99
  v_mfma_f32_32x32x8bf16_1k v[64:79], v[196:197], v[180:181], v[64:79]
  ds_read_b64 v[212:213], v225 offset:15360
  v_exp_f32 v100, v100
  v_exp_f32 v101, v101
  v_exp_f32 v102, v102
  v_exp_f32 v103, v103
  v_cvt_pk_bf16_f32 v130, v100, v101
  v_cvt_pk_bf16_f32 v131, v102, v103
  v_mfma_f32_32x32x16_bf16 v[160:175], v[204:207], v[140:143], v[160:175]
  v_exp_f32 v104, v104
  v_exp_f32 v105, v105
  v_exp_f32 v106, v106
  v_exp_f32 v107, v107
  v_cvt_pk_bf16_f32 v132, v104, v105
  v_cvt_pk_bf16_f32 v133, v106, v107
  v_mfma_f32_32x32x16_bf16 v[144:159], v[216:219], v[128:131], v[144:159]
  ds_read_b128 v[200:203], v226 offset:12288
  v_exp_f32 v108, v108
  v_exp_f32 v109, v109
  v_exp_f32 v110, v110
  v_exp_f32 v111, v111
  v_cvt_pk_bf16_f32 v134, v108, v109
  v_cvt_pk_bf16_f32 v135, v110, v111
  v_mfma_f32_32x32x16_bf16 v[80:95], v[192:195], v[184:187], 0
  ds_read_b128 v[204:207], v253 offset:12288
  v_exp_f32 v112, v112
  v_exp_f32 v113, v113
  v_exp_f32 v114, v114
  v_exp_f32 v115, v115
  v_cvt_pk_bf16_f32 v136, v112, v113
  v_cvt_pk_bf16_f32 v137, v114, v115
  v_mfma_f32_32x32x8bf16_1k v[80:95], v[196:197], v[188:189], v[80:95]
  v_exp_f32 v116, v116
  v_exp_f32 v117, v117
  v_exp_f32 v118, v118
  v_exp_f32 v119, v119
  v_cvt_pk_bf16_f32 v138, v116, v117
  v_cvt_pk_bf16_f32 v139, v118, v119
  v_mfma_f32_32x32x16_bf16 v[144:159], v[220:223], v[132:135], v[144:159]
  v_exp_f32 v120, v120
  v_exp_f32 v121, v121
  v_exp_f32 v122, v122
  v_exp_f32 v123, v123
  v_cvt_pk_bf16_f32 v140, v120, v121
  v_cvt_pk_bf16_f32 v141, v122, v123
  v_mfma_f32_32x32x16_bf16 v[160:175], v[216:219], v[136:139], v[160:175]
  s_waitcnt lgkmcnt(0)
  v_exp_f32 v124, v124
  v_exp_f32 v125, v125
  v_exp_f32 v126, v126
  v_exp_f32 v127, v127
  v_cvt_pk_bf16_f32 v142, v124, v125
  v_cvt_pk_bf16_f32 v143, v126, v127
  v_mfma_f32_32x32x16_bf16 v[96:111], v[208:211], v[176:179], 0
  ds_read_b128 v[192:195], v224 offset:18432
  v_exp_f32 v64, v64
  v_exp_f32 v65, v65
  v_exp_f32 v66, v66
  v_exp_f32 v67, v67
  v_cvt_pk_bf16_f32 v128, v64, v65
  v_cvt_pk_bf16_f32 v129, v66, v67
  v_mfma_f32_32x32x8bf16_1k v[96:111], v[212:213], v[180:181], v[96:111]
  ds_read_b64 v[196:197], v225 offset:18432
  v_exp_f32 v68, v68
  v_exp_f32 v69, v69
  v_exp_f32 v70, v70
  v_exp_f32 v71, v71
  v_cvt_pk_bf16_f32 v130, v68, v69
  v_cvt_pk_bf16_f32 v131, v70, v71
  v_mfma_f32_32x32x16_bf16 v[160:175], v[220:223], v[140:143], v[160:175]
  v_exp_f32 v72, v72
  v_exp_f32 v73, v73
  v_exp_f32 v74, v74
  v_exp_f32 v75, v75
  v_cvt_pk_bf16_f32 v132, v72, v73
  v_cvt_pk_bf16_f32 v133, v74, v75
  v_mfma_f32_32x32x16_bf16 v[144:159], v[200:203], v[128:131], v[144:159]
  ds_read_b128 v[216:219], v226 offset:15360
  v_exp_f32 v76, v76
  v_exp_f32 v77, v77
  v_exp_f32 v78, v78
  v_exp_f32 v79, v79
  v_cvt_pk_bf16_f32 v134, v76, v77
  v_cvt_pk_bf16_f32 v135, v78, v79
  v_mfma_f32_32x32x16_bf16 v[112:127], v[208:211], v[184:187], 0
  ds_read_b128 v[220:223], v253 offset:15360
  v_exp_f32 v80, v80
  v_exp_f32 v81, v81
  v_exp_f32 v82, v82
  v_exp_f32 v83, v83
  v_cvt_pk_bf16_f32 v136, v80, v81
  v_cvt_pk_bf16_f32 v137, v82, v83
  v_mfma_f32_32x32x8bf16_1k v[112:127], v[212:213], v[188:189], v[112:127]
  v_exp_f32 v84, v84
  v_exp_f32 v85, v85
  v_exp_f32 v86, v86
  v_exp_f32 v87, v87
  v_cvt_pk_bf16_f32 v138, v84, v85
  v_cvt_pk_bf16_f32 v139, v86, v87
  v_mfma_f32_32x32x16_bf16 v[144:159], v[204:207], v[132:135], v[144:159]
  v_exp_f32 v88, v88
  v_exp_f32 v89, v89
  v_exp_f32 v90, v90
  v_exp_f32 v91, v91
  v_cvt_pk_bf16_f32 v140, v88, v89
  v_cvt_pk_bf16_f32 v141, v90, v91
  v_mfma_f32_32x32x16_bf16 v[160:175], v[200:203], v[136:139], v[160:175]
  s_waitcnt lgkmcnt(0)
  v_exp_f32 v92, v92
  v_exp_f32 v93, v93
  v_exp_f32 v94, v94
  v_exp_f32 v95, v95
  v_cvt_pk_bf16_f32 v142, v92, v93
  v_cvt_pk_bf16_f32 v143, v94, v95
  v_mfma_f32_32x32x16_bf16 v[64:79], v[192:195], v[176:179], 0
  ds_read_b128 v[208:211], v224 offset:21504
  v_exp_f32 v96, v96
  v_exp_f32 v97, v97
  v_exp_f32 v98, v98
  v_exp_f32 v99, v99
  v_cvt_pk_bf16_f32 v128, v96, v97
  v_cvt_pk_bf16_f32 v129, v98, v99
  v_mfma_f32_32x32x8bf16_1k v[64:79], v[196:197], v[180:181], v[64:79]
  ds_read_b64 v[212:213], v225 offset:21504
  v_exp_f32 v100, v100
  v_exp_f32 v101, v101
  v_exp_f32 v102, v102
  v_exp_f32 v103, v103
  v_cvt_pk_bf16_f32 v130, v100, v101
  v_cvt_pk_bf16_f32 v131, v102, v103
  v_mfma_f32_32x32x16_bf16 v[160:175], v[204:207], v[140:143], v[160:175]
  v_exp_f32 v104, v104
  v_exp_f32 v105, v105
  v_exp_f32 v106, v106
  v_exp_f32 v107, v107
  v_cvt_pk_bf16_f32 v132, v104, v105
  v_cvt_pk_bf16_f32 v133, v106, v107
  v_mfma_f32_32x32x16_bf16 v[144:159], v[216:219], v[128:131], v[144:159]
  ds_read_b128 v[200:203], v226 offset:18432
  v_exp_f32 v108, v108
  v_exp_f32 v109, v109
  v_exp_f32 v110, v110
  v_exp_f32 v111, v111
  v_cvt_pk_bf16_f32 v134, v108, v109
  v_cvt_pk_bf16_f32 v135, v110, v111
  v_mfma_f32_32x32x16_bf16 v[80:95], v[192:195], v[184:187], 0
  ds_read_b128 v[204:207], v253 offset:18432
  v_exp_f32 v112, v112
  v_exp_f32 v113, v113
  v_exp_f32 v114, v114
  v_exp_f32 v115, v115
  v_cvt_pk_bf16_f32 v136, v112, v113
  v_cvt_pk_bf16_f32 v137, v114, v115
  v_mfma_f32_32x32x8bf16_1k v[80:95], v[196:197], v[188:189], v[80:95]
  v_exp_f32 v116, v116
  v_exp_f32 v117, v117
  v_exp_f32 v118, v118
  v_exp_f32 v119, v119
  v_cvt_pk_bf16_f32 v138, v116, v117
  v_cvt_pk_bf16_f32 v139, v118, v119
  v_mfma_f32_32x32x16_bf16 v[144:159], v[220:223], v[132:135], v[144:159]
  v_exp_f32 v120, v120
  v_exp_f32 v121, v121
  v_exp_f32 v122, v122
  v_exp_f32 v123, v123
  v_cvt_pk_bf16_f32 v140, v120, v121
  v_cvt_pk_bf16_f32 v141, v122, v123
  v_mfma_f32_32x32x16_bf16 v[160:175], v[216:219], v[136:139], v[160:175]
  s_waitcnt lgkmcnt(0)
  v_exp_f32 v124, v124
  v_exp_f32 v125, v125
  v_exp_f32 v126, v126
  v_exp_f32 v127, v127
  v_cvt_pk_bf16_f32 v142, v124, v125
  v_cvt_pk_bf16_f32 v143, v126, v127
  s_barrier
  v_mfma_f32_32x32x16_bf16 v[96:111], v[208:211], v[176:179], 0
  ds_read_b128 v[192:195], v224 offset:24576
  v_exp_f32 v64, v64
  v_exp_f32 v65, v65
  v_exp_f32 v66, v66
  v_exp_f32 v67, v67
  v_cvt_pk_bf16_f32 v128, v64, v65
  v_cvt_pk_bf16_f32 v129, v66, v67
  v_mfma_f32_32x32x8bf16_1k v[96:111], v[212:213], v[180:181], v[96:111]
  ds_read_b64 v[196:197], v225 offset:24576
  v_exp_f32 v68, v68
  v_exp_f32 v69, v69
  v_exp_f32 v70, v70
  v_exp_f32 v71, v71
  v_cvt_pk_bf16_f32 v130, v68, v69
  v_cvt_pk_bf16_f32 v131, v70, v71
  v_mfma_f32_32x32x16_bf16 v[160:175], v[220:223], v[140:143], v[160:175]
  s_add_u32 m0, s54, 102400
  s_nop 0
  buffer_load_dwordx4 v2, s[8:11], s55 offen offset:0 sc1 lds
  v_exp_f32 v72, v72
  v_exp_f32 v73, v73
  v_exp_f32 v74, v74
  v_exp_f32 v75, v75
  v_cvt_pk_bf16_f32 v132, v72, v73
  v_cvt_pk_bf16_f32 v133, v74, v75
  v_mfma_f32_32x32x16_bf16 v[144:159], v[200:203], v[128:131], v[144:159]
  ds_read_b128 v[216:219], v226 offset:21504
  v_exp_f32 v76, v76
  v_exp_f32 v77, v77
  v_exp_f32 v78, v78
  v_exp_f32 v79, v79
  v_cvt_pk_bf16_f32 v134, v76, v77
  v_cvt_pk_bf16_f32 v135, v78, v79
  v_mfma_f32_32x32x16_bf16 v[112:127], v[208:211], v[184:187], 0
  ds_read_b128 v[220:223], v253 offset:21504
  v_exp_f32 v80, v80
  v_exp_f32 v81, v81
  v_exp_f32 v82, v82
  v_exp_f32 v83, v83
  v_cvt_pk_bf16_f32 v136, v80, v81
  v_cvt_pk_bf16_f32 v137, v82, v83
  v_mfma_f32_32x32x8bf16_1k v[112:127], v[212:213], v[188:189], v[112:127]
  buffer_load_dwordx4 v2, s[8:11], s55 offen offset:1024 sc1 lds
  v_exp_f32 v84, v84
  v_exp_f32 v85, v85
  v_exp_f32 v86, v86
  v_exp_f32 v87, v87
  v_cvt_pk_bf16_f32 v138, v84, v85
  v_cvt_pk_bf16_f32 v139, v86, v87
  v_mfma_f32_32x32x16_bf16 v[144:159], v[204:207], v[132:135], v[144:159]
  buffer_load_dwordx4 v2, s[8:11], s55 offen offset:2048 sc1 lds
  s_add_u32 s55, s55, 12288
  v_exp_f32 v88, v88
  v_exp_f32 v89, v89
  v_exp_f32 v90, v90
  v_exp_f32 v91, v91
  v_cvt_pk_bf16_f32 v140, v88, v89
  v_cvt_pk_bf16_f32 v141, v90, v91
  v_mfma_f32_32x32x16_bf16 v[160:175], v[200:203], v[136:139], v[160:175]
  s_waitcnt lgkmcnt(0)
  v_exp_f32 v92, v92
  v_exp_f32 v93, v93
  v_exp_f32 v94, v94
  v_exp_f32 v95, v95
  v_cvt_pk_bf16_f32 v142, v92, v93
  v_cvt_pk_bf16_f32 v143, v94, v95
  v_mfma_f32_32x32x16_bf16 v[64:79], v[192:195], v[176:179], 0
  ds_read_b128 v[208:211], v224 offset:27648
  v_exp_f32 v96, v96
  v_exp_f32 v97, v97
  v_exp_f32 v98, v98
  v_exp_f32 v99, v99
  v_cvt_pk_bf16_f32 v128, v96, v97
  v_cvt_pk_bf16_f32 v129, v98, v99
  v_mfma_f32_32x32x8bf16_1k v[64:79], v[196:197], v[180:181], v[64:79]
  ds_read_b64 v[212:213], v225 offset:27648
  v_exp_f32 v100, v100
  v_exp_f32 v101, v101
  v_exp_f32 v102, v102
  v_exp_f32 v103, v103
  v_cvt_pk_bf16_f32 v130, v100, v101
  v_cvt_pk_bf16_f32 v131, v102, v103
  v_mfma_f32_32x32x16_bf16 v[160:175], v[204:207], v[140:143], v[160:175]
  v_exp_f32 v104, v104
  v_exp_f32 v105, v105
  v_exp_f32 v106, v106
  v_exp_f32 v107, v107
  v_cvt_pk_bf16_f32 v132, v104, v105
  v_cvt_pk_bf16_f32 v133, v106, v107
  v_mfma_f32_32x32x16_bf16 v[144:159], v[216:219], v[128:131], v[144:159]
  ds_read_b128 v[200:203], v226 offset:24576
  v_exp_f32 v108, v108
  v_exp_f32 v109, v109
  v_exp_f32 v110, v110
  v_exp_f32 v111, v111
  v_cvt_pk_bf16_f32 v134, v108, v109
  v_cvt_pk_bf16_f32 v135, v110, v111
  v_mfma_f32_32x32x16_bf16 v[80:95], v[192:195], v[184:187], 0
  ds_read_b128 v[204:207], v253 offset:24576
  v_exp_f32 v112, v112
  v_exp_f32 v113, v113
  v_exp_f32 v114, v114
  v_exp_f32 v115, v115
  v_cvt_pk_bf16_f32 v136, v112, v113
  v_cvt_pk_bf16_f32 v137, v114, v115
  v_mfma_f32_32x32x8bf16_1k v[80:95], v[196:197], v[188:189], v[80:95]
  v_exp_f32 v116, v116
  v_exp_f32 v117, v117
  v_exp_f32 v118, v118
  v_exp_f32 v119, v119
  v_cvt_pk_bf16_f32 v138, v116, v117
  v_cvt_pk_bf16_f32 v139, v118, v119
  v_mfma_f32_32x32x16_bf16 v[144:159], v[220:223], v[132:135], v[144:159]
  v_exp_f32 v120, v120
  v_exp_f32 v121, v121
  v_exp_f32 v122, v122
  v_exp_f32 v123, v123
  v_cvt_pk_bf16_f32 v140, v120, v121
  v_cvt_pk_bf16_f32 v141, v122, v123
  v_mfma_f32_32x32x16_bf16 v[160:175], v[216:219], v[136:139], v[160:175]
  s_waitcnt lgkmcnt(0)
  v_exp_f32 v124, v124
  v_exp_f32 v125, v125
  v_exp_f32 v126, v126
  v_exp_f32 v127, v127
  v_cvt_pk_bf16_f32 v142, v124, v125
  v_cvt_pk_bf16_f32 v143, v126, v127
  v_mfma_f32_32x32x16_bf16 v[96:111], v[208:211], v[176:179], 0
  ds_read_b128 v[192:195], v224 offset:30720
  v_exp_f32 v64, v64
  v_exp_f32 v65, v65
  v_exp_f32 v66, v66
  v_exp_f32 v67, v67
  v_cvt_pk_bf16_f32 v128, v64, v65
  v_cvt_pk_bf16_f32 v129, v66, v67
  v_mfma_f32_32x32x8bf16_1k v[96:111], v[212:213], v[180:181], v[96:111]
  ds_read_b64 v[196:197], v225 offset:30720
  v_exp_f32 v68, v68
  v_exp_f32 v69, v69
  v_exp_f32 v70, v70
  v_exp_f32 v71, v71
  v_cvt_pk_bf16_f32 v130, v68, v69
  v_cvt_pk_bf16_f32 v131, v70, v71
  v_mfma_f32_32x32x16_bf16 v[160:175], v[220:223], v[140:143], v[160:175]
  v_exp_f32 v72, v72
  v_exp_f32 v73, v73
  v_exp_f32 v74, v74
  v_exp_f32 v75, v75
  v_cvt_pk_bf16_f32 v132, v72, v73
  v_cvt_pk_bf16_f32 v133, v74, v75
  v_mfma_f32_32x32x16_bf16 v[144:159], v[200:203], v[128:131], v[144:159]
  ds_read_b128 v[216:219], v226 offset:27648
  v_exp_f32 v76, v76
  v_exp_f32 v77, v77
  v_exp_f32 v78, v78
  v_exp_f32 v79, v79
  v_cvt_pk_bf16_f32 v134, v76, v77
  v_cvt_pk_bf16_f32 v135, v78, v79
  v_mfma_f32_32x32x16_bf16 v[112:127], v[208:211], v[184:187], 0
  ds_read_b128 v[220:223], v253 offset:27648
  v_exp_f32 v80, v80
  v_exp_f32 v81, v81
  v_exp_f32 v82, v82
  v_exp_f32 v83, v83
  v_cvt_pk_bf16_f32 v136, v80, v81
  v_cvt_pk_bf16_f32 v137, v82, v83
  v_mfma_f32_32x32x8bf16_1k v[112:127], v[212:213], v[188:189], v[112:127]
  v_exp_f32 v84, v84
  v_exp_f32 v85, v85
  v_exp_f32 v86, v86
  v_exp_f32 v87, v87
  v_cvt_pk_bf16_f32 v138, v84, v85
  v_cvt_pk_bf16_f32 v139, v86, v87
  v_mfma_f32_32x32x16_bf16 v[144:159], v[204:207], v[132:135], v[144:159]
  v_exp_f32 v88, v88
  v_exp_f32 v89, v89
  v_exp_f32 v90, v90
  v_exp_f32 v91, v91
  v_cvt_pk_bf16_f32 v140, v88, v89
  v_cvt_pk_bf16_f32 v141, v90, v91
  v_mfma_f32_32x32x16_bf16 v[160:175], v[200:203], v[136:139], v[160:175]
  s_waitcnt lgkmcnt(0)
  v_exp_f32 v92, v92
  v_exp_f32 v93, v93
  v_exp_f32 v94, v94
  v_exp_f32 v95, v95
  v_cvt_pk_bf16_f32 v142, v92, v93
  v_cvt_pk_bf16_f32 v143, v94, v95
  v_mfma_f32_32x32x16_bf16 v[64:79], v[192:195], v[176:179], 0
  ds_read_b128 v[208:211], v224 offset:33792
  v_exp_f32 v96, v96
  v_exp_f32 v97, v97
  v_exp_f32 v98, v98
  v_exp_f32 v99, v99
  v_cvt_pk_bf16_f32 v128, v96, v97
  v_cvt_pk_bf16_f32 v129, v98, v99
  v_mfma_f32_32x32x8bf16_1k v[64:79], v[196:197], v[180:181], v[64:79]
  ds_read_b64 v[212:213], v225 offset:33792
  v_exp_f32 v100, v100
  v_exp_f32 v101, v101
  v_exp_f32 v102, v102
  v_exp_f32 v103, v103
  v_cvt_pk_bf16_f32 v130, v100, v101
  v_cvt_pk_bf16_f32 v131, v102, v103
  v_mfma_f32_32x32x16_bf16 v[160:175], v[204:207], v[140:143], v[160:175]
  v_exp_f32 v104, v104
  v_exp_f32 v105, v105
  v_exp_f32 v106, v106
  v_exp_f32 v107, v107
  v_cvt_pk_bf16_f32 v132, v104, v105
  v_cvt_pk_bf16_f32 v133, v106, v107
  v_mfma_f32_32x32x16_bf16 v[144:159], v[216:219], v[128:131], v[144:159]
  ds_read_b128 v[200:203], v226 offset:30720
  v_exp_f32 v108, v108
  v_exp_f32 v109, v109
  v_exp_f32 v110, v110
  v_exp_f32 v111, v111
  v_cvt_pk_bf16_f32 v134, v108, v109
  v_cvt_pk_bf16_f32 v135, v110, v111
  v_mfma_f32_32x32x16_bf16 v[80:95], v[192:195], v[184:187], 0
  ds_read_b128 v[204:207], v253 offset:30720
  v_exp_f32 v112, v112
  v_exp_f32 v113, v113
  v_exp_f32 v114, v114
  v_exp_f32 v115, v115
  v_cvt_pk_bf16_f32 v136, v112, v113
  v_cvt_pk_bf16_f32 v137, v114, v115
  v_mfma_f32_32x32x8bf16_1k v[80:95], v[196:197], v[188:189], v[80:95]
  v_exp_f32 v116, v116
  v_exp_f32 v117, v117
  v_exp_f32 v118, v118
  v_exp_f32 v119, v119
  v_cvt_pk_bf16_f32 v138, v116, v117
  v_cvt_pk_bf16_f32 v139, v118, v119
  v_mfma_f32_32x32x16_bf16 v[144:159], v[220:223], v[132:135], v[144:159]
  v_exp_f32 v120, v120
  v_exp_f32 v121, v121
  v_exp_f32 v122, v122
  v_exp_f32 v123, v123
  v_cvt_pk_bf16_f32 v140, v120, v121
  v_cvt_pk_bf16_f32 v141, v122, v123
  v_mfma_f32_32x32x16_bf16 v[160:175], v[216:219], v[136:139], v[160:175]
  s_waitcnt lgkmcnt(0)
  v_exp_f32 v124, v124
  v_exp_f32 v125, v125
  v_exp_f32 v126, v126
  v_exp_f32 v127, v127
  v_cvt_pk_bf16_f32 v142, v124, v125
  v_cvt_pk_bf16_f32 v143, v126, v127
  s_waitcnt vmcnt(3)
  s_cmp_eq_u32 s32, 0
  s_nop 2
  s_cbranch_scc0 PREPL_75
  s_cmp_eq_u32 s28, 0
  s_cbranch_scc0 PREPL_75
  s_mov_b32 s40, 12288
  buffer_load_dwordx4 v[8:11], v2, s[8:11], s40 offen sc1
PREPL_75:
  s_barrier
  v_mfma_f32_32x32x16_bf16 v[96:111], v[208:211], v[176:179], 0
  ds_read_b128 v[192:195], v224 offset:36864
  v_exp_f32 v64, v64
  v_exp_f32 v65, v65
  v_exp_f32 v66, v66
  v_exp_f32 v67, v67
  v_cvt_pk_bf16_f32 v128, v64, v65
  v_cvt_pk_bf16_f32 v129, v66, v67
  v_mfma_f32_32x32x8bf16_1k v[96:111], v[212:213], v[180:181], v[96:111]
  ds_read_b64 v[196:197], v225 offset:36864
  v_exp_f32 v68, v68
  v_exp_f32 v69, v69
  v_exp_f32 v70, v70
  v_exp_f32 v71, v71
  v_cvt_pk_bf16_f32 v130, v68, v69
  v_cvt_pk_bf16_f32 v131, v70, v71
  v_mfma_f32_32x32x16_bf16 v[160:175], v[220:223], v[140:143], v[160:175]
  s_add_u32 m0, s54, 114688
  s_nop 0
  buffer_load_dwordx4 v2, s[8:11], s55 offen offset:0 sc1 lds
  v_exp_f32 v72, v72
  v_exp_f32 v73, v73
  v_exp_f32 v74, v74
  v_exp_f32 v75, v75
  v_cvt_pk_bf16_f32 v132, v72, v73
  v_cvt_pk_bf16_f32 v133, v74, v75
  v_mfma_f32_32x32x16_bf16 v[144:159], v[200:203], v[128:131], v[144:159]
  ds_read_b128 v[216:219], v226 offset:33792
  v_exp_f32 v76, v76
  v_exp_f32 v77, v77
  v_exp_f32 v78, v78
  v_exp_f32 v79, v79
  v_cvt_pk_bf16_f32 v134, v76, v77
  v_cvt_pk_bf16_f32 v135, v78, v79
  v_mfma_f32_32x32x16_bf16 v[112:127], v[208:211], v[184:187], 0
  ds_read_b128 v[220:223], v253 offset:33792
  v_exp_f32 v80, v80
  v_exp_f32 v81, v81
  v_exp_f32 v82, v82
  v_exp_f32 v83, v83
  v_cvt_pk_bf16_f32 v136, v80, v81
  v_cvt_pk_bf16_f32 v137, v82, v83
  v_mfma_f32_32x32x8bf16_1k v[112:127], v[212:213], v[188:189], v[112:127]
  buffer_load_dwordx4 v2, s[8:11], s55 offen offset:1024 sc1 lds
  v_exp_f32 v84, v84
  v_exp_f32 v85, v85
  v_exp_f32 v86, v86
  v_exp_f32 v87, v87
  v_cvt_pk_bf16_f32 v138, v84, v85
  v_cvt_pk_bf16_f32 v139, v86, v87
  v_mfma_f32_32x32x16_bf16 v[144:159], v[204:207], v[132:135], v[144:159]
  buffer_load_dwordx4 v2, s[8:11], s55 offen offset:2048 sc1 lds
  s_add_u32 s55, s55, 12288
  v_exp_f32 v88, v88
  v_exp_f32 v89, v89
  v_exp_f32 v90, v90
  v_exp_f32 v91, v91
  v_cvt_pk_bf16_f32 v140, v88, v89
  v_cvt_pk_bf16_f32 v141, v90, v91
  v_mfma_f32_32x32x16_bf16 v[160:175], v[200:203], v[136:139], v[160:175]
  s_waitcnt lgkmcnt(0)
  v_exp_f32 v92, v92
  v_exp_f32 v93, v93
  v_exp_f32 v94, v94
  v_exp_f32 v95, v95
  v_cvt_pk_bf16_f32 v142, v92, v93
  v_cvt_pk_bf16_f32 v143, v94, v95
  v_mfma_f32_32x32x16_bf16 v[64:79], v[192:195], v[176:179], 0
  ds_read_b128 v[208:211], v224 offset:39936
  v_exp_f32 v96, v96
  v_exp_f32 v97, v97
  v_exp_f32 v98, v98
  v_exp_f32 v99, v99
  v_cvt_pk_bf16_f32 v128, v96, v97
  v_cvt_pk_bf16_f32 v129, v98, v99
  v_mfma_f32_32x32x8bf16_1k v[64:79], v[196:197], v[180:181], v[64:79]
  ds_read_b64 v[212:213], v225 offset:39936
  v_exp_f32 v100, v100
  v_exp_f32 v101, v101
  v_exp_f32 v102, v102
  v_exp_f32 v103, v103
  v_cvt_pk_bf16_f32 v130, v100, v101
  v_cvt_pk_bf16_f32 v131, v102, v103
  v_mfma_f32_32x32x16_bf16 v[160:175], v[204:207], v[140:143], v[160:175]
  v_exp_f32 v104, v104
  v_exp_f32 v105, v105
  v_exp_f32 v106, v106
  v_exp_f32 v107, v107
  v_cvt_pk_bf16_f32 v132, v104, v105
  v_cvt_pk_bf16_f32 v133, v106, v107
  v_mfma_f32_32x32x16_bf16 v[144:159], v[216:219], v[128:131], v[144:159]
  ds_read_b128 v[200:203], v226 offset:36864
  v_exp_f32 v108, v108
  v_exp_f32 v109, v109
  v_exp_f32 v110, v110
  v_exp_f32 v111, v111
  v_cvt_pk_bf16_f32 v134, v108, v109
  v_cvt_pk_bf16_f32 v135, v110, v111
  v_mfma_f32_32x32x16_bf16 v[80:95], v[192:195], v[184:187], 0
  ds_read_b128 v[204:207], v253 offset:36864
  v_exp_f32 v112, v112
  v_exp_f32 v113, v113
  v_exp_f32 v114, v114
  v_exp_f32 v115, v115
  v_cvt_pk_bf16_f32 v136, v112, v113
  v_cvt_pk_bf16_f32 v137, v114, v115
  v_mfma_f32_32x32x8bf16_1k v[80:95], v[196:197], v[188:189], v[80:95]
  v_exp_f32 v116, v116
  v_exp_f32 v117, v117
  v_exp_f32 v118, v118
  v_exp_f32 v119, v119
  v_cvt_pk_bf16_f32 v138, v116, v117
  v_cvt_pk_bf16_f32 v139, v118, v119
  v_mfma_f32_32x32x16_bf16 v[144:159], v[220:223], v[132:135], v[144:159]
  v_exp_f32 v120, v120
  v_exp_f32 v121, v121
  v_exp_f32 v122, v122
  v_exp_f32 v123, v123
  v_cvt_pk_bf16_f32 v140, v120, v121
  v_cvt_pk_bf16_f32 v141, v122, v123
  v_mfma_f32_32x32x16_bf16 v[160:175], v[216:219], v[136:139], v[160:175]
  s_waitcnt lgkmcnt(0)
  v_exp_f32 v124, v124
  v_exp_f32 v125, v125
  v_exp_f32 v126, v126
  v_exp_f32 v127, v127
  v_cvt_pk_bf16_f32 v142, v124, v125
  v_cvt_pk_bf16_f32 v143, v126, v127
  v_mfma_f32_32x32x16_bf16 v[96:111], v[208:211], v[176:179], 0
  ds_read_b128 v[192:195], v224 offset:43008
  v_exp_f32 v64, v64
  v_exp_f32 v65, v65
  v_exp_f32 v66, v66
  v_exp_f32 v67, v67
  v_cvt_pk_bf16_f32 v128, v64, v65
  v_cvt_pk_bf16_f32 v129, v66, v67
  v_mfma_f32_32x32x8bf16_1k v[96:111], v[212:213], v[180:181], v[96:111]
  ds_read_b64 v[196:197], v225 offset:43008
  v_exp_f32 v68, v68
  v_exp_f32 v69, v69
  v_exp_f32 v70, v70
  v_exp_f32 v71, v71
  v_cvt_pk_bf16_f32 v130, v68, v69
  v_cvt_pk_bf16_f32 v131, v70, v71
  v_mfma_f32_32x32x16_bf16 v[160:175], v[220:223], v[140:143], v[160:175]
  v_exp_f32 v72, v72
  v_exp_f32 v73, v73
  v_exp_f32 v74, v74
  v_exp_f32 v75, v75
  v_cvt_pk_bf16_f32 v132, v72, v73
  v_cvt_pk_bf16_f32 v133, v74, v75
  v_mfma_f32_32x32x16_bf16 v[144:159], v[200:203], v[128:131], v[144:159]
  ds_read_b128 v[216:219], v226 offset:39936
  v_exp_f32 v76, v76
  v_exp_f32 v77, v77
  v_exp_f32 v78, v78
  v_exp_f32 v79, v79
  v_cvt_pk_bf16_f32 v134, v76, v77
  v_cvt_pk_bf16_f32 v135, v78, v79
  v_mfma_f32_32x32x16_bf16 v[112:127], v[208:211], v[184:187], 0
  ds_read_b128 v[220:223], v253 offset:39936
  v_exp_f32 v80, v80
  v_exp_f32 v81, v81
  v_exp_f32 v82, v82
  v_exp_f32 v83, v83
  v_cvt_pk_bf16_f32 v136, v80, v81
  v_cvt_pk_bf16_f32 v137, v82, v83
  v_mfma_f32_32x32x8bf16_1k v[112:127], v[212:213], v[188:189], v[112:127]
  v_exp_f32 v84, v84
  v_exp_f32 v85, v85
  v_exp_f32 v86, v86
  v_exp_f32 v87, v87
  v_cvt_pk_bf16_f32 v138, v84, v85
  v_cvt_pk_bf16_f32 v139, v86, v87
  v_mfma_f32_32x32x16_bf16 v[144:159], v[204:207], v[132:135], v[144:159]
  v_exp_f32 v88, v88
  v_exp_f32 v89, v89
  v_exp_f32 v90, v90
  v_exp_f32 v91, v91
  v_cvt_pk_bf16_f32 v140, v88, v89
  v_cvt_pk_bf16_f32 v141, v90, v91
  v_mfma_f32_32x32x16_bf16 v[160:175], v[200:203], v[136:139], v[160:175]
  s_waitcnt lgkmcnt(0)
  v_exp_f32 v92, v92
  v_exp_f32 v93, v93
  v_exp_f32 v94, v94
  v_exp_f32 v95, v95
  v_cvt_pk_bf16_f32 v142, v92, v93
  v_cvt_pk_bf16_f32 v143, v94, v95
  v_mfma_f32_32x32x16_bf16 v[64:79], v[192:195], v[176:179], 0
  ds_read_b128 v[208:211], v224 offset:46080
  v_exp_f32 v96, v96
  v_exp_f32 v97, v97
  v_exp_f32 v98, v98
  v_exp_f32 v99, v99
  v_cvt_pk_bf16_f32 v128, v96, v97
  v_cvt_pk_bf16_f32 v129, v98, v99
  v_mfma_f32_32x32x8bf16_1k v[64:79], v[196:197], v[180:181], v[64:79]
  ds_read_b64 v[212:213], v225 offset:46080
  v_exp_f32 v100, v100
  v_exp_f32 v101, v101
  v_exp_f32 v102, v102
  v_exp_f32 v103, v103
  v_cvt_pk_bf16_f32 v130, v100, v101
  v_cvt_pk_bf16_f32 v131, v102, v103
  v_mfma_f32_32x32x16_bf16 v[160:175], v[204:207], v[140:143], v[160:175]
  v_exp_f32 v104, v104
  v_exp_f32 v105, v105
  v_exp_f32 v106, v106
  v_exp_f32 v107, v107
  v_cvt_pk_bf16_f32 v132, v104, v105
  v_cvt_pk_bf16_f32 v133, v106, v107
  v_mfma_f32_32x32x16_bf16 v[144:159], v[216:219], v[128:131], v[144:159]
  ds_read_b128 v[200:203], v226 offset:43008
  v_exp_f32 v108, v108
  v_exp_f32 v109, v109
  v_exp_f32 v110, v110
  v_exp_f32 v111, v111
  v_cvt_pk_bf16_f32 v134, v108, v109
  v_cvt_pk_bf16_f32 v135, v110, v111
  v_mfma_f32_32x32x16_bf16 v[80:95], v[192:195], v[184:187], 0
  ds_read_b128 v[204:207], v253 offset:43008
  v_exp_f32 v112, v112
  v_exp_f32 v113, v113
  v_exp_f32 v114, v114
  v_exp_f32 v115, v115
  v_cvt_pk_bf16_f32 v136, v112, v113
  v_cvt_pk_bf16_f32 v137, v114, v115
  v_mfma_f32_32x32x8bf16_1k v[80:95], v[196:197], v[188:189], v[80:95]
  v_exp_f32 v116, v116
  v_exp_f32 v117, v117
  v_exp_f32 v118, v118
  v_exp_f32 v119, v119
  v_cvt_pk_bf16_f32 v138, v116, v117
  v_cvt_pk_bf16_f32 v139, v118, v119
  v_mfma_f32_32x32x16_bf16 v[144:159], v[220:223], v[132:135], v[144:159]
  v_exp_f32 v120, v120
  v_exp_f32 v121, v121
  v_exp_f32 v122, v122
  v_exp_f32 v123, v123
  v_cvt_pk_bf16_f32 v140, v120, v121
  v_cvt_pk_bf16_f32 v141, v122, v123
  v_mfma_f32_32x32x16_bf16 v[160:175], v[216:219], v[136:139], v[160:175]
  s_waitcnt lgkmcnt(0)
  v_exp_f32 v124, v124
  v_exp_f32 v125, v125
  v_exp_f32 v126, v126
  v_exp_f32 v127, v127
  v_cvt_pk_bf16_f32 v142, v124, v125
  v_cvt_pk_bf16_f32 v143, v126, v127
  s_waitcnt vmcnt(3)
  s_cmp_eq_u32 s32, 0
  s_nop 2
  s_cbranch_scc0 PREPW_76
  s_cmp_eq_u32 s28, 0
  s_cbranch_scc0 PREPW_76
  v_min_u32 v8, v8, v9
  v_min_u32 v10, v10, v11
  v_min_u32 v8, v8, v10
  v_cmp_gt_u32 vcc, 1, v8
  s_cmp_eq_u64 vcc, 0
  s_nop 3
  s_cbranch_scc1 PREPW_76
  s_mov_b32 s43, 1
  s_mov_b32 s40, 12288
  s_mov_b32 s42, 400000
PRP_77:
  buffer_load_dwordx4 v[8:11], v2, s[8:11], s40 offen sc1
  s_waitcnt vmcnt(0)
  v_min_u32 v8, v8, v9
  v_min_u32 v10, v10, v11
  v_min_u32 v8, v8, v10
  v_cmp_gt_u32 vcc, s43, v8
  s_cmp_eq_u64 vcc, 0
  s_nop 3
  s_cbranch_scc1 PRP_done_78
  s_sleep 1
  s_sub_u32 s42, s42, 1
  s_cmp_lg_u32 s42, 0
  s_cbranch_scc1 PRP_77
PRP_done_78:
PREPW_76:
  s_barrier
  v_mfma_f32_32x32x16_bf16 v[96:111], v[208:211], v[176:179], 0
  ds_read_b128 v[192:195], v224 offset:0
  v_exp_f32 v64, v64
  v_exp_f32 v65, v65
  v_exp_f32 v66, v66
  v_exp_f32 v67, v67
  v_cvt_pk_bf16_f32 v128, v64, v65
  v_cvt_pk_bf16_f32 v129, v66, v67
  v_mfma_f32_32x32x8bf16_1k v[96:111], v[212:213], v[180:181], v[96:111]
  ds_read_b64 v[196:197], v225 offset:0
  v_exp_f32 v68, v68
  v_exp_f32 v69, v69
  v_exp_f32 v70, v70
  v_exp_f32 v71, v71
  v_cvt_pk_bf16_f32 v130, v68, v69
  v_cvt_pk_bf16_f32 v131, v70, v71
  v_mfma_f32_32x32x16_bf16 v[160:175], v[220:223], v[140:143], v[160:175]
  s_add_u32 m0, s54, 126976
  s_nop 0
  buffer_load_dwordx4 v2, s[8:11], s55 offen offset:0 sc1 lds
  v_exp_f32 v72, v72
  v_exp_f32 v73, v73
  v_exp_f32 v74, v74
  v_exp_f32 v75, v75
  v_cvt_pk_bf16_f32 v132, v72, v73
  v_cvt_pk_bf16_f32 v133, v74, v75
  v_mfma_f32_32x32x16_bf16 v[144:159], v[200:203], v[128:131], v[144:159]
  ds_read_b128 v[216:219], v226 offset:46080
  v_exp_f32 v76, v76
  v_exp_f32 v77, v77
  v_exp_f32 v78, v78
  v_exp_f32 v79, v79
  v_cvt_pk_bf16_f32 v134, v76, v77
  v_cvt_pk_bf16_f32 v135, v78, v79
  v_mfma_f32_32x32x16_bf16 v[112:127], v[208:211], v[184:187], 0
  ds_read_b128 v[220:223], v253 offset:46080
  v_exp_f32 v80, v80
  v_exp_f32 v81, v81
  v_exp_f32 v82, v82
  v_exp_f32 v83, v83
  v_cvt_pk_bf16_f32 v136, v80, v81
  v_cvt_pk_bf16_f32 v137, v82, v83
  v_mfma_f32_32x32x8bf16_1k v[112:127], v[212:213], v[188:189], v[112:127]
  buffer_load_dwordx4 v2, s[8:11], s55 offen offset:1024 sc1 lds
  v_exp_f32 v84, v84
  v_exp_f32 v85, v85
  v_exp_f32 v86, v86
  v_exp_f32 v87, v87
  v_cvt_pk_bf16_f32 v138, v84, v85
  v_cvt_pk_bf16_f32 v139, v86, v87
  v_mfma_f32_32x32x16_bf16 v[144:159], v[204:207], v[132:135], v[144:159]
  buffer_load_dwordx4 v2, s[8:11], s55 offen offset:2048 sc1 lds
  s_add_u32 s55, s55, 12288
  v_exp_f32 v88, v88
  v_exp_f32 v89, v89
  v_exp_f32 v90, v90
  v_exp_f32 v91, v91
  v_cvt_pk_bf16_f32 v140, v88, v89
  v_cvt_pk_bf16_f32 v141, v90, v91
  v_mfma_f32_32x32x16_bf16 v[160:175], v[200:203], v[136:139], v[160:175]
  s_waitcnt lgkmcnt(0)
  v_exp_f32 v92, v92
  v_exp_f32 v93, v93
  v_exp_f32 v94, v94
  v_exp_f32 v95, v95
  v_cvt_pk_bf16_f32 v142, v92, v93
  v_cvt_pk_bf16_f32 v143, v94, v95
  v_mfma_f32_32x32x16_bf16 v[64:79], v[192:195], v[176:179], 0
  ds_read_b128 v[208:211], v224 offset:3072
  v_exp_f32 v96, v96
  v_exp_f32 v97, v97
  v_exp_f32 v98, v98
  v_exp_f32 v99, v99
  v_cvt_pk_bf16_f32 v128, v96, v97
  v_cvt_pk_bf16_f32 v129, v98, v99
  v_mfma_f32_32x32x8bf16_1k v[64:79], v[196:197], v[180:181], v[64:79]
  ds_read_b64 v[212:213], v225 offset:3072
  v_exp_f32 v100, v100
  v_exp_f32 v101, v101
  v_exp_f32 v102, v102
  v_exp_f32 v103, v103
  v_cvt_pk_bf16_f32 v130, v100, v101
  v_cvt_pk_bf16_f32 v131, v102, v103
  v_mfma_f32_32x32x16_bf16 v[160:175], v[204:207], v[140:143], v[160:175]
  v_exp_f32 v104, v104
  v_exp_f32 v105, v105
  v_exp_f32 v106, v106
  v_exp_f32 v107, v107
  v_cvt_pk_bf16_f32 v132, v104, v105
  v_cvt_pk_bf16_f32 v133, v106, v107
  v_mfma_f32_32x32x16_bf16 v[144:159], v[216:219], v[128:131], v[144:159]
  ds_read_b128 v[200:203], v226 offset:0
  v_exp_f32 v108, v108
  v_exp_f32 v109, v109
  v_exp_f32 v110, v110
  v_exp_f32 v111, v111
  v_cvt_pk_bf16_f32 v134, v108, v109
  v_cvt_pk_bf16_f32 v135, v110, v111
  v_mfma_f32_32x32x16_bf16 v[80:95], v[192:195], v[184:187], 0
  ds_read_b128 v[204:207], v253 offset:0
  v_exp_f32 v112, v112
  v_exp_f32 v113, v113
  v_exp_f32 v114, v114
  v_exp_f32 v115, v115
  v_cvt_pk_bf16_f32 v136, v112, v113
  v_cvt_pk_bf16_f32 v137, v114, v115
  v_mfma_f32_32x32x8bf16_1k v[80:95], v[196:197], v[188:189], v[80:95]
  v_exp_f32 v116, v116
  v_exp_f32 v117, v117
  v_exp_f32 v118, v118
  v_exp_f32 v119, v119
  v_cvt_pk_bf16_f32 v138, v116, v117
  v_cvt_pk_bf16_f32 v139, v118, v119
  v_mfma_f32_32x32x16_bf16 v[144:159], v[220:223], v[132:135], v[144:159]
  v_exp_f32 v120, v120
  v_exp_f32 v121, v121
  v_exp_f32 v122, v122
  v_exp_f32 v123, v123
  v_cvt_pk_bf16_f32 v140, v120, v121
  v_cvt_pk_bf16_f32 v141, v122, v123
  v_mfma_f32_32x32x16_bf16 v[160:175], v[216:219], v[136:139], v[160:175]
  s_waitcnt lgkmcnt(0)
  v_exp_f32 v124, v124
  v_exp_f32 v125, v125
  v_exp_f32 v126, v126
  v_exp_f32 v127, v127
  v_cvt_pk_bf16_f32 v142, v124, v125
  v_cvt_pk_bf16_f32 v143, v126, v127
  v_mfma_f32_32x32x16_bf16 v[96:111], v[208:211], v[176:179], 0
  ds_read_b128 v[192:195], v224 offset:6144
  v_exp_f32 v64, v64
  v_exp_f32 v65, v65
  v_exp_f32 v66, v66
  v_exp_f32 v67, v67
  v_cvt_pk_bf16_f32 v128, v64, v65
  v_cvt_pk_bf16_f32 v129, v66, v67
  v_mfma_f32_32x32x8bf16_1k v[96:111], v[212:213], v[180:181], v[96:111]
  ds_read_b64 v[196:197], v225 offset:6144
  v_exp_f32 v68, v68
  v_exp_f32 v69, v69
  v_exp_f32 v70, v70
  v_exp_f32 v71, v71
  v_cvt_pk_bf16_f32 v130, v68, v69
  v_cvt_pk_bf16_f32 v131, v70, v71
  v_mfma_f32_32x32x16_bf16 v[160:175], v[220:223], v[140:143], v[160:175]
  s_add_u32 m0, s60, 0
  s_nop 0
  buffer_load_dwordx4 v2, s[8:11], s59 offen offset:0 sc1 lds
  v_exp_f32 v72, v72
  v_exp_f32 v73, v73
  v_exp_f32 v74, v74
  v_exp_f32 v75, v75
  v_cvt_pk_bf16_f32 v132, v72, v73
  v_cvt_pk_bf16_f32 v133, v74, v75
  v_mfma_f32_32x32x16_bf16 v[144:159], v[200:203], v[128:131], v[144:159]
  ds_read_b128 v[216:219], v226 offset:3072
  v_exp_f32 v76, v76
  v_exp_f32 v77, v77
  v_exp_f32 v78, v78
  v_exp_f32 v79, v79
  v_cvt_pk_bf16_f32 v134, v76, v77
  v_cvt_pk_bf16_f32 v135, v78, v79
  v_mfma_f32_32x32x16_bf16 v[112:127], v[208:211], v[184:187], 0
  ds_read_b128 v[220:223], v253 offset:3072
  v_exp_f32 v80, v80
  v_exp_f32 v81, v81
  v_exp_f32 v82, v82
  v_exp_f32 v83, v83
  v_cvt_pk_bf16_f32 v136, v80, v81
  v_cvt_pk_bf16_f32 v137, v82, v83
  v_mfma_f32_32x32x8bf16_1k v[112:127], v[212:213], v[188:189], v[112:127]
  s_add_u32 m0, s60, 0
  s_nop 0
  buffer_load_dwordx4 v2, s[8:11], s59 offen offset:1024 sc1 lds
  v_exp_f32 v84, v84
  v_exp_f32 v85, v85
  v_exp_f32 v86, v86
  v_exp_f32 v87, v87
  v_cvt_pk_bf16_f32 v138, v84, v85
  v_cvt_pk_bf16_f32 v139, v86, v87
  v_mfma_f32_32x32x16_bf16 v[144:159], v[204:207], v[132:135], v[144:159]
  s_add_u32 m0, s60, 0
  s_nop 0
  buffer_load_dwordx4 v2, s[8:11], s59 offen offset:2048 sc1 lds
  v_exp_f32 v88, v88
  v_exp_f32 v89, v89
  v_exp_f32 v90, v90
  v_exp_f32 v91, v91
  v_cvt_pk_bf16_f32 v140, v88, v89
  v_cvt_pk_bf16_f32 v141, v90, v91
  v_mfma_f32_32x32x16_bf16 v[160:175], v[200:203], v[136:139], v[160:175]
  s_waitcnt lgkmcnt(0)
  v_exp_f32 v92, v92
  v_exp_f32 v93, v93
  v_exp_f32 v94, v94
  v_exp_f32 v95, v95
  v_cvt_pk_bf16_f32 v142, v92, v93
  v_cvt_pk_bf16_f32 v143, v94, v95
  v_mfma_f32_32x32x16_bf16 v[64:79], v[192:195], v[176:179], 0
  ds_read_b128 v[208:211], v224 offset:9216
  v_exp_f32 v96, v96
  v_exp_f32 v97, v97
  v_exp_f32 v98, v98
  v_exp_f32 v99, v99
  v_cvt_pk_bf16_f32 v128, v96, v97
  v_cvt_pk_bf16_f32 v129, v98, v99
  v_mfma_f32_32x32x8bf16_1k v[64:79], v[196:197], v[180:181], v[64:79]
  ds_read_b64 v[212:213], v225 offset:9216
  v_exp_f32 v100, v100
  v_exp_f32 v101, v101
  v_exp_f32 v102, v102
  v_exp_f32 v103, v103
  v_cvt_pk_bf16_f32 v130, v100, v101
  v_cvt_pk_bf16_f32 v131, v102, v103
  v_mfma_f32_32x32x16_bf16 v[160:175], v[204:207], v[140:143], v[160:175]
  s_add_u32 m0, s60, 0
  s_nop 0
  buffer_load_dwordx4 v2, s[8:11], s59 offen offset:3072 sc1 lds
  v_exp_f32 v104, v104
  v_exp_f32 v105, v105
  v_exp_f32 v106, v106
  v_exp_f32 v107, v107
  v_cvt_pk_bf16_f32 v132, v104, v105
  v_cvt_pk_bf16_f32 v133, v106, v107
  v_mfma_f32_32x32x16_bf16 v[144:159], v[216:219], v[128:131], v[144:159]
  ds_read_b128 v[200:203], v226 offset:6144
  v_exp_f32 v108, v108
  v_exp_f32 v109, v109
  v_exp_f32 v110, v110
  v_exp_f32 v111, v111
  v_cvt_pk_bf16_f32 v134, v108, v109
  v_cvt_pk_bf16_f32 v135, v110, v111
  v_mfma_f32_32x32x16_bf16 v[80:95], v[192:195], v[184:187], 0
  ds_read_b128 v[204:207], v253 offset:6144
  v_exp_f32 v112, v112
  v_exp_f32 v113, v113
  v_exp_f32 v114, v114
  v_exp_f32 v115, v115
  v_cvt_pk_bf16_f32 v136, v112, v113
  v_cvt_pk_bf16_f32 v137, v114, v115
  v_mfma_f32_32x32x8bf16_1k v[80:95], v[196:197], v[188:189], v[80:95]
  s_add_u32 s59, s59, 4096
  s_add_u32 m0, s60, 4096
  s_nop 0
  buffer_load_dwordx4 v2, s[8:11], s59 offen offset:0 sc1 lds
  v_exp_f32 v116, v116
  v_exp_f32 v117, v117
  v_exp_f32 v118, v118
  v_exp_f32 v119, v119
  v_cvt_pk_bf16_f32 v138, v116, v117
  v_cvt_pk_bf16_f32 v139, v118, v119
  v_mfma_f32_32x32x16_bf16 v[144:159], v[220:223], v[132:135], v[144:159]
  s_add_u32 m0, s60, 4096
  s_nop 0
  buffer_load_dwordx4 v2, s[8:11], s59 offen offset:1024 sc1 lds
  v_exp_f32 v120, v120
  v_exp_f32 v121, v121
  v_exp_f32 v122, v122
  v_exp_f32 v123, v123
  v_cvt_pk_bf16_f32 v140, v120, v121
  v_cvt_pk_bf16_f32 v141, v122, v123
  v_mfma_f32_32x32x16_bf16 v[160:175], v[216:219], v[136:139], v[160:175]
  s_waitcnt lgkmcnt(0)
  v_exp_f32 v124, v124
  v_exp_f32 v125, v125
  v_exp_f32 v126, v126
  v_exp_f32 v127, v127
  v_cvt_pk_bf16_f32 v142, v124, v125
  v_cvt_pk_bf16_f32 v143, v126, v127
  s_waitcnt vmcnt(9)
  s_barrier
  v_mfma_f32_32x32x16_bf16 v[96:111], v[208:211], v[176:179], 0
  ds_read_b128 v[192:195], v224 offset:12288
  v_exp_f32 v64, v64
  v_exp_f32 v65, v65
  v_exp_f32 v66, v66
  v_exp_f32 v67, v67
  v_cvt_pk_bf16_f32 v128, v64, v65
  v_cvt_pk_bf16_f32 v129, v66, v67
  v_mfma_f32_32x32x8bf16_1k v[96:111], v[212:213], v[180:181], v[96:111]
  ds_read_b64 v[196:197], v225 offset:12288
  v_exp_f32 v68, v68
  v_exp_f32 v69, v69
  v_exp_f32 v70, v70
  v_exp_f32 v71, v71
  v_cvt_pk_bf16_f32 v130, v68, v69
  v_cvt_pk_bf16_f32 v131, v70, v71
  v_mfma_f32_32x32x16_bf16 v[160:175], v[220:223], v[140:143], v[160:175]
  s_add_u32 m0, s54, 139264
  s_nop 0
  buffer_load_dwordx4 v2, s[8:11], s55 offen offset:0 sc1 lds
  v_exp_f32 v72, v72
  v_exp_f32 v73, v73
  v_exp_f32 v74, v74
  v_exp_f32 v75, v75
  v_cvt_pk_bf16_f32 v132, v72, v73
  v_cvt_pk_bf16_f32 v133, v74, v75
  v_mfma_f32_32x32x16_bf16 v[144:159], v[200:203], v[128:131], v[144:159]
  ds_read_b128 v[216:219], v226 offset:9216
  v_exp_f32 v76, v76
  v_exp_f32 v77, v77
  v_exp_f32 v78, v78
  v_exp_f32 v79, v79
  v_cvt_pk_bf16_f32 v134, v76, v77
  v_cvt_pk_bf16_f32 v135, v78, v79
  v_mfma_f32_32x32x16_bf16 v[112:127], v[208:211], v[184:187], 0
  ds_read_b128 v[220:223], v253 offset:9216
  v_exp_f32 v80, v80
  v_exp_f32 v81, v81
  v_exp_f32 v82, v82
  v_exp_f32 v83, v83
  v_cvt_pk_bf16_f32 v136, v80, v81
  v_cvt_pk_bf16_f32 v137, v82, v83
  v_mfma_f32_32x32x8bf16_1k v[112:127], v[212:213], v[188:189], v[112:127]
  buffer_load_dwordx4 v2, s[8:11], s55 offen offset:1024 sc1 lds
  v_exp_f32 v84, v84
  v_exp_f32 v85, v85
  v_exp_f32 v86, v86
  v_exp_f32 v87, v87
  v_cvt_pk_bf16_f32 v138, v84, v85
  v_cvt_pk_bf16_f32 v139, v86, v87
  v_mfma_f32_32x32x16_bf16 v[144:159], v[204:207], v[132:135], v[144:159]
  buffer_load_dwordx4 v2, s[8:11], s55 offen offset:2048 sc1 lds
  s_add_u32 s55, s55, 12288
  v_exp_f32 v88, v88
  v_exp_f32 v89, v89
  v_exp_f32 v90, v90
  v_exp_f32 v91, v91
  v_cvt_pk_bf16_f32 v140, v88, v89
  v_cvt_pk_bf16_f32 v141, v90, v91
  v_mfma_f32_32x32x16_bf16 v[160:175], v[200:203], v[136:139], v[160:175]
  s_waitcnt lgkmcnt(0)
  v_exp_f32 v92, v92
  v_exp_f32 v93, v93
  v_exp_f32 v94, v94
  v_exp_f32 v95, v95
  v_cvt_pk_bf16_f32 v142, v92, v93
  v_cvt_pk_bf16_f32 v143, v94, v95
  v_mfma_f32_32x32x16_bf16 v[64:79], v[192:195], v[176:179], 0
  ds_read_b128 v[208:211], v224 offset:15360
  v_exp_f32 v96, v96
  v_exp_f32 v97, v97
  v_exp_f32 v98, v98
  v_exp_f32 v99, v99
  v_cvt_pk_bf16_f32 v128, v96, v97
  v_cvt_pk_bf16_f32 v129, v98, v99
  v_mfma_f32_32x32x8bf16_1k v[64:79], v[196:197], v[180:181], v[64:79]
  ds_read_b64 v[212:213], v225 offset:15360
  v_exp_f32 v100, v100
  v_exp_f32 v101, v101
  v_exp_f32 v102, v102
  v_exp_f32 v103, v103
  v_cvt_pk_bf16_f32 v130, v100, v101
  v_cvt_pk_bf16_f32 v131, v102, v103
  v_mfma_f32_32x32x16_bf16 v[160:175], v[204:207], v[140:143], v[160:175]
  s_add_u32 m0, s60, 4096
  s_nop 0
  buffer_load_dwordx4 v2, s[8:11], s59 offen offset:2048 sc1 lds
  v_exp_f32 v104, v104
  v_exp_f32 v105, v105
  v_exp_f32 v106, v106
  v_exp_f32 v107, v107
  v_cvt_pk_bf16_f32 v132, v104, v105
  v_cvt_pk_bf16_f32 v133, v106, v107
  v_mfma_f32_32x32x16_bf16 v[144:159], v[216:219], v[128:131], v[144:159]
  ds_read_b128 v[200:203], v226 offset:12288
  v_exp_f32 v108, v108
  v_exp_f32 v109, v109
  v_exp_f32 v110, v110
  v_exp_f32 v111, v111
  v_cvt_pk_bf16_f32 v134, v108, v109
  v_cvt_pk_bf16_f32 v135, v110, v111
  v_mfma_f32_32x32x16_bf16 v[80:95], v[192:195], v[184:187], 0
  ds_read_b128 v[204:207], v253 offset:12288
  v_exp_f32 v112, v112
  v_exp_f32 v113, v113
  v_exp_f32 v114, v114
  v_exp_f32 v115, v115
  v_cvt_pk_bf16_f32 v136, v112, v113
  v_cvt_pk_bf16_f32 v137, v114, v115
  v_mfma_f32_32x32x8bf16_1k v[80:95], v[196:197], v[188:189], v[80:95]
  s_add_u32 m0, s60, 4096
  s_nop 0
  buffer_load_dwordx4 v2, s[8:11], s59 offen offset:3072 sc1 lds
  v_exp_f32 v116, v116
  v_exp_f32 v117, v117
  v_exp_f32 v118, v118
  v_exp_f32 v119, v119
  v_cvt_pk_bf16_f32 v138, v116, v117
  v_cvt_pk_bf16_f32 v139, v118, v119
  v_mfma_f32_32x32x16_bf16 v[144:159], v[220:223], v[132:135], v[144:159]
  s_add_u32 s59, s59, 4096
  s_add_u32 m0, s60, 8192
  s_nop 0
  buffer_load_dwordx4 v2, s[8:11], s59 offen offset:0 sc1 lds
  v_exp_f32 v120, v120
  v_exp_f32 v121, v121
  v_exp_f32 v122, v122
  v_exp_f32 v123, v123
  v_cvt_pk_bf16_f32 v140, v120, v121
  v_cvt_pk_bf16_f32 v141, v122, v123
  v_mfma_f32_32x32x16_bf16 v[160:175], v[216:219], v[136:139], v[160:175]
  s_waitcnt lgkmcnt(0)
  v_exp_f32 v124, v124
  v_exp_f32 v125, v125
  v_exp_f32 v126, v126
  v_exp_f32 v127, v127
  v_cvt_pk_bf16_f32 v142, v124, v125
  v_cvt_pk_bf16_f32 v143, v126, v127
  v_mfma_f32_32x32x16_bf16 v[96:111], v[208:211], v[176:179], 0
  ds_read_b128 v[192:195], v224 offset:18432
  v_exp_f32 v64, v64
  v_exp_f32 v65, v65
  v_exp_f32 v66, v66
  v_exp_f32 v67, v67
  v_cvt_pk_bf16_f32 v128, v64, v65
  v_cvt_pk_bf16_f32 v129, v66, v67
  v_mfma_f32_32x32x8bf16_1k v[96:111], v[212:213], v[180:181], v[96:111]
  ds_read_b64 v[196:197], v225 offset:18432
  v_exp_f32 v68, v68
  v_exp_f32 v69, v69
  v_exp_f32 v70, v70
  v_exp_f32 v71, v71
  v_cvt_pk_bf16_f32 v130, v68, v69
  v_cvt_pk_bf16_f32 v131, v70, v71
  v_mfma_f32_32x32x16_bf16 v[160:175], v[220:223], v[140:143], v[160:175]
  s_add_u32 m0, s60, 8192
  s_nop 0
  buffer_load_dwordx4 v2, s[8:11], s59 offen offset:1024 sc1 lds
  v_exp_f32 v72, v72
  v_exp_f32 v73, v73
  v_exp_f32 v74, v74
  v_exp_f32 v75, v75
  v_cvt_pk_bf16_f32 v132, v72, v73
  v_cvt_pk_bf16_f32 v133, v74, v75
  v_mfma_f32_32x32x16_bf16 v[144:159], v[200:203], v[128:131], v[144:159]
  ds_read_b128 v[216:219], v226 offset:15360
  v_exp_f32 v76, v76
  v_exp_f32 v77, v77
  v_exp_f32 v78, v78
  v_exp_f32 v79, v79
  v_cvt_pk_bf16_f32 v134, v76, v77
  v_cvt_pk_bf16_f32 v135, v78, v79
  v_mfma_f32_32x32x16_bf16 v[112:127], v[208:211], v[184:187], 0
  ds_read_b128 v[220:223], v253 offset:15360
  v_exp_f32 v80, v80
  v_exp_f32 v81, v81
  v_exp_f32 v82, v82
  v_exp_f32 v83, v83
  v_cvt_pk_bf16_f32 v136, v80, v81
  v_cvt_pk_bf16_f32 v137, v82, v83
  v_mfma_f32_32x32x8bf16_1k v[112:127], v[212:213], v[188:189], v[112:127]
  s_add_u32 m0, s60, 8192
  s_nop 0
  buffer_load_dwordx4 v2, s[8:11], s59 offen offset:2048 sc1 lds
  v_exp_f32 v84, v84
  v_exp_f32 v85, v85
  v_exp_f32 v86, v86
  v_exp_f32 v87, v87
  v_cvt_pk_bf16_f32 v138, v84, v85
  v_cvt_pk_bf16_f32 v139, v86, v87
  v_mfma_f32_32x32x16_bf16 v[144:159], v[204:207], v[132:135], v[144:159]
  s_add_u32 m0, s60, 8192
  s_nop 0
  buffer_load_dwordx4 v2, s[8:11], s59 offen offset:3072 sc1 lds
  v_exp_f32 v88, v88
  v_exp_f32 v89, v89
  v_exp_f32 v90, v90
  v_exp_f32 v91, v91
  v_cvt_pk_bf16_f32 v140, v88, v89
  v_cvt_pk_bf16_f32 v141, v90, v91
  v_mfma_f32_32x32x16_bf16 v[160:175], v[200:203], v[136:139], v[160:175]
  s_waitcnt lgkmcnt(0)
  v_exp_f32 v92, v92
  v_exp_f32 v93, v93
  v_exp_f32 v94, v94
  v_exp_f32 v95, v95
  v_cvt_pk_bf16_f32 v142, v92, v93
  v_cvt_pk_bf16_f32 v143, v94, v95
  v_mfma_f32_32x32x16_bf16 v[64:79], v[192:195], v[176:179], 0
  ds_read_b128 v[208:211], v224 offset:21504
  v_exp_f32 v96, v96
  v_exp_f32 v97, v97
  v_exp_f32 v98, v98
  v_exp_f32 v99, v99
  v_cvt_pk_bf16_f32 v128, v96, v97
  v_cvt_pk_bf16_f32 v129, v98, v99
  v_mfma_f32_32x32x8bf16_1k v[64:79], v[196:197], v[180:181], v[64:79]
  ds_read_b64 v[212:213], v225 offset:21504
  v_exp_f32 v100, v100
  v_exp_f32 v101, v101
  v_exp_f32 v102, v102
  v_exp_f32 v103, v103
  v_cvt_pk_bf16_f32 v130, v100, v101
  v_cvt_pk_bf16_f32 v131, v102, v103
  v_mfma_f32_32x32x16_bf16 v[160:175], v[204:207], v[140:143], v[160:175]
  s_add_u32 s59, s59, 4096
  s_add_u32 m0, s60, 12288
  s_nop 0
  buffer_load_dwordx4 v2, s[8:11], s59 offen offset:0 sc1 lds
  v_exp_f32 v104, v104
  v_exp_f32 v105, v105
  v_exp_f32 v106, v106
  v_exp_f32 v107, v107
  v_cvt_pk_bf16_f32 v132, v104, v105
  v_cvt_pk_bf16_f32 v133, v106, v107
  v_mfma_f32_32x32x16_bf16 v[144:159], v[216:219], v[128:131], v[144:159]
  ds_read_b128 v[200:203], v226 offset:18432
  v_exp_f32 v108, v108
  v_exp_f32 v109, v109
  v_exp_f32 v110, v110
  v_exp_f32 v111, v111
  v_cvt_pk_bf16_f32 v134, v108, v109
  v_cvt_pk_bf16_f32 v135, v110, v111
  v_mfma_f32_32x32x16_bf16 v[80:95], v[192:195], v[184:187], 0
  ds_read_b128 v[204:207], v253 offset:18432
  v_exp_f32 v112, v112
  v_exp_f32 v113, v113
  v_exp_f32 v114, v114
  v_exp_f32 v115, v115
  v_cvt_pk_bf16_f32 v136, v112, v113
  v_cvt_pk_bf16_f32 v137, v114, v115
  v_mfma_f32_32x32x8bf16_1k v[80:95], v[196:197], v[188:189], v[80:95]
  s_add_u32 m0, s60, 12288
  s_nop 0
  buffer_load_dwordx4 v2, s[8:11], s59 offen offset:1024 sc1 lds
  v_exp_f32 v116, v116
  v_exp_f32 v117, v117
  v_exp_f32 v118, v118
  v_exp_f32 v119, v119
  v_cvt_pk_bf16_f32 v138, v116, v117
  v_cvt_pk_bf16_f32 v139, v118, v119
  v_mfma_f32_32x32x16_bf16 v[144:159], v[220:223], v[132:135], v[144:159]
  s_add_u32 m0, s60, 12288
  s_nop 0
  buffer_load_dwordx4 v2, s[8:11], s59 offen offset:2048 sc1 lds
  v_exp_f32 v120, v120
  v_exp_f32 v121, v121
  v_exp_f32 v122, v122
  v_exp_f32 v123, v123
  v_cvt_pk_bf16_f32 v140, v120, v121
  v_cvt_pk_bf16_f32 v141, v122, v123
  v_mfma_f32_32x32x16_bf16 v[160:175], v[216:219], v[136:139], v[160:175]
  s_waitcnt lgkmcnt(0)
  v_exp_f32 v124, v124
  v_exp_f32 v125, v125
  v_exp_f32 v126, v126
  v_exp_f32 v127, v127
  v_cvt_pk_bf16_f32 v142, v124, v125
  v_cvt_pk_bf16_f32 v143, v126, v127
  s_waitcnt vmcnt(18)
  s_barrier
  v_mfma_f32_32x32x16_bf16 v[96:111], v[208:211], v[176:179], 0
  ds_read_b128 v[192:195], v224 offset:24576
  v_exp_f32 v64, v64
  v_exp_f32 v65, v65
  v_exp_f32 v66, v66
  v_exp_f32 v67, v67
  v_cvt_pk_bf16_f32 v128, v64, v65
  v_cvt_pk_bf16_f32 v129, v66, v67
  v_mfma_f32_32x32x8bf16_1k v[96:111], v[212:213], v[180:181], v[96:111]
  ds_read_b64 v[196:197], v225 offset:24576
  v_exp_f32 v68, v68
  v_exp_f32 v69, v69
  v_exp_f32 v70, v70
  v_exp_f32 v71, v71
  v_cvt_pk_bf16_f32 v130, v68, v69
  v_cvt_pk_bf16_f32 v131, v70, v71
  v_mfma_f32_32x32x16_bf16 v[160:175], v[220:223], v[140:143], v[160:175]
  s_add_u32 m0, s54, 102400
  s_nop 0
  buffer_load_dwordx4 v2, s[8:11], s55 offen offset:0 sc1 lds
  v_exp_f32 v72, v72
  v_exp_f32 v73, v73
  v_exp_f32 v74, v74
  v_exp_f32 v75, v75
  v_cvt_pk_bf16_f32 v132, v72, v73
  v_cvt_pk_bf16_f32 v133, v74, v75
  v_mfma_f32_32x32x16_bf16 v[144:159], v[200:203], v[128:131], v[144:159]
  ds_read_b128 v[216:219], v226 offset:21504
  v_exp_f32 v76, v76
  v_exp_f32 v77, v77
  v_exp_f32 v78, v78
  v_exp_f32 v79, v79
  v_cvt_pk_bf16_f32 v134, v76, v77
  v_cvt_pk_bf16_f32 v135, v78, v79
  v_mfma_f32_32x32x16_bf16 v[112:127], v[208:211], v[184:187], 0
  ds_read_b128 v[220:223], v253 offset:21504
  v_exp_f32 v80, v80
  v_exp_f32 v81, v81
  v_exp_f32 v82, v82
  v_exp_f32 v83, v83
  v_cvt_pk_bf16_f32 v136, v80, v81
  v_cvt_pk_bf16_f32 v137, v82, v83
  v_mfma_f32_32x32x8bf16_1k v[112:127], v[212:213], v[188:189], v[112:127]
  buffer_load_dwordx4 v2, s[8:11], s55 offen offset:1024 sc1 lds
  v_exp_f32 v84, v84
  v_exp_f32 v85, v85
  v_exp_f32 v86, v86
  v_exp_f32 v87, v87
  v_cvt_pk_bf16_f32 v138, v84, v85
  v_cvt_pk_bf16_f32 v139, v86, v87
  v_mfma_f32_32x32x16_bf16 v[144:159], v[204:207], v[132:135], v[144:159]
  buffer_load_dwordx4 v2, s[8:11], s55 offen offset:2048 sc1 lds
  s_add_u32 s55, s55, 12288
  v_exp_f32 v88, v88
  v_exp_f32 v89, v89
  v_exp_f32 v90, v90
  v_exp_f32 v91, v91
  v_cvt_pk_bf16_f32 v140, v88, v89
  v_cvt_pk_bf16_f32 v141, v90, v91
  v_mfma_f32_32x32x16_bf16 v[160:175], v[200:203], v[136:139], v[160:175]
  s_waitcnt lgkmcnt(0)
  v_exp_f32 v92, v92
  v_exp_f32 v93, v93
  v_exp_f32 v94, v94
  v_exp_f32 v95, v95
  v_cvt_pk_bf16_f32 v142, v92, v93
  v_cvt_pk_bf16_f32 v143, v94, v95
  v_mfma_f32_32x32x16_bf16 v[64:79], v[192:195], v[176:179], 0
  ds_read_b128 v[208:211], v224 offset:27648
  v_exp_f32 v96, v96
  v_exp_f32 v97, v97
  v_exp_f32 v98, v98
  v_exp_f32 v99, v99
  v_cvt_pk_bf16_f32 v128, v96, v97
  v_cvt_pk_bf16_f32 v129, v98, v99
  v_mfma_f32_32x32x8bf16_1k v[64:79], v[196:197], v[180:181], v[64:79]
  ds_read_b64 v[212:213], v225 offset:27648
  v_exp_f32 v100, v100
  v_exp_f32 v101, v101
  v_exp_f32 v102, v102
  v_exp_f32 v103, v103
  v_cvt_pk_bf16_f32 v130, v100, v101
  v_cvt_pk_bf16_f32 v131, v102, v103
  v_mfma_f32_32x32x16_bf16 v[160:175], v[204:207], v[140:143], v[160:175]
  s_add_u32 m0, s60, 12288
  s_nop 0
  buffer_load_dwordx4 v2, s[8:11], s59 offen offset:3072 sc1 lds
  v_exp_f32 v104, v104
  v_exp_f32 v105, v105
  v_exp_f32 v106, v106
  v_exp_f32 v107, v107
  v_cvt_pk_bf16_f32 v132, v104, v105
  v_cvt_pk_bf16_f32 v133, v106, v107
  v_mfma_f32_32x32x16_bf16 v[144:159], v[216:219], v[128:131], v[144:159]
  ds_read_b128 v[200:203], v226 offset:24576
  v_exp_f32 v108, v108
  v_exp_f32 v109, v109
  v_exp_f32 v110, v110
  v_exp_f32 v111, v111
  v_cvt_pk_bf16_f32 v134, v108, v109
  v_cvt_pk_bf16_f32 v135, v110, v111
  v_mfma_f32_32x32x16_bf16 v[80:95], v[192:195], v[184:187], 0
  ds_read_b128 v[204:207], v253 offset:24576
  v_exp_f32 v112, v112
  v_exp_f32 v113, v113
  v_exp_f32 v114, v114
  v_exp_f32 v115, v115
  v_cvt_pk_bf16_f32 v136, v112, v113
  v_cvt_pk_bf16_f32 v137, v114, v115
  v_mfma_f32_32x32x8bf16_1k v[80:95], v[196:197], v[188:189], v[80:95]
  s_add_u32 s59, s59, 4096
  s_add_u32 m0, s60, 16384
  s_nop 0
  buffer_load_dwordx4 v2, s[8:11], s59 offen offset:0 sc1 lds
  v_exp_f32 v116, v116
  v_exp_f32 v117, v117
  v_exp_f32 v118, v118
  v_exp_f32 v119, v119
  v_cvt_pk_bf16_f32 v138, v116, v117
  v_cvt_pk_bf16_f32 v139, v118, v119
  v_mfma_f32_32x32x16_bf16 v[144:159], v[220:223], v[132:135], v[144:159]
  s_add_u32 m0, s60, 16384
  s_nop 0
  buffer_load_dwordx4 v2, s[8:11], s59 offen offset:1024 sc1 lds
  v_exp_f32 v120, v120
  v_exp_f32 v121, v121
  v_exp_f32 v122, v122
  v_exp_f32 v123, v123
  v_cvt_pk_bf16_f32 v140, v120, v121
  v_cvt_pk_bf16_f32 v141, v122, v123
  v_mfma_f32_32x32x16_bf16 v[160:175], v[216:219], v[136:139], v[160:175]
  s_waitcnt lgkmcnt(0)
  v_exp_f32 v124, v124
  v_exp_f32 v125, v125
  v_exp_f32 v126, v126
  v_exp_f32 v127, v127
  v_cvt_pk_bf16_f32 v142, v124, v125
  v_cvt_pk_bf16_f32 v143, v126, v127
  v_mfma_f32_32x32x16_bf16 v[96:111], v[208:211], v[176:179], 0
  ds_read_b128 v[192:195], v224 offset:30720
  v_exp_f32 v64, v64
  v_exp_f32 v65, v65
  v_exp_f32 v66, v66
  v_exp_f32 v67, v67
  v_cvt_pk_bf16_f32 v128, v64, v65
  v_cvt_pk_bf16_f32 v129, v66, v67
  v_mfma_f32_32x32x8bf16_1k v[96:111], v[212:213], v[180:181], v[96:111]
  ds_read_b64 v[196:197], v225 offset:30720
  v_exp_f32 v68, v68
  v_exp_f32 v69, v69
  v_exp_f32 v70, v70
  v_exp_f32 v71, v71
  v_cvt_pk_bf16_f32 v130, v68, v69
  v_cvt_pk_bf16_f32 v131, v70, v71
  v_mfma_f32_32x32x16_bf16 v[160:175], v[220:223], v[140:143], v[160:175]
  s_add_u32 m0, s60, 16384
  s_nop 0
  buffer_load_dwordx4 v2, s[8:11], s59 offen offset:2048 sc1 lds
  v_exp_f32 v72, v72
  v_exp_f32 v73, v73
  v_exp_f32 v74, v74
  v_exp_f32 v75, v75
  v_cvt_pk_bf16_f32 v132, v72, v73
  v_cvt_pk_bf16_f32 v133, v74, v75
  v_mfma_f32_32x32x16_bf16 v[144:159], v[200:203], v[128:131], v[144:159]
  ds_read_b128 v[216:219], v226 offset:27648
  v_exp_f32 v76, v76
  v_exp_f32 v77, v77
  v_exp_f32 v78, v78
  v_exp_f32 v79, v79
  v_cvt_pk_bf16_f32 v134, v76, v77
  v_cvt_pk_bf16_f32 v135, v78, v79
  v_mfma_f32_32x32x16_bf16 v[112:127], v[208:211], v[184:187], 0
  ds_read_b128 v[220:223], v253 offset:27648
  v_exp_f32 v80, v80
  v_exp_f32 v81, v81
  v_exp_f32 v82, v82
  v_exp_f32 v83, v83
  v_cvt_pk_bf16_f32 v136, v80, v81
  v_cvt_pk_bf16_f32 v137, v82, v83
  v_mfma_f32_32x32x8bf16_1k v[112:127], v[212:213], v[188:189], v[112:127]
  s_add_u32 m0, s60, 16384
  s_nop 0
  buffer_load_dwordx4 v2, s[8:11], s59 offen offset:3072 sc1 lds
  v_exp_f32 v84, v84
  v_exp_f32 v85, v85
  v_exp_f32 v86, v86
  v_exp_f32 v87, v87
  v_cvt_pk_bf16_f32 v138, v84, v85
  v_cvt_pk_bf16_f32 v139, v86, v87
  v_mfma_f32_32x32x16_bf16 v[144:159], v[204:207], v[132:135], v[144:159]
  s_add_u32 s59, s59, 4096
  s_add_u32 m0, s60, 20480
  s_nop 0
  buffer_load_dwordx4 v2, s[8:11], s59 offen offset:0 sc1 lds
  v_exp_f32 v88, v88
  v_exp_f32 v89, v89
  v_exp_f32 v90, v90
  v_exp_f32 v91, v91
  v_cvt_pk_bf16_f32 v140, v88, v89
  v_cvt_pk_bf16_f32 v141, v90, v91
  v_mfma_f32_32x32x16_bf16 v[160:175], v[200:203], v[136:139], v[160:175]
  s_waitcnt lgkmcnt(0)
  v_exp_f32 v92, v92
  v_exp_f32 v93, v93
  v_exp_f32 v94, v94
  v_exp_f32 v95, v95
  v_cvt_pk_bf16_f32 v142, v92, v93
  v_cvt_pk_bf16_f32 v143, v94, v95
  v_mfma_f32_32x32x16_bf16 v[64:79], v[192:195], v[176:179], 0
  ds_read_b128 v[208:211], v224 offset:33792
  v_exp_f32 v96, v96
  v_exp_f32 v97, v97
  v_exp_f32 v98, v98
  v_exp_f32 v99, v99
  v_cvt_pk_bf16_f32 v128, v96, v97
  v_cvt_pk_bf16_f32 v129, v98, v99
  v_mfma_f32_32x32x8bf16_1k v[64:79], v[196:197], v[180:181], v[64:79]
  ds_read_b64 v[212:213], v225 offset:33792
  v_exp_f32 v100, v100
  v_exp_f32 v101, v101
  v_exp_f32 v102, v102
  v_exp_f32 v103, v103
  v_cvt_pk_bf16_f32 v130, v100, v101
  v_cvt_pk_bf16_f32 v131, v102, v103
  v_mfma_f32_32x32x16_bf16 v[160:175], v[204:207], v[140:143], v[160:175]
  s_add_u32 m0, s60, 20480
  s_nop 0
  buffer_load_dwordx4 v2, s[8:11], s59 offen offset:1024 sc1 lds
  v_exp_f32 v104, v104
  v_exp_f32 v105, v105
  v_exp_f32 v106, v106
  v_exp_f32 v107, v107
  v_cvt_pk_bf16_f32 v132, v104, v105
  v_cvt_pk_bf16_f32 v133, v106, v107
  v_mfma_f32_32x32x16_bf16 v[144:159], v[216:219], v[128:131], v[144:159]
  ds_read_b128 v[200:203], v226 offset:30720
  v_exp_f32 v108, v108
  v_exp_f32 v109, v109
  v_exp_f32 v110, v110
  v_exp_f32 v111, v111
  v_cvt_pk_bf16_f32 v134, v108, v109
  v_cvt_pk_bf16_f32 v135, v110, v111
  v_mfma_f32_32x32x16_bf16 v[80:95], v[192:195], v[184:187], 0
  ds_read_b128 v[204:207], v253 offset:30720
  v_exp_f32 v112, v112
  v_exp_f32 v113, v113
  v_exp_f32 v114, v114
  v_exp_f32 v115, v115
  v_cvt_pk_bf16_f32 v136, v112, v113
  v_cvt_pk_bf16_f32 v137, v114, v115
  v_mfma_f32_32x32x8bf16_1k v[80:95], v[196:197], v[188:189], v[80:95]
  s_add_u32 m0, s60, 20480
  s_nop 0
  buffer_load_dwordx4 v2, s[8:11], s59 offen offset:2048 sc1 lds
  v_exp_f32 v116, v116
  v_exp_f32 v117, v117
  v_exp_f32 v118, v118
  v_exp_f32 v119, v119
  v_cvt_pk_bf16_f32 v138, v116, v117
  v_cvt_pk_bf16_f32 v139, v118, v119
  v_mfma_f32_32x32x16_bf16 v[144:159], v[220:223], v[132:135], v[144:159]
  s_add_u32 m0, s60, 20480
  s_nop 0
  buffer_load_dwordx4 v2, s[8:11], s59 offen offset:3072 sc1 lds
  v_exp_f32 v120, v120
  v_exp_f32 v121, v121
  v_exp_f32 v122, v122
  v_exp_f32 v123, v123
  v_cvt_pk_bf16_f32 v140, v120, v121
  v_cvt_pk_bf16_f32 v141, v122, v123
  v_mfma_f32_32x32x16_bf16 v[160:175], v[216:219], v[136:139], v[160:175]
  s_waitcnt lgkmcnt(0)
  v_exp_f32 v124, v124
  v_exp_f32 v125, v125
  v_exp_f32 v126, v126
  v_exp_f32 v127, v127
  v_cvt_pk_bf16_f32 v142, v124, v125
  v_cvt_pk_bf16_f32 v143, v126, v127
  s_waitcnt vmcnt(21)
  s_barrier
  v_mfma_f32_32x32x16_bf16 v[96:111], v[208:211], v[176:179], 0
  ds_read_b128 v[192:195], v224 offset:36864
  v_exp_f32 v64, v64
  v_exp_f32 v65, v65
  v_exp_f32 v66, v66
  v_exp_f32 v67, v67
  v_cvt_pk_bf16_f32 v128, v64, v65
  v_cvt_pk_bf16_f32 v129, v66, v67
  v_mfma_f32_32x32x8bf16_1k v[96:111], v[212:213], v[180:181], v[96:111]
  ds_read_b64 v[196:197], v225 offset:36864
  v_exp_f32 v68, v68
  v_exp_f32 v69, v69
  v_exp_f32 v70, v70
  v_exp_f32 v71, v71
  v_cvt_pk_bf16_f32 v130, v68, v69
  v_cvt_pk_bf16_f32 v131, v70, v71
  v_mfma_f32_32x32x16_bf16 v[160:175], v[220:223], v[140:143], v[160:175]
  s_add_u32 m0, s54, 114688
  s_nop 0
  buffer_load_dwordx4 v2, s[8:11], s55 offen offset:0 sc1 lds
  v_exp_f32 v72, v72
  v_exp_f32 v73, v73
  v_exp_f32 v74, v74
  v_exp_f32 v75, v75
  v_cvt_pk_bf16_f32 v132, v72, v73
  v_cvt_pk_bf16_f32 v133, v74, v75
  v_mfma_f32_32x32x16_bf16 v[144:159], v[200:203], v[128:131], v[144:159]
  ds_read_b128 v[216:219], v226 offset:33792
  v_exp_f32 v76, v76
  v_exp_f32 v77, v77
  v_exp_f32 v78, v78
  v_exp_f32 v79, v79
  v_cvt_pk_bf16_f32 v134, v76, v77
  v_cvt_pk_bf16_f32 v135, v78, v79
  v_mfma_f32_32x32x16_bf16 v[112:127], v[208:211], v[184:187], 0
  ds_read_b128 v[220:223], v253 offset:33792
  v_exp_f32 v80, v80
  v_exp_f32 v81, v81
  v_exp_f32 v82, v82
  v_exp_f32 v83, v83
  v_cvt_pk_bf16_f32 v136, v80, v81
  v_cvt_pk_bf16_f32 v137, v82, v83
  v_mfma_f32_32x32x8bf16_1k v[112:127], v[212:213], v[188:189], v[112:127]
  buffer_load_dwordx4 v2, s[8:11], s55 offen offset:1024 sc1 lds
  v_exp_f32 v84, v84
  v_exp_f32 v85, v85
  v_exp_f32 v86, v86
  v_exp_f32 v87, v87
  v_cvt_pk_bf16_f32 v138, v84, v85
  v_cvt_pk_bf16_f32 v139, v86, v87
  v_mfma_f32_32x32x16_bf16 v[144:159], v[204:207], v[132:135], v[144:159]
  buffer_load_dwordx4 v2, s[8:11], s55 offen offset:2048 sc1 lds
  s_add_u32 s55, s55, 12288
  v_exp_f32 v88, v88
  v_exp_f32 v89, v89
  v_exp_f32 v90, v90
  v_exp_f32 v91, v91
  v_cvt_pk_bf16_f32 v140, v88, v89
  v_cvt_pk_bf16_f32 v141, v90, v91
  v_mfma_f32_32x32x16_bf16 v[160:175], v[200:203], v[136:139], v[160:175]
  s_waitcnt lgkmcnt(0)
  v_exp_f32 v92, v92
  v_exp_f32 v93, v93
  v_exp_f32 v94, v94
  v_exp_f32 v95, v95
  v_cvt_pk_bf16_f32 v142, v92, v93
  v_cvt_pk_bf16_f32 v143, v94, v95
  v_mfma_f32_32x32x16_bf16 v[64:79], v[192:195], v[176:179], 0
  ds_read_b128 v[208:211], v224 offset:39936
  v_exp_f32 v96, v96
  v_exp_f32 v97, v97
  v_exp_f32 v98, v98
  v_exp_f32 v99, v99
  v_cvt_pk_bf16_f32 v128, v96, v97
  v_cvt_pk_bf16_f32 v129, v98, v99
  v_mfma_f32_32x32x8bf16_1k v[64:79], v[196:197], v[180:181], v[64:79]
  ds_read_b64 v[212:213], v225 offset:39936
  v_exp_f32 v100, v100
  v_exp_f32 v101, v101
  v_exp_f32 v102, v102
  v_exp_f32 v103, v103
  v_cvt_pk_bf16_f32 v130, v100, v101
  v_cvt_pk_bf16_f32 v131, v102, v103
  v_mfma_f32_32x32x16_bf16 v[160:175], v[204:207], v[140:143], v[160:175]
  s_add_u32 s59, s59, 4096
  s_add_u32 m0, s60, 24576
  s_nop 0
  buffer_load_dwordx4 v2, s[8:11], s59 offen offset:0 sc1 lds
  v_exp_f32 v104, v104
  v_exp_f32 v105, v105
  v_exp_f32 v106, v106
  v_exp_f32 v107, v107
  v_cvt_pk_bf16_f32 v132, v104, v105
  v_cvt_pk_bf16_f32 v133, v106, v107
  v_mfma_f32_32x32x16_bf16 v[144:159], v[216:219], v[128:131], v[144:159]
  ds_read_b128 v[200:203], v226 offset:36864
  v_exp_f32 v108, v108
  v_exp_f32 v109, v109
  v_exp_f32 v110, v110
  v_exp_f32 v111, v111
  v_cvt_pk_bf16_f32 v134, v108, v109
  v_cvt_pk_bf16_f32 v135, v110, v111
  v_mfma_f32_32x32x16_bf16 v[80:95], v[192:195], v[184:187], 0
  ds_read_b128 v[204:207], v253 offset:36864
  v_exp_f32 v112, v112
  v_exp_f32 v113, v113
  v_exp_f32 v114, v114
  v_exp_f32 v115, v115
  v_cvt_pk_bf16_f32 v136, v112, v113
  v_cvt_pk_bf16_f32 v137, v114, v115
  v_mfma_f32_32x32x8bf16_1k v[80:95], v[196:197], v[188:189], v[80:95]
  buffer_load_dwordx4 a[0:3], v2, s[8:11], s61 offen offset:0 sc1
  v_exp_f32 v116, v116
  v_exp_f32 v117, v117
  v_exp_f32 v118, v118
  v_exp_f32 v119, v119
  v_cvt_pk_bf16_f32 v138, v116, v117
  v_cvt_pk_bf16_f32 v139, v118, v119
  v_mfma_f32_32x32x16_bf16 v[144:159], v[220:223], v[132:135], v[144:159]
  buffer_load_dwordx4 a[4:7], v2, s[8:11], s61 offen offset:1024 sc1
  v_exp_f32 v120, v120
  v_exp_f32 v121, v121
  v_exp_f32 v122, v122
  v_exp_f32 v123, v123
  v_cvt_pk_bf16_f32 v140, v120, v121
  v_cvt_pk_bf16_f32 v141, v122, v123
  v_mfma_f32_32x32x16_bf16 v[160:175], v[216:219], v[136:139], v[160:175]
  s_waitcnt lgkmcnt(0)
  v_exp_f32 v124, v124
  v_exp_f32 v125, v125
  v_exp_f32 v126, v126
  v_exp_f32 v127, v127
  v_cvt_pk_bf16_f32 v142, v124, v125
  v_cvt_pk_bf16_f32 v143, v126, v127
  v_mfma_f32_32x32x16_bf16 v[96:111], v[208:211], v[176:179], 0
  ds_read_b128 v[192:195], v224 offset:43008
  v_exp_f32 v64, v64
  v_exp_f32 v65, v65
  v_exp_f32 v66, v66
  v_exp_f32 v67, v67
  v_cvt_pk_bf16_f32 v128, v64, v65
  v_cvt_pk_bf16_f32 v129, v66, v67
  v_mfma_f32_32x32x8bf16_1k v[96:111], v[212:213], v[180:181], v[96:111]
  ds_read_b64 v[196:197], v225 offset:43008
  v_exp_f32 v68, v68
  v_exp_f32 v69, v69
  v_exp_f32 v70, v70
  v_exp_f32 v71, v71
  v_cvt_pk_bf16_f32 v130, v68, v69
  v_cvt_pk_bf16_f32 v131, v70, v71
  v_mfma_f32_32x32x16_bf16 v[160:175], v[220:223], v[140:143], v[160:175]
  buffer_load_dwordx4 a[8:11], v2, s[8:11], s61 offen offset:2048 sc1
  v_exp_f32 v72, v72
  v_exp_f32 v73, v73
  v_exp_f32 v74, v74
  v_exp_f32 v75, v75
  v_cvt_pk_bf16_f32 v132, v72, v73
  v_cvt_pk_bf16_f32 v133, v74, v75
  v_mfma_f32_32x32x16_bf16 v[144:159], v[200:203], v[128:131], v[144:159]
  ds_read_b128 v[216:219], v226 offset:39936
  v_exp_f32 v76, v76
  v_exp_f32 v77, v77
  v_exp_f32 v78, v78
  v_exp_f32 v79, v79
  v_cvt_pk_bf16_f32 v134, v76, v77
  v_cvt_pk_bf16_f32 v135, v78, v79
  v_mfma_f32_32x32x16_bf16 v[112:127], v[208:211], v[184:187], 0
  ds_read_b128 v[220:223], v253 offset:39936
  v_exp_f32 v80, v80
  v_exp_f32 v81, v81
  v_exp_f32 v82, v82
  v_exp_f32 v83, v83
  v_cvt_pk_bf16_f32 v136, v80, v81
  v_cvt_pk_bf16_f32 v137, v82, v83
  v_mfma_f32_32x32x8bf16_1k v[112:127], v[212:213], v[188:189], v[112:127]
  buffer_load_dwordx4 a[12:15], v2, s[8:11], s61 offen offset:3072 sc1
  v_exp_f32 v84, v84
  v_exp_f32 v85, v85
  v_exp_f32 v86, v86
  v_exp_f32 v87, v87
  v_cvt_pk_bf16_f32 v138, v84, v85
  v_cvt_pk_bf16_f32 v139, v86, v87
  v_mfma_f32_32x32x16_bf16 v[144:159], v[204:207], v[132:135], v[144:159]
  s_add_u32 s61, s61, 4096
  buffer_load_dwordx4 a[16:19], v2, s[8:11], s61 offen offset:0 sc1
  v_exp_f32 v88, v88
  v_exp_f32 v89, v89
  v_exp_f32 v90, v90
  v_exp_f32 v91, v91
  v_cvt_pk_bf16_f32 v140, v88, v89
  v_cvt_pk_bf16_f32 v141, v90, v91
  v_mfma_f32_32x32x16_bf16 v[160:175], v[200:203], v[136:139], v[160:175]
  s_waitcnt lgkmcnt(0)
  v_exp_f32 v92, v92
  v_exp_f32 v93, v93
  v_exp_f32 v94, v94
  v_exp_f32 v95, v95
  v_cvt_pk_bf16_f32 v142, v92, v93
  v_cvt_pk_bf16_f32 v143, v94, v95
  v_mfma_f32_32x32x16_bf16 v[64:79], v[192:195], v[176:179], 0
  ds_read_b128 v[208:211], v224 offset:46080
  v_exp_f32 v96, v96
  v_exp_f32 v97, v97
  v_exp_f32 v98, v98
  v_exp_f32 v99, v99
  v_cvt_pk_bf16_f32 v128, v96, v97
  v_cvt_pk_bf16_f32 v129, v98, v99
  v_mfma_f32_32x32x8bf16_1k v[64:79], v[196:197], v[180:181], v[64:79]
  ds_read_b64 v[212:213], v225 offset:46080
  v_exp_f32 v100, v100
  v_exp_f32 v101, v101
  v_exp_f32 v102, v102
  v_exp_f32 v103, v103
  v_cvt_pk_bf16_f32 v130, v100, v101
  v_cvt_pk_bf16_f32 v131, v102, v103
  v_mfma_f32_32x32x16_bf16 v[160:175], v[204:207], v[140:143], v[160:175]
  buffer_load_dwordx4 a[20:23], v2, s[8:11], s61 offen offset:1024 sc1
  v_exp_f32 v104, v104
  v_exp_f32 v105, v105
  v_exp_f32 v106, v106
  v_exp_f32 v107, v107
  v_cvt_pk_bf16_f32 v132, v104, v105
  v_cvt_pk_bf16_f32 v133, v106, v107
  v_mfma_f32_32x32x16_bf16 v[144:159], v[216:219], v[128:131], v[144:159]
  ds_read_b128 v[200:203], v226 offset:43008
  v_exp_f32 v108, v108
  v_exp_f32 v109, v109
  v_exp_f32 v110, v110
  v_exp_f32 v111, v111
  v_cvt_pk_bf16_f32 v134, v108, v109
  v_cvt_pk_bf16_f32 v135, v110, v111
  v_mfma_f32_32x32x16_bf16 v[80:95], v[192:195], v[184:187], 0
  ds_read_b128 v[204:207], v253 offset:43008
  v_exp_f32 v112, v112
  v_exp_f32 v113, v113
  v_exp_f32 v114, v114
  v_exp_f32 v115, v115
  v_cvt_pk_bf16_f32 v136, v112, v113
  v_cvt_pk_bf16_f32 v137, v114, v115
  v_mfma_f32_32x32x8bf16_1k v[80:95], v[196:197], v[188:189], v[80:95]
  buffer_load_dwordx4 a[24:27], v2, s[8:11], s61 offen offset:2048 sc1
  v_exp_f32 v116, v116
  v_exp_f32 v117, v117
  v_exp_f32 v118, v118
  v_exp_f32 v119, v119
  v_cvt_pk_bf16_f32 v138, v116, v117
  v_cvt_pk_bf16_f32 v139, v118, v119
  v_mfma_f32_32x32x16_bf16 v[144:159], v[220:223], v[132:135], v[144:159]
  buffer_load_dwordx4 a[28:31], v2, s[8:11], s61 offen offset:3072 sc1
  v_exp_f32 v120, v120
  v_exp_f32 v121, v121
  v_exp_f32 v122, v122
  v_exp_f32 v123, v123
  v_cvt_pk_bf16_f32 v140, v120, v121
  v_cvt_pk_bf16_f32 v141, v122, v123
  v_mfma_f32_32x32x16_bf16 v[160:175], v[216:219], v[136:139], v[160:175]
  s_waitcnt lgkmcnt(0)
  v_exp_f32 v124, v124
  v_exp_f32 v125, v125
  v_exp_f32 v126, v126
  v_exp_f32 v127, v127
  v_cvt_pk_bf16_f32 v142, v124, v125
  v_cvt_pk_bf16_f32 v143, v126, v127
  s_waitcnt vmcnt(21)
  s_barrier
  v_mfma_f32_32x32x16_bf16 v[96:111], v[208:211], v[176:179], 0
  ds_read_b128 v[192:195], v224 offset:0
  v_exp_f32 v64, v64
  v_exp_f32 v65, v65
  v_exp_f32 v66, v66
  v_exp_f32 v67, v67
  v_cvt_pk_bf16_f32 v128, v64, v65
  v_cvt_pk_bf16_f32 v129, v66, v67
  v_mfma_f32_32x32x8bf16_1k v[96:111], v[212:213], v[180:181], v[96:111]
  ds_read_b64 v[196:197], v225 offset:0
  v_exp_f32 v68, v68
  v_exp_f32 v69, v69
  v_exp_f32 v70, v70
  v_exp_f32 v71, v71
  v_cvt_pk_bf16_f32 v130, v68, v69
  v_cvt_pk_bf16_f32 v131, v70, v71
  v_mfma_f32_32x32x16_bf16 v[160:175], v[220:223], v[140:143], v[160:175]
  s_add_u32 m0, s54, 126976
  s_nop 0
  buffer_load_dwordx4 v2, s[8:11], s55 offen offset:0 sc1 lds
  v_exp_f32 v72, v72
  v_exp_f32 v73, v73
  v_exp_f32 v74, v74
  v_exp_f32 v75, v75
  v_cvt_pk_bf16_f32 v132, v72, v73
  v_cvt_pk_bf16_f32 v133, v74, v75
  v_mfma_f32_32x32x16_bf16 v[144:159], v[200:203], v[128:131], v[144:159]
  ds_read_b128 v[216:219], v226 offset:46080
  v_exp_f32 v76, v76
  v_exp_f32 v77, v77
  v_exp_f32 v78, v78
  v_exp_f32 v79, v79
  v_cvt_pk_bf16_f32 v134, v76, v77
  v_cvt_pk_bf16_f32 v135, v78, v79
  v_mfma_f32_32x32x16_bf16 v[112:127], v[208:211], v[184:187], 0
  ds_read_b128 v[220:223], v253 offset:46080
  v_exp_f32 v80, v80
  v_exp_f32 v81, v81
  v_exp_f32 v82, v82
  v_exp_f32 v83, v83
  v_cvt_pk_bf16_f32 v136, v80, v81
  v_cvt_pk_bf16_f32 v137, v82, v83
  v_mfma_f32_32x32x8bf16_1k v[112:127], v[212:213], v[188:189], v[112:127]
  buffer_load_dwordx4 v2, s[8:11], s55 offen offset:1024 sc1 lds
  v_exp_f32 v84, v84
  v_exp_f32 v85, v85
  v_exp_f32 v86, v86
  v_exp_f32 v87, v87
  v_cvt_pk_bf16_f32 v138, v84, v85
  v_cvt_pk_bf16_f32 v139, v86, v87
  v_mfma_f32_32x32x16_bf16 v[144:159], v[204:207], v[132:135], v[144:159]
  buffer_load_dwordx4 v2, s[8:11], s55 offen offset:2048 sc1 lds
  s_add_u32 s55, s55, 12288
  v_exp_f32 v88, v88
  v_exp_f32 v89, v89
  v_exp_f32 v90, v90
  v_exp_f32 v91, v91
  v_cvt_pk_bf16_f32 v140, v88, v89
  v_cvt_pk_bf16_f32 v141, v90, v91
  v_mfma_f32_32x32x16_bf16 v[160:175], v[200:203], v[136:139], v[160:175]
  s_waitcnt lgkmcnt(0)
  v_exp_f32 v92, v92
  v_exp_f32 v93, v93
  v_exp_f32 v94, v94
  v_exp_f32 v95, v95
  v_cvt_pk_bf16_f32 v142, v92, v93
  v_cvt_pk_bf16_f32 v143, v94, v95
  v_mfma_f32_32x32x16_bf16 v[64:79], v[192:195], v[176:179], 0
  ds_read_b128 v[208:211], v224 offset:3072
  v_exp_f32 v96, v96
  v_exp_f32 v97, v97
  v_exp_f32 v98, v98
  v_exp_f32 v99, v99
  v_cvt_pk_bf16_f32 v128, v96, v97
  v_cvt_pk_bf16_f32 v129, v98, v99
  v_mfma_f32_32x32x8bf16_1k v[64:79], v[196:197], v[180:181], v[64:79]
  ds_read_b64 v[212:213], v225 offset:3072
  v_exp_f32 v100, v100
  v_exp_f32 v101, v101
  v_exp_f32 v102, v102
  v_exp_f32 v103, v103
  v_cvt_pk_bf16_f32 v130, v100, v101
  v_cvt_pk_bf16_f32 v131, v102, v103
  v_mfma_f32_32x32x16_bf16 v[160:175], v[204:207], v[140:143], v[160:175]
  s_add_u32 s61, s61, 4096
  buffer_load_dwordx4 a[32:35], v2, s[8:11], s61 offen offset:0 sc1
  v_exp_f32 v104, v104
  v_exp_f32 v105, v105
  v_exp_f32 v106, v106
  v_exp_f32 v107, v107
  v_cvt_pk_bf16_f32 v132, v104, v105
  v_cvt_pk_bf16_f32 v133, v106, v107
  v_mfma_f32_32x32x16_bf16 v[144:159], v[216:219], v[128:131], v[144:159]
  ds_read_b128 v[200:203], v226 offset:0
  v_exp_f32 v108, v108
  v_exp_f32 v109, v109
  v_exp_f32 v110, v110
  v_exp_f32 v111, v111
  v_cvt_pk_bf16_f32 v134, v108, v109
  v_cvt_pk_bf16_f32 v135, v110, v111
  v_mfma_f32_32x32x16_bf16 v[80:95], v[192:195], v[184:187], 0
  ds_read_b128 v[204:207], v253 offset:0
  v_exp_f32 v112, v112
  v_exp_f32 v113, v113
  v_exp_f32 v114, v114
  v_exp_f32 v115, v115
  v_cvt_pk_bf16_f32 v136, v112, v113
  v_cvt_pk_bf16_f32 v137, v114, v115
  v_mfma_f32_32x32x8bf16_1k v[80:95], v[196:197], v[188:189], v[80:95]
  buffer_load_dwordx4 a[36:39], v2, s[8:11], s61 offen offset:1024 sc1
  v_exp_f32 v116, v116
  v_exp_f32 v117, v117
  v_exp_f32 v118, v118
  v_exp_f32 v119, v119
  v_cvt_pk_bf16_f32 v138, v116, v117
  v_cvt_pk_bf16_f32 v139, v118, v119
  v_mfma_f32_32x32x16_bf16 v[144:159], v[220:223], v[132:135], v[144:159]
  buffer_load_dwordx4 a[40:43], v2, s[8:11], s61 offen offset:2048 sc1
  v_exp_f32 v120, v120
  v_exp_f32 v121, v121
  v_exp_f32 v122, v122
  v_exp_f32 v123, v123
  v_cvt_pk_bf16_f32 v140, v120, v121
  v_cvt_pk_bf16_f32 v141, v122, v123
  v_mfma_f32_32x32x16_bf16 v[160:175], v[216:219], v[136:139], v[160:175]
  s_waitcnt lgkmcnt(0)
  v_exp_f32 v124, v124
  v_exp_f32 v125, v125
  v_exp_f32 v126, v126
  v_exp_f32 v127, v127
  v_cvt_pk_bf16_f32 v142, v124, v125
  v_cvt_pk_bf16_f32 v143, v126, v127
  v_mfma_f32_32x32x16_bf16 v[96:111], v[208:211], v[176:179], 0
  ds_read_b128 v[192:195], v224 offset:6144
  v_exp_f32 v64, v64
  v_exp_f32 v65, v65
  v_exp_f32 v66, v66
  v_exp_f32 v67, v67
  v_cvt_pk_bf16_f32 v128, v64, v65
  v_cvt_pk_bf16_f32 v129, v66, v67
  v_mfma_f32_32x32x8bf16_1k v[96:111], v[212:213], v[180:181], v[96:111]
  ds_read_b64 v[196:197], v225 offset:6144
  v_exp_f32 v68, v68
  v_exp_f32 v69, v69
  v_exp_f32 v70, v70
  v_exp_f32 v71, v71
  v_cvt_pk_bf16_f32 v130, v68, v69
  v_cvt_pk_bf16_f32 v131, v70, v71
  v_mfma_f32_32x32x16_bf16 v[160:175], v[220:223], v[140:143], v[160:175]
  buffer_load_dwordx4 a[44:47], v2, s[8:11], s61 offen offset:3072 sc1
  v_exp_f32 v72, v72
  v_exp_f32 v73, v73
  v_exp_f32 v74, v74
  v_exp_f32 v75, v75
  v_cvt_pk_bf16_f32 v132, v72, v73
  v_cvt_pk_bf16_f32 v133, v74, v75
  v_mfma_f32_32x32x16_bf16 v[144:159], v[200:203], v[128:131], v[144:159]
  ds_read_b128 v[216:219], v226 offset:3072
  v_exp_f32 v76, v76
  v_exp_f32 v77, v77
  v_exp_f32 v78, v78
  v_exp_f32 v79, v79
  v_cvt_pk_bf16_f32 v134, v76, v77
  v_cvt_pk_bf16_f32 v135, v78, v79
  v_mfma_f32_32x32x16_bf16 v[112:127], v[208:211], v[184:187], 0
  ds_read_b128 v[220:223], v253 offset:3072
  v_exp_f32 v80, v80
  v_exp_f32 v81, v81
  v_exp_f32 v82, v82
  v_exp_f32 v83, v83
  v_cvt_pk_bf16_f32 v136, v80, v81
  v_cvt_pk_bf16_f32 v137, v82, v83
  v_mfma_f32_32x32x8bf16_1k v[112:127], v[212:213], v[188:189], v[112:127]
  s_add_u32 s61, s61, 4096
  buffer_load_dwordx4 a[48:51], v2, s[8:11], s61 offen offset:0 sc1
  v_exp_f32 v84, v84
  v_exp_f32 v85, v85
  v_exp_f32 v86, v86
  v_exp_f32 v87, v87
  v_cvt_pk_bf16_f32 v138, v84, v85
  v_cvt_pk_bf16_f32 v139, v86, v87
  v_mfma_f32_32x32x16_bf16 v[144:159], v[204:207], v[132:135], v[144:159]
  buffer_load_dwordx4 a[52:55], v2, s[8:11], s61 offen offset:1024 sc1
  v_exp_f32 v88, v88
  v_exp_f32 v89, v89
  v_exp_f32 v90, v90
  v_exp_f32 v91, v91
  v_cvt_pk_bf16_f32 v140, v88, v89
  v_cvt_pk_bf16_f32 v141, v90, v91
  v_mfma_f32_32x32x16_bf16 v[160:175], v[200:203], v[136:139], v[160:175]
  s_waitcnt lgkmcnt(0)
  v_exp_f32 v92, v92
  v_exp_f32 v93, v93
  v_exp_f32 v94, v94
  v_exp_f32 v95, v95
  v_cvt_pk_bf16_f32 v142, v92, v93
  v_cvt_pk_bf16_f32 v143, v94, v95
  v_mfma_f32_32x32x16_bf16 v[64:79], v[192:195], v[176:179], 0
  ds_read_b128 v[208:211], v224 offset:9216
  v_exp_f32 v96, v96
  v_exp_f32 v97, v97
  v_exp_f32 v98, v98
  v_exp_f32 v99, v99
  v_cvt_pk_bf16_f32 v128, v96, v97
  v_cvt_pk_bf16_f32 v129, v98, v99
  v_mfma_f32_32x32x8bf16_1k v[64:79], v[196:197], v[180:181], v[64:79]
  ds_read_b64 v[212:213], v225 offset:9216
  v_exp_f32 v100, v100
  v_exp_f32 v101, v101
  v_exp_f32 v102, v102
  v_exp_f32 v103, v103
  v_cvt_pk_bf16_f32 v130, v100, v101
  v_cvt_pk_bf16_f32 v131, v102, v103
  v_mfma_f32_32x32x16_bf16 v[160:175], v[204:207], v[140:143], v[160:175]
  buffer_load_dwordx4 a[56:59], v2, s[8:11], s61 offen offset:2048 sc1
  v_exp_f32 v104, v104
  v_exp_f32 v105, v105
  v_exp_f32 v106, v106
  v_exp_f32 v107, v107
  v_cvt_pk_bf16_f32 v132, v104, v105
  v_cvt_pk_bf16_f32 v133, v106, v107
  v_mfma_f32_32x32x16_bf16 v[144:159], v[216:219], v[128:131], v[144:159]
  ds_read_b128 v[200:203], v226 offset:6144
  v_exp_f32 v108, v108
  v_exp_f32 v109, v109
  v_exp_f32 v110, v110
  v_exp_f32 v111, v111
  v_cvt_pk_bf16_f32 v134, v108, v109
  v_cvt_pk_bf16_f32 v135, v110, v111
  v_mfma_f32_32x32x16_bf16 v[80:95], v[192:195], v[184:187], 0
  ds_read_b128 v[204:207], v253 offset:6144
  v_exp_f32 v112, v112
  v_exp_f32 v113, v113
  v_exp_f32 v114, v114
  v_exp_f32 v115, v115
  v_cvt_pk_bf16_f32 v136, v112, v113
  v_cvt_pk_bf16_f32 v137, v114, v115
  v_mfma_f32_32x32x8bf16_1k v[80:95], v[196:197], v[188:189], v[80:95]
  buffer_load_dwordx4 a[60:63], v2, s[8:11], s61 offen offset:3072 sc1
  v_exp_f32 v116, v116
  v_exp_f32 v117, v117
  v_exp_f32 v118, v118
  v_exp_f32 v119, v119
  v_cvt_pk_bf16_f32 v138, v116, v117
  v_cvt_pk_bf16_f32 v139, v118, v119
  v_mfma_f32_32x32x16_bf16 v[144:159], v[220:223], v[132:135], v[144:159]
  s_add_u32 s61, s61, 4096
  buffer_load_dwordx4 a[64:67], v2, s[8:11], s61 offen offset:0 sc1
  v_exp_f32 v120, v120
  v_exp_f32 v121, v121
  v_exp_f32 v122, v122
  v_exp_f32 v123, v123
  v_cvt_pk_bf16_f32 v140, v120, v121
  v_cvt_pk_bf16_f32 v141, v122, v123
  v_mfma_f32_32x32x16_bf16 v[160:175], v[216:219], v[136:139], v[160:175]
  s_waitcnt lgkmcnt(0)
  v_exp_f32 v124, v124
  v_exp_f32 v125, v125
  v_exp_f32 v126, v126
  v_exp_f32 v127, v127
  v_cvt_pk_bf16_f32 v142, v124, v125
  v_cvt_pk_bf16_f32 v143, v126, v127
  s_waitcnt vmcnt(21)
  s_barrier
  v_mfma_f32_32x32x16_bf16 v[96:111], v[208:211], v[176:179], 0
  ds_read_b128 v[192:195], v224 offset:12288
  v_exp_f32 v64, v64
  v_exp_f32 v65, v65
  v_exp_f32 v66, v66
  v_exp_f32 v67, v67
  v_cvt_pk_bf16_f32 v128, v64, v65
  v_cvt_pk_bf16_f32 v129, v66, v67
  v_mfma_f32_32x32x8bf16_1k v[96:111], v[212:213], v[180:181], v[96:111]
  ds_read_b64 v[196:197], v225 offset:12288
  v_exp_f32 v68, v68
  v_exp_f32 v69, v69
  v_exp_f32 v70, v70
  v_exp_f32 v71, v71
  v_cvt_pk_bf16_f32 v130, v68, v69
  v_cvt_pk_bf16_f32 v131, v70, v71
  v_mfma_f32_32x32x16_bf16 v[160:175], v[220:223], v[140:143], v[160:175]
  s_add_u32 m0, s54, 139264
  s_nop 0
  buffer_load_dwordx4 v2, s[8:11], s55 offen offset:0 sc1 lds
  v_exp_f32 v72, v72
  v_exp_f32 v73, v73
  v_exp_f32 v74, v74
  v_exp_f32 v75, v75
  v_cvt_pk_bf16_f32 v132, v72, v73
  v_cvt_pk_bf16_f32 v133, v74, v75
  v_mfma_f32_32x32x16_bf16 v[144:159], v[200:203], v[128:131], v[144:159]
  ds_read_b128 v[216:219], v226 offset:9216
  v_exp_f32 v76, v76
  v_exp_f32 v77, v77
  v_exp_f32 v78, v78
  v_exp_f32 v79, v79
  v_cvt_pk_bf16_f32 v134, v76, v77
  v_cvt_pk_bf16_f32 v135, v78, v79
  v_mfma_f32_32x32x16_bf16 v[112:127], v[208:211], v[184:187], 0
  ds_read_b128 v[220:223], v253 offset:9216
  v_exp_f32 v80, v80
  v_exp_f32 v81, v81
  v_exp_f32 v82, v82
  v_exp_f32 v83, v83
  v_cvt_pk_bf16_f32 v136, v80, v81
  v_cvt_pk_bf16_f32 v137, v82, v83
  v_mfma_f32_32x32x8bf16_1k v[112:127], v[212:213], v[188:189], v[112:127]
  buffer_load_dwordx4 v2, s[8:11], s55 offen offset:1024 sc1 lds
  v_exp_f32 v84, v84
  v_exp_f32 v85, v85
  v_exp_f32 v86, v86
  v_exp_f32 v87, v87
  v_cvt_pk_bf16_f32 v138, v84, v85
  v_cvt_pk_bf16_f32 v139, v86, v87
  v_mfma_f32_32x32x16_bf16 v[144:159], v[204:207], v[132:135], v[144:159]
  buffer_load_dwordx4 v2, s[8:11], s55 offen offset:2048 sc1 lds
  s_add_u32 s55, s55, 12288
  v_exp_f32 v88, v88
  v_exp_f32 v89, v89
  v_exp_f32 v90, v90
  v_exp_f32 v91, v91
  v_cvt_pk_bf16_f32 v140, v88, v89
  v_cvt_pk_bf16_f32 v141, v90, v91
  v_mfma_f32_32x32x16_bf16 v[160:175], v[200:203], v[136:139], v[160:175]
  s_waitcnt lgkmcnt(0)
  v_exp_f32 v92, v92
  v_exp_f32 v93, v93
  v_exp_f32 v94, v94
  v_exp_f32 v95, v95
  v_cvt_pk_bf16_f32 v142, v92, v93
  v_cvt_pk_bf16_f32 v143, v94, v95
  v_mfma_f32_32x32x16_bf16 v[64:79], v[192:195], v[176:179], 0
  ds_read_b128 v[208:211], v224 offset:15360
  v_exp_f32 v96, v96
  v_exp_f32 v97, v97
  v_exp_f32 v98, v98
  v_exp_f32 v99, v99
  v_cvt_pk_bf16_f32 v128, v96, v97
  v_cvt_pk_bf16_f32 v129, v98, v99
  v_mfma_f32_32x32x8bf16_1k v[64:79], v[196:197], v[180:181], v[64:79]
  ds_read_b64 v[212:213], v225 offset:15360
  v_exp_f32 v100, v100
  v_exp_f32 v101, v101
  v_exp_f32 v102, v102
  v_exp_f32 v103, v103
  v_cvt_pk_bf16_f32 v130, v100, v101
  v_cvt_pk_bf16_f32 v131, v102, v103
  v_mfma_f32_32x32x16_bf16 v[160:175], v[204:207], v[140:143], v[160:175]
  buffer_load_dwordx4 a[68:71], v2, s[8:11], s61 offen offset:1024 sc1
  v_exp_f32 v104, v104
  v_exp_f32 v105, v105
  v_exp_f32 v106, v106
  v_exp_f32 v107, v107
  v_cvt_pk_bf16_f32 v132, v104, v105
  v_cvt_pk_bf16_f32 v133, v106, v107
  v_mfma_f32_32x32x16_bf16 v[144:159], v[216:219], v[128:131], v[144:159]
  ds_read_b128 v[200:203], v226 offset:12288
  v_exp_f32 v108, v108
  v_exp_f32 v109, v109
  v_exp_f32 v110, v110
  v_exp_f32 v111, v111
  v_cvt_pk_bf16_f32 v134, v108, v109
  v_cvt_pk_bf16_f32 v135, v110, v111
  v_mfma_f32_32x32x16_bf16 v[80:95], v[192:195], v[184:187], 0
  ds_read_b128 v[204:207], v253 offset:12288
  v_exp_f32 v112, v112
  v_exp_f32 v113, v113
  v_exp_f32 v114, v114
  v_exp_f32 v115, v115
  v_cvt_pk_bf16_f32 v136, v112, v113
  v_cvt_pk_bf16_f32 v137, v114, v115
  v_mfma_f32_32x32x8bf16_1k v[80:95], v[196:197], v[188:189], v[80:95]
  buffer_load_dwordx4 a[72:75], v2, s[8:11], s61 offen offset:2048 sc1
  v_exp_f32 v116, v116
  v_exp_f32 v117, v117
  v_exp_f32 v118, v118
  v_exp_f32 v119, v119
  v_cvt_pk_bf16_f32 v138, v116, v117
  v_cvt_pk_bf16_f32 v139, v118, v119
  v_mfma_f32_32x32x16_bf16 v[144:159], v[220:223], v[132:135], v[144:159]
  buffer_load_dwordx4 a[76:79], v2, s[8:11], s61 offen offset:3072 sc1
  v_exp_f32 v120, v120
  v_exp_f32 v121, v121
  v_exp_f32 v122, v122
  v_exp_f32 v123, v123
  v_cvt_pk_bf16_f32 v140, v120, v121
  v_cvt_pk_bf16_f32 v141, v122, v123
  v_mfma_f32_32x32x16_bf16 v[160:175], v[216:219], v[136:139], v[160:175]
  s_waitcnt lgkmcnt(0)
  v_exp_f32 v124, v124
  v_exp_f32 v125, v125
  v_exp_f32 v126, v126
  v_exp_f32 v127, v127
  v_cvt_pk_bf16_f32 v142, v124, v125
  v_cvt_pk_bf16_f32 v143, v126, v127
  v_mfma_f32_32x32x16_bf16 v[96:111], v[208:211], v[176:179], 0
  ds_read_b128 v[192:195], v224 offset:18432
  v_exp_f32 v64, v64
  v_exp_f32 v65, v65
  v_exp_f32 v66, v66
  v_exp_f32 v67, v67
  v_cvt_pk_bf16_f32 v128, v64, v65
  v_cvt_pk_bf16_f32 v129, v66, v67
  v_mfma_f32_32x32x8bf16_1k v[96:111], v[212:213], v[180:181], v[96:111]
  ds_read_b64 v[196:197], v225 offset:18432
  v_exp_f32 v68, v68
  v_exp_f32 v69, v69
  v_exp_f32 v70, v70
  v_exp_f32 v71, v71
  v_cvt_pk_bf16_f32 v130, v68, v69
  v_cvt_pk_bf16_f32 v131, v70, v71
  v_mfma_f32_32x32x16_bf16 v[160:175], v[220:223], v[140:143], v[160:175]
  s_add_u32 s61, s61, 4096
  buffer_load_dwordx4 a[80:83], v2, s[8:11], s61 offen offset:0 sc1
  v_exp_f32 v72, v72
  v_exp_f32 v73, v73
  v_exp_f32 v74, v74
  v_exp_f32 v75, v75
  v_cvt_pk_bf16_f32 v132, v72, v73
  v_cvt_pk_bf16_f32 v133, v74, v75
  v_mfma_f32_32x32x16_bf16 v[144:159], v[200:203], v[128:131], v[144:159]
  ds_read_b128 v[216:219], v226 offset:15360
  v_exp_f32 v76, v76
  v_exp_f32 v77, v77
  v_exp_f32 v78, v78
  v_exp_f32 v79, v79
  v_cvt_pk_bf16_f32 v134, v76, v77
  v_cvt_pk_bf16_f32 v135, v78, v79
  v_mfma_f32_32x32x16_bf16 v[112:127], v[208:211], v[184:187], 0
  ds_read_b128 v[220:223], v253 offset:15360
  v_exp_f32 v80, v80
  v_exp_f32 v81, v81
  v_exp_f32 v82, v82
  v_exp_f32 v83, v83
  v_cvt_pk_bf16_f32 v136, v80, v81
  v_cvt_pk_bf16_f32 v137, v82, v83
  v_mfma_f32_32x32x8bf16_1k v[112:127], v[212:213], v[188:189], v[112:127]
  buffer_load_dwordx4 a[84:87], v2, s[8:11], s61 offen offset:1024 sc1
  v_exp_f32 v84, v84
  v_exp_f32 v85, v85
  v_exp_f32 v86, v86
  v_exp_f32 v87, v87
  v_cvt_pk_bf16_f32 v138, v84, v85
  v_cvt_pk_bf16_f32 v139, v86, v87
  v_mfma_f32_32x32x16_bf16 v[144:159], v[204:207], v[132:135], v[144:159]
  buffer_load_dwordx4 a[88:91], v2, s[8:11], s61 offen offset:2048 sc1
  v_exp_f32 v88, v88
  v_exp_f32 v89, v89
  v_exp_f32 v90, v90
  v_exp_f32 v91, v91
  v_cvt_pk_bf16_f32 v140, v88, v89
  v_cvt_pk_bf16_f32 v141, v90, v91
  v_mfma_f32_32x32x16_bf16 v[160:175], v[200:203], v[136:139], v[160:175]
  s_waitcnt lgkmcnt(0)
  v_exp_f32 v92, v92
  v_exp_f32 v93, v93
  v_exp_f32 v94, v94
  v_exp_f32 v95, v95
  v_cvt_pk_bf16_f32 v142, v92, v93
  v_cvt_pk_bf16_f32 v143, v94, v95
  v_mfma_f32_32x32x16_bf16 v[64:79], v[192:195], v[176:179], 0
  ds_read_b128 v[208:211], v224 offset:21504
  v_exp_f32 v96, v96
  v_exp_f32 v97, v97
  v_exp_f32 v98, v98
  v_exp_f32 v99, v99
  v_cvt_pk_bf16_f32 v128, v96, v97
  v_cvt_pk_bf16_f32 v129, v98, v99
  v_mfma_f32_32x32x8bf16_1k v[64:79], v[196:197], v[180:181], v[64:79]
  ds_read_b64 v[212:213], v225 offset:21504
  v_exp_f32 v100, v100
  v_exp_f32 v101, v101
  v_exp_f32 v102, v102
  v_exp_f32 v103, v103
  v_cvt_pk_bf16_f32 v130, v100, v101
  v_cvt_pk_bf16_f32 v131, v102, v103
  v_mfma_f32_32x32x16_bf16 v[160:175], v[204:207], v[140:143], v[160:175]
  buffer_load_dwordx4 a[92:95], v2, s[8:11], s61 offen offset:3072 sc1
  v_exp_f32 v104, v104
  v_exp_f32 v105, v105
  v_exp_f32 v106, v106
  v_exp_f32 v107, v107
  v_cvt_pk_bf16_f32 v132, v104, v105
  v_cvt_pk_bf16_f32 v133, v106, v107
  v_mfma_f32_32x32x16_bf16 v[144:159], v[216:219], v[128:131], v[144:159]
  ds_read_b128 v[200:203], v226 offset:18432
  v_exp_f32 v108, v108
  v_exp_f32 v109, v109
  v_exp_f32 v110, v110
  v_exp_f32 v111, v111
  v_cvt_pk_bf16_f32 v134, v108, v109
  v_cvt_pk_bf16_f32 v135, v110, v111
  v_mfma_f32_32x32x16_bf16 v[80:95], v[192:195], v[184:187], 0
  ds_read_b128 v[204:207], v253 offset:18432
  v_exp_f32 v112, v112
  v_exp_f32 v113, v113
  v_exp_f32 v114, v114
  v_exp_f32 v115, v115
  v_cvt_pk_bf16_f32 v136, v112, v113
  v_cvt_pk_bf16_f32 v137, v114, v115
  v_mfma_f32_32x32x8bf16_1k v[80:95], v[196:197], v[188:189], v[80:95]
  s_add_u32 s61, s61, 4096
  buffer_load_dwordx4 a[96:99], v2, s[8:11], s61 offen offset:0 sc1
  v_exp_f32 v116, v116
  v_exp_f32 v117, v117
  v_exp_f32 v118, v118
  v_exp_f32 v119, v119
  v_cvt_pk_bf16_f32 v138, v116, v117
  v_cvt_pk_bf16_f32 v139, v118, v119
  v_mfma_f32_32x32x16_bf16 v[144:159], v[220:223], v[132:135], v[144:159]
  buffer_load_dwordx4 a[100:103], v2, s[8:11], s61 offen offset:1024 sc1
  v_exp_f32 v120, v120
  v_exp_f32 v121, v121
  v_exp_f32 v122, v122
  v_exp_f32 v123, v123
  v_cvt_pk_bf16_f32 v140, v120, v121
  v_cvt_pk_bf16_f32 v141, v122, v123
  v_mfma_f32_32x32x16_bf16 v[160:175], v[216:219], v[136:139], v[160:175]
  s_waitcnt lgkmcnt(0)
  v_exp_f32 v124, v124
  v_exp_f32 v125, v125
  v_exp_f32 v126, v126
  v_exp_f32 v127, v127
  v_cvt_pk_bf16_f32 v142, v124, v125
  v_cvt_pk_bf16_f32 v143, v126, v127
  s_waitcnt vmcnt(21)
  s_barrier
  v_mfma_f32_32x32x16_bf16 v[96:111], v[208:211], v[176:179], 0
  ds_read_b128 v[192:195], v224 offset:24576
  v_exp_f32 v64, v64
  v_exp_f32 v65, v65
  v_exp_f32 v66, v66
  v_exp_f32 v67, v67
  v_cvt_pk_bf16_f32 v128, v64, v65
  v_cvt_pk_bf16_f32 v129, v66, v67
  v_mfma_f32_32x32x8bf16_1k v[96:111], v[212:213], v[180:181], v[96:111]
  ds_read_b64 v[196:197], v225 offset:24576
  v_exp_f32 v68, v68
  v_exp_f32 v69, v69
  v_exp_f32 v70, v70
  v_exp_f32 v71, v71
  v_cvt_pk_bf16_f32 v130, v68, v69
  v_cvt_pk_bf16_f32 v131, v70, v71
  v_mfma_f32_32x32x16_bf16 v[160:175], v[220:223], v[140:143], v[160:175]
  s_add_u32 m0, s54, 102400
  s_nop 0
  buffer_load_dwordx4 v2, s[8:11], s55 offen offset:0 sc1 lds
  v_exp_f32 v72, v72
  v_exp_f32 v73, v73
  v_exp_f32 v74, v74
  v_exp_f32 v75, v75
  v_cvt_pk_bf16_f32 v132, v72, v73
  v_cvt_pk_bf16_f32 v133, v74, v75
  v_mfma_f32_32x32x16_bf16 v[144:159], v[200:203], v[128:131], v[144:159]
  ds_read_b128 v[216:219], v226 offset:21504
  v_exp_f32 v76, v76
  v_exp_f32 v77, v77
  v_exp_f32 v78, v78
  v_exp_f32 v79, v79
  v_cvt_pk_bf16_f32 v134, v76, v77
  v_cvt_pk_bf16_f32 v135, v78, v79
  v_mfma_f32_32x32x16_bf16 v[112:127], v[208:211], v[184:187], 0
  ds_read_b128 v[220:223], v253 offset:21504
  v_exp_f32 v80, v80
  v_exp_f32 v81, v81
  v_exp_f32 v82, v82
  v_exp_f32 v83, v83
  v_cvt_pk_bf16_f32 v136, v80, v81
  v_cvt_pk_bf16_f32 v137, v82, v83
  v_mfma_f32_32x32x8bf16_1k v[112:127], v[212:213], v[188:189], v[112:127]
  buffer_load_dwordx4 v2, s[8:11], s55 offen offset:1024 sc1 lds
  v_exp_f32 v84, v84
  v_exp_f32 v85, v85
  v_exp_f32 v86, v86
  v_exp_f32 v87, v87
  v_cvt_pk_bf16_f32 v138, v84, v85
  v_cvt_pk_bf16_f32 v139, v86, v87
  v_mfma_f32_32x32x16_bf16 v[144:159], v[204:207], v[132:135], v[144:159]
  buffer_load_dwordx4 v2, s[8:11], s55 offen offset:2048 sc1 lds
  s_add_u32 s55, s55, 12288
  v_exp_f32 v88, v88
  v_exp_f32 v89, v89
  v_exp_f32 v90, v90
  v_exp_f32 v91, v91
  v_cvt_pk_bf16_f32 v140, v88, v89
  v_cvt_pk_bf16_f32 v141, v90, v91
  v_mfma_f32_32x32x16_bf16 v[160:175], v[200:203], v[136:139], v[160:175]
  s_waitcnt lgkmcnt(0)
  v_exp_f32 v92, v92
  v_exp_f32 v93, v93
  v_exp_f32 v94, v94
  v_exp_f32 v95, v95
  v_cvt_pk_bf16_f32 v142, v92, v93
  v_cvt_pk_bf16_f32 v143, v94, v95
  v_mfma_f32_32x32x16_bf16 v[64:79], v[192:195], v[176:179], 0
  ds_read_b128 v[208:211], v224 offset:27648
  v_exp_f32 v96, v96
  v_exp_f32 v97, v97
  v_exp_f32 v98, v98
  v_exp_f32 v99, v99
  v_cvt_pk_bf16_f32 v128, v96, v97
  v_cvt_pk_bf16_f32 v129, v98, v99
  v_mfma_f32_32x32x8bf16_1k v[64:79], v[196:197], v[180:181], v[64:79]
  ds_read_b64 v[212:213], v225 offset:27648
  v_exp_f32 v100, v100
  v_exp_f32 v101, v101
  v_exp_f32 v102, v102
  v_exp_f32 v103, v103
  v_cvt_pk_bf16_f32 v130, v100, v101
  v_cvt_pk_bf16_f32 v131, v102, v103
  v_mfma_f32_32x32x16_bf16 v[160:175], v[204:207], v[140:143], v[160:175]
  buffer_load_dwordx4 a[104:107], v2, s[8:11], s61 offen offset:2048 sc1
  v_exp_f32 v104, v104
  v_exp_f32 v105, v105
  v_exp_f32 v106, v106
  v_exp_f32 v107, v107
  v_cvt_pk_bf16_f32 v132, v104, v105
  v_cvt_pk_bf16_f32 v133, v106, v107
  v_mfma_f32_32x32x16_bf16 v[144:159], v[216:219], v[128:131], v[144:159]
  ds_read_b128 v[200:203], v226 offset:24576
  v_exp_f32 v108, v108
  v_exp_f32 v109, v109
  v_exp_f32 v110, v110
  v_exp_f32 v111, v111
  v_cvt_pk_bf16_f32 v134, v108, v109
  v_cvt_pk_bf16_f32 v135, v110, v111
  v_mfma_f32_32x32x16_bf16 v[80:95], v[192:195], v[184:187], 0
  ds_read_b128 v[204:207], v253 offset:24576
  v_exp_f32 v112, v112
  v_exp_f32 v113, v113
  v_exp_f32 v114, v114
  v_exp_f32 v115, v115
  v_cvt_pk_bf16_f32 v136, v112, v113
  v_cvt_pk_bf16_f32 v137, v114, v115
  v_mfma_f32_32x32x8bf16_1k v[80:95], v[196:197], v[188:189], v[80:95]
  buffer_load_dwordx4 a[108:111], v2, s[8:11], s61 offen offset:3072 sc1
  v_exp_f32 v116, v116
  v_exp_f32 v117, v117
  v_exp_f32 v118, v118
  v_exp_f32 v119, v119
  v_cvt_pk_bf16_f32 v138, v116, v117
  v_cvt_pk_bf16_f32 v139, v118, v119
  v_mfma_f32_32x32x16_bf16 v[144:159], v[220:223], v[132:135], v[144:159]
  s_add_u32 s61, s61, 4096
  buffer_load_dwordx4 a[112:115], v2, s[8:11], s61 offen offset:0 sc1
  v_exp_f32 v120, v120
  v_exp_f32 v121, v121
  v_exp_f32 v122, v122
  v_exp_f32 v123, v123
  v_cvt_pk_bf16_f32 v140, v120, v121
  v_cvt_pk_bf16_f32 v141, v122, v123
  v_mfma_f32_32x32x16_bf16 v[160:175], v[216:219], v[136:139], v[160:175]
  s_waitcnt lgkmcnt(0)
  v_exp_f32 v124, v124
  v_exp_f32 v125, v125
  v_exp_f32 v126, v126
  v_exp_f32 v127, v127
  v_cvt_pk_bf16_f32 v142, v124, v125
  v_cvt_pk_bf16_f32 v143, v126, v127
  v_mfma_f32_32x32x16_bf16 v[96:111], v[208:211], v[176:179], 0
  ds_read_b128 v[192:195], v224 offset:30720
  v_exp_f32 v64, v64
  v_exp_f32 v65, v65
  v_exp_f32 v66, v66
  v_exp_f32 v67, v67
  v_cvt_pk_bf16_f32 v128, v64, v65
  v_cvt_pk_bf16_f32 v129, v66, v67
  v_mfma_f32_32x32x8bf16_1k v[96:111], v[212:213], v[180:181], v[96:111]
  ds_read_b64 v[196:197], v225 offset:30720
  v_exp_f32 v68, v68
  v_exp_f32 v69, v69
  v_exp_f32 v70, v70
  v_exp_f32 v71, v71
  v_cvt_pk_bf16_f32 v130, v68, v69
  v_cvt_pk_bf16_f32 v131, v70, v71
  v_mfma_f32_32x32x16_bf16 v[160:175], v[220:223], v[140:143], v[160:175]
  buffer_load_dwordx4 a[116:119], v2, s[8:11], s61 offen offset:1024 sc1
  v_exp_f32 v72, v72
  v_exp_f32 v73, v73
  v_exp_f32 v74, v74
  v_exp_f32 v75, v75
  v_cvt_pk_bf16_f32 v132, v72, v73
  v_cvt_pk_bf16_f32 v133, v74, v75
  v_mfma_f32_32x32x16_bf16 v[144:159], v[200:203], v[128:131], v[144:159]
  ds_read_b128 v[216:219], v226 offset:27648
  v_exp_f32 v76, v76
  v_exp_f32 v77, v77
  v_exp_f32 v78, v78
  v_exp_f32 v79, v79
  v_cvt_pk_bf16_f32 v134, v76, v77
  v_cvt_pk_bf16_f32 v135, v78, v79
  v_mfma_f32_32x32x16_bf16 v[112:127], v[208:211], v[184:187], 0
  ds_read_b128 v[220:223], v253 offset:27648
  v_exp_f32 v80, v80
  v_exp_f32 v81, v81
  v_exp_f32 v82, v82
  v_exp_f32 v83, v83
  v_cvt_pk_bf16_f32 v136, v80, v81
  v_cvt_pk_bf16_f32 v137, v82, v83
  v_mfma_f32_32x32x8bf16_1k v[112:127], v[212:213], v[188:189], v[112:127]
  buffer_load_dwordx4 a[120:123], v2, s[8:11], s61 offen offset:2048 sc1
  v_exp_f32 v84, v84
  v_exp_f32 v85, v85
  v_exp_f32 v86, v86
  v_exp_f32 v87, v87
  v_cvt_pk_bf16_f32 v138, v84, v85
  v_cvt_pk_bf16_f32 v139, v86, v87
  v_mfma_f32_32x32x16_bf16 v[144:159], v[204:207], v[132:135], v[144:159]
  buffer_load_dwordx4 a[124:127], v2, s[8:11], s61 offen offset:3072 sc1
  v_exp_f32 v88, v88
  v_exp_f32 v89, v89
  v_exp_f32 v90, v90
  v_exp_f32 v91, v91
  v_cvt_pk_bf16_f32 v140, v88, v89
  v_cvt_pk_bf16_f32 v141, v90, v91
  v_mfma_f32_32x32x16_bf16 v[160:175], v[200:203], v[136:139], v[160:175]
  s_waitcnt lgkmcnt(0)
  v_exp_f32 v92, v92
  v_exp_f32 v93, v93
  v_exp_f32 v94, v94
  v_exp_f32 v95, v95
  v_cvt_pk_bf16_f32 v142, v92, v93
  v_cvt_pk_bf16_f32 v143, v94, v95
  v_mfma_f32_32x32x16_bf16 v[64:79], v[192:195], v[176:179], 0
  ds_read_b128 v[208:211], v224 offset:33792
  v_exp_f32 v96, v96
  v_exp_f32 v97, v97
  v_exp_f32 v98, v98
  v_exp_f32 v99, v99
  v_cvt_pk_bf16_f32 v128, v96, v97
  v_cvt_pk_bf16_f32 v129, v98, v99
  v_mfma_f32_32x32x8bf16_1k v[64:79], v[196:197], v[180:181], v[64:79]
  ds_read_b64 v[212:213], v225 offset:33792
  v_exp_f32 v100, v100
  v_exp_f32 v101, v101
  v_exp_f32 v102, v102
  v_exp_f32 v103, v103
  v_cvt_pk_bf16_f32 v130, v100, v101
  v_cvt_pk_bf16_f32 v131, v102, v103
  v_mfma_f32_32x32x16_bf16 v[160:175], v[204:207], v[140:143], v[160:175]
  s_add_u32 s61, s61, 4096
  buffer_load_dwordx4 a[128:131], v2, s[8:11], s61 offen offset:0 sc1
  v_exp_f32 v104, v104
  v_exp_f32 v105, v105
  v_exp_f32 v106, v106
  v_exp_f32 v107, v107
  v_cvt_pk_bf16_f32 v132, v104, v105
  v_cvt_pk_bf16_f32 v133, v106, v107
  v_mfma_f32_32x32x16_bf16 v[144:159], v[216:219], v[128:131], v[144:159]
  ds_read_b128 v[200:203], v226 offset:30720
  v_exp_f32 v108, v108
  v_exp_f32 v109, v109
  v_exp_f32 v110, v110
  v_exp_f32 v111, v111
  v_cvt_pk_bf16_f32 v134, v108, v109
  v_cvt_pk_bf16_f32 v135, v110, v111
  v_mfma_f32_32x32x16_bf16 v[80:95], v[192:195], v[184:187], 0
  ds_read_b128 v[204:207], v253 offset:30720
  v_exp_f32 v112, v112
  v_exp_f32 v113, v113
  v_exp_f32 v114, v114
  v_exp_f32 v115, v115
  v_cvt_pk_bf16_f32 v136, v112, v113
  v_cvt_pk_bf16_f32 v137, v114, v115
  v_mfma_f32_32x32x8bf16_1k v[80:95], v[196:197], v[188:189], v[80:95]
  buffer_load_dwordx4 a[132:135], v2, s[8:11], s61 offen offset:1024 sc1
  v_exp_f32 v116, v116
  v_exp_f32 v117, v117
  v_exp_f32 v118, v118
  v_exp_f32 v119, v119
  v_cvt_pk_bf16_f32 v138, v116, v117
  v_cvt_pk_bf16_f32 v139, v118, v119
  v_mfma_f32_32x32x16_bf16 v[144:159], v[220:223], v[132:135], v[144:159]
  buffer_load_dwordx4 a[136:139], v2, s[8:11], s61 offen offset:2048 sc1
  v_exp_f32 v120, v120
  v_exp_f32 v121, v121
  v_exp_f32 v122, v122
  v_exp_f32 v123, v123
  v_cvt_pk_bf16_f32 v140, v120, v121
  v_cvt_pk_bf16_f32 v141, v122, v123
  v_mfma_f32_32x32x16_bf16 v[160:175], v[216:219], v[136:139], v[160:175]
  s_waitcnt lgkmcnt(0)
  v_exp_f32 v124, v124
  v_exp_f32 v125, v125
  v_exp_f32 v126, v126
  v_exp_f32 v127, v127
  v_cvt_pk_bf16_f32 v142, v124, v125
  v_cvt_pk_bf16_f32 v143, v126, v127
  s_waitcnt vmcnt(21)
  s_barrier
  v_mfma_f32_32x32x16_bf16 v[96:111], v[208:211], v[176:179], 0
  ds_read_b128 v[192:195], v224 offset:36864
  v_exp_f32 v64, v64
  v_exp_f32 v65, v65
  v_exp_f32 v66, v66
  v_exp_f32 v67, v67
  v_cvt_pk_bf16_f32 v128, v64, v65
  v_cvt_pk_bf16_f32 v129, v66, v67
  v_mfma_f32_32x32x8bf16_1k v[96:111], v[212:213], v[180:181], v[96:111]
  ds_read_b64 v[196:197], v225 offset:36864
  v_exp_f32 v68, v68
  v_exp_f32 v69, v69
  v_exp_f32 v70, v70
  v_exp_f32 v71, v71
  v_cvt_pk_bf16_f32 v130, v68, v69
  v_cvt_pk_bf16_f32 v131, v70, v71
  v_mfma_f32_32x32x16_bf16 v[160:175], v[220:223], v[140:143], v[160:175]
  s_add_u32 m0, s54, 114688
  s_nop 0
  buffer_load_dwordx4 v2, s[8:11], s55 offen offset:0 sc1 lds
  v_exp_f32 v72, v72
  v_exp_f32 v73, v73
  v_exp_f32 v74, v74
  v_exp_f32 v75, v75
  v_cvt_pk_bf16_f32 v132, v72, v73
  v_cvt_pk_bf16_f32 v133, v74, v75
  v_mfma_f32_32x32x16_bf16 v[144:159], v[200:203], v[128:131], v[144:159]
  ds_read_b128 v[216:219], v226 offset:33792
  v_exp_f32 v76, v76
  v_exp_f32 v77, v77
  v_exp_f32 v78, v78
  v_exp_f32 v79, v79
  v_cvt_pk_bf16_f32 v134, v76, v77
  v_cvt_pk_bf16_f32 v135, v78, v79
  v_mfma_f32_32x32x16_bf16 v[112:127], v[208:211], v[184:187], 0
  ds_read_b128 v[220:223], v253 offset:33792
  v_exp_f32 v80, v80
  v_exp_f32 v81, v81
  v_exp_f32 v82, v82
  v_exp_f32 v83, v83
  v_cvt_pk_bf16_f32 v136, v80, v81
  v_cvt_pk_bf16_f32 v137, v82, v83
  v_mfma_f32_32x32x8bf16_1k v[112:127], v[212:213], v[188:189], v[112:127]
  buffer_load_dwordx4 v2, s[8:11], s55 offen offset:1024 sc1 lds
  v_exp_f32 v84, v84
  v_exp_f32 v85, v85
  v_exp_f32 v86, v86
  v_exp_f32 v87, v87
  v_cvt_pk_bf16_f32 v138, v84, v85
  v_cvt_pk_bf16_f32 v139, v86, v87
  v_mfma_f32_32x32x16_bf16 v[144:159], v[204:207], v[132:135], v[144:159]
  buffer_load_dwordx4 v2, s[8:11], s55 offen offset:2048 sc1 lds
  s_add_u32 s55, s55, 12288
  v_exp_f32 v88, v88
  v_exp_f32 v89, v89
  v_exp_f32 v90, v90
  v_exp_f32 v91, v91
  v_cvt_pk_bf16_f32 v140, v88, v89
  v_cvt_pk_bf16_f32 v141, v90, v91
  v_mfma_f32_32x32x16_bf16 v[160:175], v[200:203], v[136:139], v[160:175]
  s_waitcnt lgkmcnt(0)
  v_exp_f32 v92, v92
  v_exp_f32 v93, v93
  v_exp_f32 v94, v94
  v_exp_f32 v95, v95
  v_cvt_pk_bf16_f32 v142, v92, v93
  v_cvt_pk_bf16_f32 v143, v94, v95
  v_mfma_f32_32x32x16_bf16 v[64:79], v[192:195], v[176:179], 0
  ds_read_b128 v[208:211], v224 offset:39936
  v_exp_f32 v96, v96
  v_exp_f32 v97, v97
  v_exp_f32 v98, v98
  v_exp_f32 v99, v99
  v_cvt_pk_bf16_f32 v128, v96, v97
  v_cvt_pk_bf16_f32 v129, v98, v99
  v_mfma_f32_32x32x8bf16_1k v[64:79], v[196:197], v[180:181], v[64:79]
  ds_read_b64 v[212:213], v225 offset:39936
  v_exp_f32 v100, v100
  v_exp_f32 v101, v101
  v_exp_f32 v102, v102
  v_exp_f32 v103, v103
  v_cvt_pk_bf16_f32 v130, v100, v101
  v_cvt_pk_bf16_f32 v131, v102, v103
  v_mfma_f32_32x32x16_bf16 v[160:175], v[204:207], v[140:143], v[160:175]
  buffer_load_dwordx4 a[140:143], v2, s[8:11], s61 offen offset:3072 sc1
  v_exp_f32 v104, v104
  v_exp_f32 v105, v105
  v_exp_f32 v106, v106
  v_exp_f32 v107, v107
  v_cvt_pk_bf16_f32 v132, v104, v105
  v_cvt_pk_bf16_f32 v133, v106, v107
  v_mfma_f32_32x32x16_bf16 v[144:159], v[216:219], v[128:131], v[144:159]
  ds_read_b128 v[200:203], v226 offset:36864
  v_exp_f32 v108, v108
  v_exp_f32 v109, v109
  v_exp_f32 v110, v110
  v_exp_f32 v111, v111
  v_cvt_pk_bf16_f32 v134, v108, v109
  v_cvt_pk_bf16_f32 v135, v110, v111
  v_mfma_f32_32x32x16_bf16 v[80:95], v[192:195], v[184:187], 0
  ds_read_b128 v[204:207], v253 offset:36864
  v_exp_f32 v112, v112
  v_exp_f32 v113, v113
  v_exp_f32 v114, v114
  v_exp_f32 v115, v115
  v_cvt_pk_bf16_f32 v136, v112, v113
  v_cvt_pk_bf16_f32 v137, v114, v115
  v_mfma_f32_32x32x8bf16_1k v[80:95], v[196:197], v[188:189], v[80:95]
  s_add_u32 s61, s61, 4096
  buffer_load_dwordx4 a[144:147], v2, s[8:11], s61 offen offset:0 sc1
  v_exp_f32 v116, v116
  v_exp_f32 v117, v117
  v_exp_f32 v118, v118
  v_exp_f32 v119, v119
  v_cvt_pk_bf16_f32 v138, v116, v117
  v_cvt_pk_bf16_f32 v139, v118, v119
  v_mfma_f32_32x32x16_bf16 v[144:159], v[220:223], v[132:135], v[144:159]
  buffer_load_dwordx4 a[148:151], v2, s[8:11], s61 offen offset:1024 sc1
  v_exp_f32 v120, v120
  v_exp_f32 v121, v121
  v_exp_f32 v122, v122
  v_exp_f32 v123, v123
  v_cvt_pk_bf16_f32 v140, v120, v121
  v_cvt_pk_bf16_f32 v141, v122, v123
  v_mfma_f32_32x32x16_bf16 v[160:175], v[216:219], v[136:139], v[160:175]
  s_waitcnt lgkmcnt(0)
  v_exp_f32 v124, v124
  v_exp_f32 v125, v125
  v_exp_f32 v126, v126
  v_exp_f32 v127, v127
  v_cvt_pk_bf16_f32 v142, v124, v125
  v_cvt_pk_bf16_f32 v143, v126, v127
  v_mfma_f32_32x32x16_bf16 v[96:111], v[208:211], v[176:179], 0
  ds_read_b128 v[192:195], v224 offset:43008
  v_exp_f32 v64, v64
  v_exp_f32 v65, v65
  v_exp_f32 v66, v66
  v_exp_f32 v67, v67
  v_cvt_pk_bf16_f32 v128, v64, v65
  v_cvt_pk_bf16_f32 v129, v66, v67
  v_mfma_f32_32x32x8bf16_1k v[96:111], v[212:213], v[180:181], v[96:111]
  ds_read_b64 v[196:197], v225 offset:43008
  v_exp_f32 v68, v68
  v_exp_f32 v69, v69
  v_exp_f32 v70, v70
  v_exp_f32 v71, v71
  v_cvt_pk_bf16_f32 v130, v68, v69
  v_cvt_pk_bf16_f32 v131, v70, v71
  v_mfma_f32_32x32x16_bf16 v[160:175], v[220:223], v[140:143], v[160:175]
  buffer_load_dwordx4 a[152:155], v2, s[8:11], s61 offen offset:2048 sc1
  v_exp_f32 v72, v72
  v_exp_f32 v73, v73
  v_exp_f32 v74, v74
  v_exp_f32 v75, v75
  v_cvt_pk_bf16_f32 v132, v72, v73
  v_cvt_pk_bf16_f32 v133, v74, v75
  v_mfma_f32_32x32x16_bf16 v[144:159], v[200:203], v[128:131], v[144:159]
  ds_read_b128 v[216:219], v226 offset:39936
  v_exp_f32 v76, v76
  v_exp_f32 v77, v77
  v_exp_f32 v78, v78
  v_exp_f32 v79, v79
  v_cvt_pk_bf16_f32 v134, v76, v77
  v_cvt_pk_bf16_f32 v135, v78, v79
  v_mfma_f32_32x32x16_bf16 v[112:127], v[208:211], v[184:187], 0
  ds_read_b128 v[220:223], v253 offset:39936
  v_exp_f32 v80, v80
  v_exp_f32 v81, v81
  v_exp_f32 v82, v82
  v_exp_f32 v83, v83
  v_cvt_pk_bf16_f32 v136, v80, v81
  v_cvt_pk_bf16_f32 v137, v82, v83
  v_mfma_f32_32x32x8bf16_1k v[112:127], v[212:213], v[188:189], v[112:127]
  buffer_load_dwordx4 a[156:159], v2, s[8:11], s61 offen offset:3072 sc1
  v_exp_f32 v84, v84
  v_exp_f32 v85, v85
  v_exp_f32 v86, v86
  v_exp_f32 v87, v87
  v_cvt_pk_bf16_f32 v138, v84, v85
  v_cvt_pk_bf16_f32 v139, v86, v87
  v_mfma_f32_32x32x16_bf16 v[144:159], v[204:207], v[132:135], v[144:159]
  s_add_u32 s61, s61, 4096
  buffer_load_dwordx4 a[160:163], v2, s[8:11], s61 offen offset:0 sc1
  v_exp_f32 v88, v88
  v_exp_f32 v89, v89
  v_exp_f32 v90, v90
  v_exp_f32 v91, v91
  v_cvt_pk_bf16_f32 v140, v88, v89
  v_cvt_pk_bf16_f32 v141, v90, v91
  v_mfma_f32_32x32x16_bf16 v[160:175], v[200:203], v[136:139], v[160:175]
  s_waitcnt lgkmcnt(0)
  v_exp_f32 v92, v92
  v_exp_f32 v93, v93
  v_exp_f32 v94, v94
  v_exp_f32 v95, v95
  v_cvt_pk_bf16_f32 v142, v92, v93
  v_cvt_pk_bf16_f32 v143, v94, v95
  v_mfma_f32_32x32x16_bf16 v[64:79], v[192:195], v[176:179], 0
  ds_read_b128 v[208:211], v224 offset:46080
  v_exp_f32 v96, v96
  v_exp_f32 v97, v97
  v_exp_f32 v98, v98
  v_exp_f32 v99, v99
  v_cvt_pk_bf16_f32 v128, v96, v97
  v_cvt_pk_bf16_f32 v129, v98, v99
  v_mfma_f32_32x32x8bf16_1k v[64:79], v[196:197], v[180:181], v[64:79]
  ds_read_b64 v[212:213], v225 offset:46080
  v_exp_f32 v100, v100
  v_exp_f32 v101, v101
  v_exp_f32 v102, v102
  v_exp_f32 v103, v103
  v_cvt_pk_bf16_f32 v130, v100, v101
  v_cvt_pk_bf16_f32 v131, v102, v103
  v_mfma_f32_32x32x16_bf16 v[160:175], v[204:207], v[140:143], v[160:175]
  buffer_load_dwordx4 a[164:167], v2, s[8:11], s61 offen offset:1024 sc1
  v_exp_f32 v104, v104
  v_exp_f32 v105, v105
  v_exp_f32 v106, v106
  v_exp_f32 v107, v107
  v_cvt_pk_bf16_f32 v132, v104, v105
  v_cvt_pk_bf16_f32 v133, v106, v107
  v_mfma_f32_32x32x16_bf16 v[144:159], v[216:219], v[128:131], v[144:159]
  ds_read_b128 v[200:203], v226 offset:43008
  v_exp_f32 v108, v108
  v_exp_f32 v109, v109
  v_exp_f32 v110, v110
  v_exp_f32 v111, v111
  v_cvt_pk_bf16_f32 v134, v108, v109
  v_cvt_pk_bf16_f32 v135, v110, v111
  v_mfma_f32_32x32x16_bf16 v[80:95], v[192:195], v[184:187], 0
  ds_read_b128 v[204:207], v253 offset:43008
  v_exp_f32 v112, v112
  v_exp_f32 v113, v113
  v_exp_f32 v114, v114
  v_exp_f32 v115, v115
  v_cvt_pk_bf16_f32 v136, v112, v113
  v_cvt_pk_bf16_f32 v137, v114, v115
  v_mfma_f32_32x32x8bf16_1k v[80:95], v[196:197], v[188:189], v[80:95]
  buffer_load_dwordx4 a[168:171], v2, s[8:11], s61 offen offset:2048 sc1
  v_exp_f32 v116, v116
  v_exp_f32 v117, v117
  v_exp_f32 v118, v118
  v_exp_f32 v119, v119
  v_cvt_pk_bf16_f32 v138, v116, v117
  v_cvt_pk_bf16_f32 v139, v118, v119
  v_mfma_f32_32x32x16_bf16 v[144:159], v[220:223], v[132:135], v[144:159]
  buffer_load_dwordx4 a[172:175], v2, s[8:11], s61 offen offset:3072 sc1
  v_exp_f32 v120, v120
  v_exp_f32 v121, v121
  v_exp_f32 v122, v122
  v_exp_f32 v123, v123
  v_cvt_pk_bf16_f32 v140, v120, v121
  v_cvt_pk_bf16_f32 v141, v122, v123
  v_mfma_f32_32x32x16_bf16 v[160:175], v[216:219], v[136:139], v[160:175]
  s_waitcnt lgkmcnt(0)
  v_exp_f32 v124, v124
  v_exp_f32 v125, v125
  v_exp_f32 v126, v126
  v_exp_f32 v127, v127
  v_cvt_pk_bf16_f32 v142, v124, v125
  v_cvt_pk_bf16_f32 v143, v126, v127
  s_waitcnt vmcnt(21)
  s_barrier
  v_mfma_f32_32x32x16_bf16 v[96:111], v[208:211], v[176:179], 0
  ds_read_b128 v[192:195], v224 offset:0
  v_exp_f32 v64, v64
  v_exp_f32 v65, v65
  v_exp_f32 v66, v66
  v_exp_f32 v67, v67
  v_cvt_pk_bf16_f32 v128, v64, v65
  v_cvt_pk_bf16_f32 v129, v66, v67
  v_mfma_f32_32x32x8bf16_1k v[96:111], v[212:213], v[180:181], v[96:111]
  ds_read_b64 v[196:197], v225 offset:0
  v_exp_f32 v68, v68
  v_exp_f32 v69, v69
  v_exp_f32 v70, v70
  v_exp_f32 v71, v71
  v_cvt_pk_bf16_f32 v130, v68, v69
  v_cvt_pk_bf16_f32 v131, v70, v71
  v_mfma_f32_32x32x16_bf16 v[160:175], v[220:223], v[140:143], v[160:175]
  s_add_u32 m0, s54, 126976
  s_nop 0
  buffer_load_dwordx4 v2, s[8:11], s55 offen offset:0 sc1 lds
  v_exp_f32 v72, v72
  v_exp_f32 v73, v73
  v_exp_f32 v74, v74
  v_exp_f32 v75, v75
  v_cvt_pk_bf16_f32 v132, v72, v73
  v_cvt_pk_bf16_f32 v133, v74, v75
  v_mfma_f32_32x32x16_bf16 v[144:159], v[200:203], v[128:131], v[144:159]
  ds_read_b128 v[216:219], v226 offset:46080
  v_exp_f32 v76, v76
  v_exp_f32 v77, v77
  v_exp_f32 v78, v78
  v_exp_f32 v79, v79
  v_cvt_pk_bf16_f32 v134, v76, v77
  v_cvt_pk_bf16_f32 v135, v78, v79
  v_mfma_f32_32x32x16_bf16 v[112:127], v[208:211], v[184:187], 0
  ds_read_b128 v[220:223], v253 offset:46080
  v_exp_f32 v80, v80
  v_exp_f32 v81, v81
  v_exp_f32 v82, v82
  v_exp_f32 v83, v83
  v_cvt_pk_bf16_f32 v136, v80, v81
  v_cvt_pk_bf16_f32 v137, v82, v83
  v_mfma_f32_32x32x8bf16_1k v[112:127], v[212:213], v[188:189], v[112:127]
  buffer_load_dwordx4 v2, s[8:11], s55 offen offset:1024 sc1 lds
  v_exp_f32 v84, v84
  v_exp_f32 v85, v85
  v_exp_f32 v86, v86
  v_exp_f32 v87, v87
  v_cvt_pk_bf16_f32 v138, v84, v85
  v_cvt_pk_bf16_f32 v139, v86, v87
  v_mfma_f32_32x32x16_bf16 v[144:159], v[204:207], v[132:135], v[144:159]
  buffer_load_dwordx4 v2, s[8:11], s55 offen offset:2048 sc1 lds
  s_add_u32 s55, s55, 12288
  v_exp_f32 v88, v88
  v_exp_f32 v89, v89
  v_exp_f32 v90, v90
  v_exp_f32 v91, v91
  v_cvt_pk_bf16_f32 v140, v88, v89
  v_cvt_pk_bf16_f32 v141, v90, v91
  v_mfma_f32_32x32x16_bf16 v[160:175], v[200:203], v[136:139], v[160:175]
  s_waitcnt lgkmcnt(0)
  v_exp_f32 v92, v92
  v_exp_f32 v93, v93
  v_exp_f32 v94, v94
  v_exp_f32 v95, v95
  v_cvt_pk_bf16_f32 v142, v92, v93
  v_cvt_pk_bf16_f32 v143, v94, v95
  v_mfma_f32_32x32x16_bf16 v[64:79], v[192:195], v[176:179], 0
  ds_read_b128 v[208:211], v224 offset:3072
  v_exp_f32 v96, v96
  v_exp_f32 v97, v97
  v_exp_f32 v98, v98
  v_exp_f32 v99, v99
  v_cvt_pk_bf16_f32 v128, v96, v97
  v_cvt_pk_bf16_f32 v129, v98, v99
  v_mfma_f32_32x32x8bf16_1k v[64:79], v[196:197], v[180:181], v[64:79]
  ds_read_b64 v[212:213], v225 offset:3072
  v_exp_f32 v100, v100
  v_exp_f32 v101, v101
  v_exp_f32 v102, v102
  v_exp_f32 v103, v103
  v_cvt_pk_bf16_f32 v130, v100, v101
  v_cvt_pk_bf16_f32 v131, v102, v103
  v_mfma_f32_32x32x16_bf16 v[160:175], v[204:207], v[140:143], v[160:175]
  s_add_u32 s61, s61, 4096
  buffer_load_dwordx4 a[176:179], v2, s[8:11], s61 offen offset:0 sc1
  v_exp_f32 v104, v104
  v_exp_f32 v105, v105
  v_exp_f32 v106, v106
  v_exp_f32 v107, v107
  v_cvt_pk_bf16_f32 v132, v104, v105
  v_cvt_pk_bf16_f32 v133, v106, v107
  v_mfma_f32_32x32x16_bf16 v[144:159], v[216:219], v[128:131], v[144:159]
  ds_read_b128 v[200:203], v226 offset:0
  v_exp_f32 v108, v108
  v_exp_f32 v109, v109
  v_exp_f32 v110, v110
  v_exp_f32 v111, v111
  v_cvt_pk_bf16_f32 v134, v108, v109
  v_cvt_pk_bf16_f32 v135, v110, v111
  v_mfma_f32_32x32x16_bf16 v[80:95], v[192:195], v[184:187], 0
  ds_read_b128 v[204:207], v253 offset:0
  v_exp_f32 v112, v112
  v_exp_f32 v113, v113
  v_exp_f32 v114, v114
  v_exp_f32 v115, v115
  v_cvt_pk_bf16_f32 v136, v112, v113
  v_cvt_pk_bf16_f32 v137, v114, v115
  v_mfma_f32_32x32x8bf16_1k v[80:95], v[196:197], v[188:189], v[80:95]
  buffer_load_dwordx4 a[180:183], v2, s[8:11], s61 offen offset:1024 sc1
  v_exp_f32 v116, v116
  v_exp_f32 v117, v117
  v_exp_f32 v118, v118
  v_exp_f32 v119, v119
  v_cvt_pk_bf16_f32 v138, v116, v117
  v_cvt_pk_bf16_f32 v139, v118, v119
  v_mfma_f32_32x32x16_bf16 v[144:159], v[220:223], v[132:135], v[144:159]
  buffer_load_dwordx4 a[184:187], v2, s[8:11], s61 offen offset:2048 sc1
  v_exp_f32 v120, v120
  v_exp_f32 v121, v121
  v_exp_f32 v122, v122
  v_exp_f32 v123, v123
  v_cvt_pk_bf16_f32 v140, v120, v121
  v_cvt_pk_bf16_f32 v141, v122, v123
  v_mfma_f32_32x32x16_bf16 v[160:175], v[216:219], v[136:139], v[160:175]
  s_waitcnt lgkmcnt(0)
  v_exp_f32 v124, v124
  v_exp_f32 v125, v125
  v_exp_f32 v126, v126
  v_exp_f32 v127, v127
  v_cvt_pk_bf16_f32 v142, v124, v125
  v_cvt_pk_bf16_f32 v143, v126, v127
  v_mfma_f32_32x32x16_bf16 v[96:111], v[208:211], v[176:179], 0
  ds_read_b128 v[192:195], v224 offset:6144
  v_exp_f32 v64, v64
  v_exp_f32 v65, v65
  v_exp_f32 v66, v66
  v_exp_f32 v67, v67
  v_cvt_pk_bf16_f32 v128, v64, v65
  v_cvt_pk_bf16_f32 v129, v66, v67
  v_mfma_f32_32x32x8bf16_1k v[96:111], v[212:213], v[180:181], v[96:111]
  ds_read_b64 v[196:197], v225 offset:6144
  v_exp_f32 v68, v68
  v_exp_f32 v69, v69
  v_exp_f32 v70, v70
  v_exp_f32 v71, v71
  v_cvt_pk_bf16_f32 v130, v68, v69
  v_cvt_pk_bf16_f32 v131, v70, v71
  v_mfma_f32_32x32x16_bf16 v[160:175], v[220:223], v[140:143], v[160:175]
  buffer_load_dwordx4 a[188:191], v2, s[8:11], s61 offen offset:3072 sc1
  v_exp_f32 v72, v72
  v_exp_f32 v73, v73
  v_exp_f32 v74, v74
  v_exp_f32 v75, v75
  v_cvt_pk_bf16_f32 v132, v72, v73
  v_cvt_pk_bf16_f32 v133, v74, v75
  v_mfma_f32_32x32x16_bf16 v[144:159], v[200:203], v[128:131], v[144:159]
  ds_read_b128 v[216:219], v226 offset:3072
  v_exp_f32 v76, v76
  v_exp_f32 v77, v77
  v_exp_f32 v78, v78
  v_exp_f32 v79, v79
  v_cvt_pk_bf16_f32 v134, v76, v77
  v_cvt_pk_bf16_f32 v135, v78, v79
  v_mfma_f32_32x32x16_bf16 v[112:127], v[208:211], v[184:187], 0
  ds_read_b128 v[220:223], v253 offset:3072
  v_exp_f32 v80, v80
  v_exp_f32 v81, v81
  v_exp_f32 v82, v82
  v_exp_f32 v83, v83
  v_cvt_pk_bf16_f32 v136, v80, v81
  v_cvt_pk_bf16_f32 v137, v82, v83
  v_mfma_f32_32x32x8bf16_1k v[112:127], v[212:213], v[188:189], v[112:127]
  s_add_u32 s61, s61, 4096
  buffer_load_dwordx4 a[192:195], v2, s[8:11], s61 offen offset:0 sc1
  v_exp_f32 v84, v84
  v_exp_f32 v85, v85
  v_exp_f32 v86, v86
  v_exp_f32 v87, v87
  v_cvt_pk_bf16_f32 v138, v84, v85
  v_cvt_pk_bf16_f32 v139, v86, v87
  v_mfma_f32_32x32x16_bf16 v[144:159], v[204:207], v[132:135], v[144:159]
  buffer_load_dwordx4 a[196:199], v2, s[8:11], s61 offen offset:1024 sc1
  v_exp_f32 v88, v88
  v_exp_f32 v89, v89
  v_exp_f32 v90, v90
  v_exp_f32 v91, v91
  v_cvt_pk_bf16_f32 v140, v88, v89
  v_cvt_pk_bf16_f32 v141, v90, v91
  v_mfma_f32_32x32x16_bf16 v[160:175], v[200:203], v[136:139], v[160:175]
  s_waitcnt lgkmcnt(0)
  v_exp_f32 v92, v92
  v_exp_f32 v93, v93
  v_exp_f32 v94, v94
  v_exp_f32 v95, v95
  v_cvt_pk_bf16_f32 v142, v92, v93
  v_cvt_pk_bf16_f32 v143, v94, v95
  v_mfma_f32_32x32x16_bf16 v[64:79], v[192:195], v[176:179], 0
  ds_read_b128 v[208:211], v224 offset:9216
  v_exp_f32 v96, v96
  v_exp_f32 v97, v97
  v_exp_f32 v98, v98
  v_exp_f32 v99, v99
  v_cvt_pk_bf16_f32 v128, v96, v97
  v_cvt_pk_bf16_f32 v129, v98, v99
  v_mfma_f32_32x32x8bf16_1k v[64:79], v[196:197], v[180:181], v[64:79]
  ds_read_b64 v[212:213], v225 offset:9216
  v_exp_f32 v100, v100
  v_exp_f32 v101, v101
  v_exp_f32 v102, v102
  v_exp_f32 v103, v103
  v_cvt_pk_bf16_f32 v130, v100, v101
  v_cvt_pk_bf16_f32 v131, v102, v103
  v_mfma_f32_32x32x16_bf16 v[160:175], v[204:207], v[140:143], v[160:175]
  buffer_load_dwordx4 a[200:203], v2, s[8:11], s61 offen offset:2048 sc1
  v_exp_f32 v104, v104
  v_exp_f32 v105, v105
  v_exp_f32 v106, v106
  v_exp_f32 v107, v107
  v_cvt_pk_bf16_f32 v132, v104, v105
  v_cvt_pk_bf16_f32 v133, v106, v107
  v_mfma_f32_32x32x16_bf16 v[144:159], v[216:219], v[128:131], v[144:159]
  ds_read_b128 v[200:203], v226 offset:6144
  v_exp_f32 v108, v108
  v_exp_f32 v109, v109
  v_exp_f32 v110, v110
  v_exp_f32 v111, v111
  v_cvt_pk_bf16_f32 v134, v108, v109
  v_cvt_pk_bf16_f32 v135, v110, v111
  v_mfma_f32_32x32x16_bf16 v[80:95], v[192:195], v[184:187], 0
  ds_read_b128 v[204:207], v253 offset:6144
  v_exp_f32 v112, v112
  v_exp_f32 v113, v113
  v_exp_f32 v114, v114
  v_exp_f32 v115, v115
  v_cvt_pk_bf16_f32 v136, v112, v113
  v_cvt_pk_bf16_f32 v137, v114, v115
  v_mfma_f32_32x32x8bf16_1k v[80:95], v[196:197], v[188:189], v[80:95]
  buffer_load_dwordx4 a[204:207], v2, s[8:11], s61 offen offset:3072 sc1
  v_exp_f32 v116, v116
  v_exp_f32 v117, v117
  v_exp_f32 v118, v118
  v_exp_f32 v119, v119
  v_cvt_pk_bf16_f32 v138, v116, v117
  v_cvt_pk_bf16_f32 v139, v118, v119
  v_mfma_f32_32x32x16_bf16 v[144:159], v[220:223], v[132:135], v[144:159]
  s_add_u32 s61, s61, 4096
  buffer_load_dwordx4 a[208:211], v2, s[8:11], s61 offen offset:0 sc1
  v_exp_f32 v120, v120
  v_exp_f32 v121, v121
  v_exp_f32 v122, v122
  v_exp_f32 v123, v123
  v_cvt_pk_bf16_f32 v140, v120, v121
  v_cvt_pk_bf16_f32 v141, v122, v123
  v_mfma_f32_32x32x16_bf16 v[160:175], v[216:219], v[136:139], v[160:175]
  s_waitcnt lgkmcnt(0)
  v_exp_f32 v124, v124
  v_exp_f32 v125, v125
  v_exp_f32 v126, v126
  v_exp_f32 v127, v127
  v_cvt_pk_bf16_f32 v142, v124, v125
  v_cvt_pk_bf16_f32 v143, v126, v127
  s_waitcnt vmcnt(21)
  s_barrier
  v_mfma_f32_32x32x16_bf16 v[96:111], v[208:211], v[176:179], 0
  ds_read_b128 v[192:195], v224 offset:12288
  v_exp_f32 v64, v64
  v_exp_f32 v65, v65
  v_exp_f32 v66, v66
  v_exp_f32 v67, v67
  v_cvt_pk_bf16_f32 v128, v64, v65
  v_cvt_pk_bf16_f32 v129, v66, v67
  v_mfma_f32_32x32x8bf16_1k v[96:111], v[212:213], v[180:181], v[96:111]
  ds_read_b64 v[196:197], v225 offset:12288
  v_exp_f32 v68, v68
  v_exp_f32 v69, v69
  v_exp_f32 v70, v70
  v_exp_f32 v71, v71
  v_cvt_pk_bf16_f32 v130, v68, v69
  v_cvt_pk_bf16_f32 v131, v70, v71
  v_mfma_f32_32x32x16_bf16 v[160:175], v[220:223], v[140:143], v[160:175]
  s_add_u32 m0, s54, 139264
  s_nop 0
  buffer_load_dwordx4 v2, s[8:11], s55 offen offset:0 sc1 lds
  v_exp_f32 v72, v72
  v_exp_f32 v73, v73
  v_exp_f32 v74, v74
  v_exp_f32 v75, v75
  v_cvt_pk_bf16_f32 v132, v72, v73
  v_cvt_pk_bf16_f32 v133, v74, v75
  v_mfma_f32_32x32x16_bf16 v[144:159], v[200:203], v[128:131], v[144:159]
  ds_read_b128 v[216:219], v226 offset:9216
  v_exp_f32 v76, v76
  v_exp_f32 v77, v77
  v_exp_f32 v78, v78
  v_exp_f32 v79, v79
  v_cvt_pk_bf16_f32 v134, v76, v77
  v_cvt_pk_bf16_f32 v135, v78, v79
  v_mfma_f32_32x32x16_bf16 v[112:127], v[208:211], v[184:187], 0
  ds_read_b128 v[220:223], v253 offset:9216
  v_exp_f32 v80, v80
  v_exp_f32 v81, v81
  v_exp_f32 v82, v82
  v_exp_f32 v83, v83
  v_cvt_pk_bf16_f32 v136, v80, v81
  v_cvt_pk_bf16_f32 v137, v82, v83
  v_mfma_f32_32x32x8bf16_1k v[112:127], v[212:213], v[188:189], v[112:127]
  buffer_load_dwordx4 v2, s[8:11], s55 offen offset:1024 sc1 lds
  v_exp_f32 v84, v84
  v_exp_f32 v85, v85
  v_exp_f32 v86, v86
  v_exp_f32 v87, v87
  v_cvt_pk_bf16_f32 v138, v84, v85
  v_cvt_pk_bf16_f32 v139, v86, v87
  v_mfma_f32_32x32x16_bf16 v[144:159], v[204:207], v[132:135], v[144:159]
  buffer_load_dwordx4 v2, s[8:11], s55 offen offset:2048 sc1 lds
  s_add_u32 s55, s55, 12288
  v_exp_f32 v88, v88
  v_exp_f32 v89, v89
  v_exp_f32 v90, v90
  v_exp_f32 v91, v91
  v_cvt_pk_bf16_f32 v140, v88, v89
  v_cvt_pk_bf16_f32 v141, v90, v91
  v_mfma_f32_32x32x16_bf16 v[160:175], v[200:203], v[136:139], v[160:175]
  s_waitcnt lgkmcnt(0)
  v_exp_f32 v92, v92
  v_exp_f32 v93, v93
  v_exp_f32 v94, v94
  v_exp_f32 v95, v95
  v_cvt_pk_bf16_f32 v142, v92, v93
  v_cvt_pk_bf16_f32 v143, v94, v95
  v_mfma_f32_32x32x16_bf16 v[64:79], v[192:195], v[176:179], 0
  ds_read_b128 v[208:211], v224 offset:15360
  v_exp_f32 v96, v96
  v_exp_f32 v97, v97
  v_exp_f32 v98, v98
  v_exp_f32 v99, v99
  v_cvt_pk_bf16_f32 v128, v96, v97
  v_cvt_pk_bf16_f32 v129, v98, v99
  v_mfma_f32_32x32x8bf16_1k v[64:79], v[196:197], v[180:181], v[64:79]
  ds_read_b64 v[212:213], v225 offset:15360
  v_exp_f32 v100, v100
  v_exp_f32 v101, v101
  v_exp_f32 v102, v102
  v_exp_f32 v103, v103
  v_cvt_pk_bf16_f32 v130, v100, v101
  v_cvt_pk_bf16_f32 v131, v102, v103
  v_mfma_f32_32x32x16_bf16 v[160:175], v[204:207], v[140:143], v[160:175]
  buffer_load_dwordx4 a[212:215], v2, s[8:11], s61 offen offset:1024 sc1
  v_exp_f32 v104, v104
  v_exp_f32 v105, v105
  v_exp_f32 v106, v106
  v_exp_f32 v107, v107
  v_cvt_pk_bf16_f32 v132, v104, v105
  v_cvt_pk_bf16_f32 v133, v106, v107
  v_mfma_f32_32x32x16_bf16 v[144:159], v[216:219], v[128:131], v[144:159]
  ds_read_b128 v[200:203], v226 offset:12288
  v_exp_f32 v108, v108
  v_exp_f32 v109, v109
  v_exp_f32 v110, v110
  v_exp_f32 v111, v111
  v_cvt_pk_bf16_f32 v134, v108, v109
  v_cvt_pk_bf16_f32 v135, v110, v111
  v_mfma_f32_32x32x16_bf16 v[80:95], v[192:195], v[184:187], 0
  ds_read_b128 v[204:207], v253 offset:12288
  v_exp_f32 v112, v112
  v_exp_f32 v113, v113
  v_exp_f32 v114, v114
  v_exp_f32 v115, v115
  v_cvt_pk_bf16_f32 v136, v112, v113
  v_cvt_pk_bf16_f32 v137, v114, v115
  v_mfma_f32_32x32x8bf16_1k v[80:95], v[196:197], v[188:189], v[80:95]
  buffer_load_dwordx4 a[216:219], v2, s[8:11], s61 offen offset:2048 sc1
  v_exp_f32 v116, v116
  v_exp_f32 v117, v117
  v_exp_f32 v118, v118
  v_exp_f32 v119, v119
  v_cvt_pk_bf16_f32 v138, v116, v117
  v_cvt_pk_bf16_f32 v139, v118, v119
  v_mfma_f32_32x32x16_bf16 v[144:159], v[220:223], v[132:135], v[144:159]
  buffer_load_dwordx4 a[220:223], v2, s[8:11], s61 offen offset:3072 sc1
  v_exp_f32 v120, v120
  v_exp_f32 v121, v121
  v_exp_f32 v122, v122
  v_exp_f32 v123, v123
  v_cvt_pk_bf16_f32 v140, v120, v121
  v_cvt_pk_bf16_f32 v141, v122, v123
  v_mfma_f32_32x32x16_bf16 v[160:175], v[216:219], v[136:139], v[160:175]
  s_waitcnt lgkmcnt(0)
  v_exp_f32 v124, v124
  v_exp_f32 v125, v125
  v_exp_f32 v126, v126
  v_exp_f32 v127, v127
  v_cvt_pk_bf16_f32 v142, v124, v125
  v_cvt_pk_bf16_f32 v143, v126, v127
  v_mfma_f32_32x32x16_bf16 v[96:111], v[208:211], v[176:179], 0
  ds_read_b128 v[192:195], v224 offset:18432
  v_exp_f32 v64, v64
  v_exp_f32 v65, v65
  v_exp_f32 v66, v66
  v_exp_f32 v67, v67
  v_cvt_pk_bf16_f32 v128, v64, v65
  v_cvt_pk_bf16_f32 v129, v66, v67
  v_mfma_f32_32x32x8bf16_1k v[96:111], v[212:213], v[180:181], v[96:111]
  ds_read_b64 v[196:197], v225 offset:18432
  v_exp_f32 v68, v68
  v_exp_f32 v69, v69
  v_exp_f32 v70, v70
  v_exp_f32 v71, v71
  v_cvt_pk_bf16_f32 v130, v68, v69
  v_cvt_pk_bf16_f32 v131, v70, v71
  v_mfma_f32_32x32x16_bf16 v[160:175], v[220:223], v[140:143], v[160:175]
  s_add_u32 s61, s61, 4096
  buffer_load_dwordx4 a[224:227], v2, s[8:11], s61 offen offset:0 sc1
  v_exp_f32 v72, v72
  v_exp_f32 v73, v73
  v_exp_f32 v74, v74
  v_exp_f32 v75, v75
  v_cvt_pk_bf16_f32 v132, v72, v73
  v_cvt_pk_bf16_f32 v133, v74, v75
  v_mfma_f32_32x32x16_bf16 v[144:159], v[200:203], v[128:131], v[144:159]
  ds_read_b128 v[216:219], v226 offset:15360
  v_exp_f32 v76, v76
  v_exp_f32 v77, v77
  v_exp_f32 v78, v78
  v_exp_f32 v79, v79
  v_cvt_pk_bf16_f32 v134, v76, v77
  v_cvt_pk_bf16_f32 v135, v78, v79
  v_mfma_f32_32x32x16_bf16 v[112:127], v[208:211], v[184:187], 0
  ds_read_b128 v[220:223], v253 offset:15360
  v_exp_f32 v80, v80
  v_exp_f32 v81, v81
  v_exp_f32 v82, v82
  v_exp_f32 v83, v83
  v_cvt_pk_bf16_f32 v136, v80, v81
  v_cvt_pk_bf16_f32 v137, v82, v83
  v_mfma_f32_32x32x8bf16_1k v[112:127], v[212:213], v[188:189], v[112:127]
  buffer_load_dwordx4 a[228:231], v2, s[8:11], s61 offen offset:1024 sc1
  buffer_load_dword v227, v56, s[8:11], s88 offen sc1
  v_exp_f32 v84, v84
  v_exp_f32 v85, v85
  v_exp_f32 v86, v86
  v_exp_f32 v87, v87
  v_cvt_pk_bf16_f32 v138, v84, v85
  v_cvt_pk_bf16_f32 v139, v86, v87
  v_mfma_f32_32x32x16_bf16 v[144:159], v[204:207], v[132:135], v[144:159]
  buffer_load_dwordx4 a[232:235], v2, s[8:11], s61 offen offset:2048 sc1
  v_exp_f32 v88, v88
  v_exp_f32 v89, v89
  v_exp_f32 v90, v90
  v_exp_f32 v91, v91
  v_cvt_pk_bf16_f32 v140, v88, v89
  v_cvt_pk_bf16_f32 v141, v90, v91
  v_mfma_f32_32x32x16_bf16 v[160:175], v[200:203], v[136:139], v[160:175]
  s_waitcnt lgkmcnt(0)
  v_exp_f32 v92, v92
  v_exp_f32 v93, v93
  v_exp_f32 v94, v94
  v_exp_f32 v95, v95
  v_cvt_pk_bf16_f32 v142, v92, v93
  v_cvt_pk_bf16_f32 v143, v94, v95
  v_mfma_f32_32x32x16_bf16 v[64:79], v[192:195], v[176:179], 0
  ds_read_b128 v[208:211], v224 offset:21504
  v_exp_f32 v96, v96
  v_exp_f32 v97, v97
  v_exp_f32 v98, v98
  v_exp_f32 v99, v99
  v_cvt_pk_bf16_f32 v128, v96, v97
  v_cvt_pk_bf16_f32 v129, v98, v99
  v_mfma_f32_32x32x8bf16_1k v[64:79], v[196:197], v[180:181], v[64:79]
  ds_read_b64 v[212:213], v225 offset:21504
  v_exp_f32 v100, v100
  v_exp_f32 v101, v101
  v_exp_f32 v102, v102
  v_exp_f32 v103, v103
  v_cvt_pk_bf16_f32 v130, v100, v101
  v_cvt_pk_bf16_f32 v131, v102, v103
  v_mfma_f32_32x32x16_bf16 v[160:175], v[204:207], v[140:143], v[160:175]
  buffer_load_dwordx4 a[236:239], v2, s[8:11], s61 offen offset:3072 sc1
  v_exp_f32 v104, v104
  v_exp_f32 v105, v105
  v_exp_f32 v106, v106
  v_exp_f32 v107, v107
  v_cvt_pk_bf16_f32 v132, v104, v105
  v_cvt_pk_bf16_f32 v133, v106, v107
  v_mfma_f32_32x32x16_bf16 v[144:159], v[216:219], v[128:131], v[144:159]
  ds_read_b128 v[200:203], v226 offset:18432
  v_exp_f32 v108, v108
  v_exp_f32 v109, v109
  v_exp_f32 v110, v110
  v_exp_f32 v111, v111
  v_cvt_pk_bf16_f32 v134, v108, v109
  v_cvt_pk_bf16_f32 v135, v110, v111
  v_mfma_f32_32x32x16_bf16 v[80:95], v[192:195], v[184:187], 0
  ds_read_b128 v[204:207], v253 offset:18432
  v_exp_f32 v112, v112
  v_exp_f32 v113, v113
  v_exp_f32 v114, v114
  v_exp_f32 v115, v115
  v_cvt_pk_bf16_f32 v136, v112, v113
  v_cvt_pk_bf16_f32 v137, v114, v115
  v_mfma_f32_32x32x8bf16_1k v[80:95], v[196:197], v[188:189], v[80:95]
  buffer_load_dwordx4 v[228:231], v252, s[8:11], s66 offen sc1
  buffer_load_dword v227, v57, s[8:11], s89 offen sc1
  v_exp_f32 v116, v116
  v_exp_f32 v117, v117
  v_exp_f32 v118, v118
  v_exp_f32 v119, v119
  v_cvt_pk_bf16_f32 v138, v116, v117
  v_cvt_pk_bf16_f32 v139, v118, v119
  v_mfma_f32_32x32x16_bf16 v[144:159], v[220:223], v[132:135], v[144:159]
  buffer_load_dwordx4 v[232:235], v252, s[8:11], s66 offen offset:64 sc1
  v_exp_f32 v120, v120
  v_exp_f32 v121, v121
  v_exp_f32 v122, v122
  v_exp_f32 v123, v123
  v_cvt_pk_bf16_f32 v140, v120, v121
  v_cvt_pk_bf16_f32 v141, v122, v123
  v_mfma_f32_32x32x16_bf16 v[160:175], v[216:219], v[136:139], v[160:175]
  s_waitcnt lgkmcnt(0)
  v_exp_f32 v124, v124
  v_exp_f32 v125, v125
  v_exp_f32 v126, v126
  v_exp_f32 v127, v127
  v_cvt_pk_bf16_f32 v142, v124, v125
  v_cvt_pk_bf16_f32 v143, v126, v127
  s_waitcnt vmcnt(23)
  s_barrier
  v_mfma_f32_32x32x16_bf16 v[96:111], v[208:211], v[176:179], 0
  ds_read_b128 v[192:195], v224 offset:24576
  v_exp_f32 v64, v64
  v_exp_f32 v65, v65
  v_exp_f32 v66, v66
  v_exp_f32 v67, v67
  v_cvt_pk_bf16_f32 v128, v64, v65
  v_cvt_pk_bf16_f32 v129, v66, v67
  v_mfma_f32_32x32x8bf16_1k v[96:111], v[212:213], v[180:181], v[96:111]
  ds_read_b64 v[196:197], v225 offset:24576
  v_exp_f32 v68, v68
  v_exp_f32 v69, v69
  v_exp_f32 v70, v70
  v_exp_f32 v71, v71
  v_cvt_pk_bf16_f32 v130, v68, v69
  v_cvt_pk_bf16_f32 v131, v70, v71
  v_mfma_f32_32x32x16_bf16 v[160:175], v[220:223], v[140:143], v[160:175]
  v_exp_f32 v72, v72
  v_exp_f32 v73, v73
  v_exp_f32 v74, v74
  v_exp_f32 v75, v75
  v_cvt_pk_bf16_f32 v132, v72, v73
  v_cvt_pk_bf16_f32 v133, v74, v75
  v_mfma_f32_32x32x16_bf16 v[144:159], v[200:203], v[128:131], v[144:159]
  ds_read_b128 v[216:219], v226 offset:21504
  v_exp_f32 v76, v76
  v_exp_f32 v77, v77
  v_exp_f32 v78, v78
  v_exp_f32 v79, v79
  v_cvt_pk_bf16_f32 v134, v76, v77
  v_cvt_pk_bf16_f32 v135, v78, v79
  v_mfma_f32_32x32x16_bf16 v[112:127], v[208:211], v[184:187], 0
  ds_read_b128 v[220:223], v253 offset:21504
  v_exp_f32 v80, v80
  v_exp_f32 v81, v81
  v_exp_f32 v82, v82
  v_exp_f32 v83, v83
  v_cvt_pk_bf16_f32 v136, v80, v81
  v_cvt_pk_bf16_f32 v137, v82, v83
  v_mfma_f32_32x32x8bf16_1k v[112:127], v[212:213], v[188:189], v[112:127]
  v_exp_f32 v84, v84
  v_exp_f32 v85, v85
  v_exp_f32 v86, v86
  v_exp_f32 v87, v87
  v_cvt_pk_bf16_f32 v138, v84, v85
  v_cvt_pk_bf16_f32 v139, v86, v87
  v_mfma_f32_32x32x16_bf16 v[144:159], v[204:207], v[132:135], v[144:159]
  v_exp_f32 v88, v88
  v_exp_f32 v89, v89
  v_exp_f32 v90, v90
  v_exp_f32 v91, v91
  v_cvt_pk_bf16_f32 v140, v88, v89
  v_cvt_pk_bf16_f32 v141, v90, v91
  v_mfma_f32_32x32x16_bf16 v[160:175], v[200:203], v[136:139], v[160:175]
  s_waitcnt lgkmcnt(0)
  v_exp_f32 v92, v92
  v_exp_f32 v93, v93
  v_exp_f32 v94, v94
  v_exp_f32 v95, v95
  v_cvt_pk_bf16_f32 v142, v92, v93
  v_cvt_pk_bf16_f32 v143, v94, v95
  v_mfma_f32_32x32x16_bf16 v[64:79], v[192:195], v[176:179], 0
  ds_read_b128 v[208:211], v224 offset:27648
  v_exp_f32 v96, v96
  v_exp_f32 v97, v97
  v_exp_f32 v98, v98
  v_exp_f32 v99, v99
  v_cvt_pk_bf16_f32 v128, v96, v97
  v_cvt_pk_bf16_f32 v129, v98, v99
  v_mfma_f32_32x32x8bf16_1k v[64:79], v[196:197], v[180:181], v[64:79]
  ds_read_b64 v[212:213], v225 offset:27648
  v_exp_f32 v100, v100
  v_exp_f32 v101, v101
  v_exp_f32 v102, v102
  v_exp_f32 v103, v103
  v_cvt_pk_bf16_f32 v130, v100, v101
  v_cvt_pk_bf16_f32 v131, v102, v103
  v_mfma_f32_32x32x16_bf16 v[160:175], v[204:207], v[140:143], v[160:175]
  buffer_load_dwordx4 v[236:239], v252, s[8:11], s67 offen sc1
  v_exp_f32 v104, v104
  v_exp_f32 v105, v105
  v_exp_f32 v106, v106
  v_exp_f32 v107, v107
  v_cvt_pk_bf16_f32 v132, v104, v105
  v_cvt_pk_bf16_f32 v133, v106, v107
  v_mfma_f32_32x32x16_bf16 v[144:159], v[216:219], v[128:131], v[144:159]
  ds_read_b128 v[200:203], v226 offset:24576
  v_exp_f32 v108, v108
  v_exp_f32 v109, v109
  v_exp_f32 v110, v110
  v_exp_f32 v111, v111
  v_cvt_pk_bf16_f32 v134, v108, v109
  v_cvt_pk_bf16_f32 v135, v110, v111
  v_mfma_f32_32x32x16_bf16 v[80:95], v[192:195], v[184:187], 0
  ds_read_b128 v[204:207], v253 offset:24576
  v_exp_f32 v112, v112
  v_exp_f32 v113, v113
  v_exp_f32 v114, v114
  v_exp_f32 v115, v115
  v_cvt_pk_bf16_f32 v136, v112, v113
  v_cvt_pk_bf16_f32 v137, v114, v115
  v_mfma_f32_32x32x8bf16_1k v[80:95], v[196:197], v[188:189], v[80:95]
  buffer_load_dword v227, v58, s[8:11], s74 offen sc1
  v_exp_f32 v116, v116
  v_exp_f32 v117, v117
  v_exp_f32 v118, v118
  v_exp_f32 v119, v119
  v_cvt_pk_bf16_f32 v138, v116, v117
  v_cvt_pk_bf16_f32 v139, v118, v119
  v_mfma_f32_32x32x16_bf16 v[144:159], v[220:223], v[132:135], v[144:159]
  v_exp_f32 v120, v120
  v_exp_f32 v121, v121
  v_exp_f32 v122, v122
  v_exp_f32 v123, v123
  v_cvt_pk_bf16_f32 v140, v120, v121
  v_cvt_pk_bf16_f32 v141, v122, v123
  v_mfma_f32_32x32x16_bf16 v[160:175], v[216:219], v[136:139], v[160:175]
  s_waitcnt lgkmcnt(0)
  v_exp_f32 v124, v124
  v_exp_f32 v125, v125
  v_exp_f32 v126, v126
  v_exp_f32 v127, v127
  v_cvt_pk_bf16_f32 v142, v124, v125
  v_cvt_pk_bf16_f32 v143, v126, v127
  v_mfma_f32_32x32x16_bf16 v[96:111], v[208:211], v[176:179], 0
  ds_read_b128 v[192:195], v224 offset:30720
  v_exp_f32 v64, v64
  v_exp_f32 v65, v65
  v_exp_f32 v66, v66
  v_exp_f32 v67, v67
  v_cvt_pk_bf16_f32 v128, v64, v65
  v_cvt_pk_bf16_f32 v129, v66, v67
  v_mfma_f32_32x32x8bf16_1k v[96:111], v[212:213], v[180:181], v[96:111]
  ds_read_b64 v[196:197], v225 offset:30720
  v_exp_f32 v68, v68
  v_exp_f32 v69, v69
  v_exp_f32 v70, v70
  v_exp_f32 v71, v71
  v_cvt_pk_bf16_f32 v130, v68, v69
  v_cvt_pk_bf16_f32 v131, v70, v71
  v_mfma_f32_32x32x16_bf16 v[160:175], v[220:223], v[140:143], v[160:175]
  v_exp_f32 v72, v72
  v_exp_f32 v73, v73
  v_exp_f32 v74, v74
  v_exp_f32 v75, v75
  v_cvt_pk_bf16_f32 v132, v72, v73
  v_cvt_pk_bf16_f32 v133, v74, v75
  v_mfma_f32_32x32x16_bf16 v[144:159], v[200:203], v[128:131], v[144:159]
  ds_read_b128 v[216:219], v226 offset:27648
  v_exp_f32 v76, v76
  v_exp_f32 v77, v77
  v_exp_f32 v78, v78
  v_exp_f32 v79, v79
  v_cvt_pk_bf16_f32 v134, v76, v77
  v_cvt_pk_bf16_f32 v135, v78, v79
  v_mfma_f32_32x32x16_bf16 v[112:127], v[208:211], v[184:187], 0
  ds_read_b128 v[220:223], v253 offset:27648
  v_exp_f32 v80, v80
  v_exp_f32 v81, v81
  v_exp_f32 v82, v82
  v_exp_f32 v83, v83
  v_cvt_pk_bf16_f32 v136, v80, v81
  v_cvt_pk_bf16_f32 v137, v82, v83
  v_mfma_f32_32x32x8bf16_1k v[112:127], v[212:213], v[188:189], v[112:127]
  buffer_load_dword v227, v59, s[8:11], s75 offen sc1
  v_exp_f32 v84, v84
  v_exp_f32 v85, v85
  v_exp_f32 v86, v86
  v_exp_f32 v87, v87
  v_cvt_pk_bf16_f32 v138, v84, v85
  v_cvt_pk_bf16_f32 v139, v86, v87
  v_mfma_f32_32x32x16_bf16 v[144:159], v[204:207], v[132:135], v[144:159]
  v_exp_f32 v88, v88
  v_exp_f32 v89, v89
  v_exp_f32 v90, v90
  v_exp_f32 v91, v91
  v_cvt_pk_bf16_f32 v140, v88, v89
  v_cvt_pk_bf16_f32 v141, v90, v91
  v_mfma_f32_32x32x16_bf16 v[160:175], v[200:203], v[136:139], v[160:175]
  s_waitcnt lgkmcnt(0)
  v_exp_f32 v92, v92
  v_exp_f32 v93, v93
  v_exp_f32 v94, v94
  v_exp_f32 v95, v95
  v_cvt_pk_bf16_f32 v142, v92, v93
  v_cvt_pk_bf16_f32 v143, v94, v95
  v_mfma_f32_32x32x16_bf16 v[64:79], v[192:195], v[176:179], 0
  ds_read_b128 v[208:211], v224 offset:33792
  v_exp_f32 v96, v96
  v_exp_f32 v97, v97
  v_exp_f32 v98, v98
  v_exp_f32 v99, v99
  v_cvt_pk_bf16_f32 v128, v96, v97
  v_cvt_pk_bf16_f32 v129, v98, v99
  v_mfma_f32_32x32x8bf16_1k v[64:79], v[196:197], v[180:181], v[64:79]
  ds_read_b64 v[212:213], v225 offset:33792
  v_exp_f32 v100, v100
  v_exp_f32 v101, v101
  v_exp_f32 v102, v102
  v_exp_f32 v103, v103
  v_cvt_pk_bf16_f32 v130, v100, v101
  v_cvt_pk_bf16_f32 v131, v102, v103
  v_mfma_f32_32x32x16_bf16 v[160:175], v[204:207], v[140:143], v[160:175]
  v_exp_f32 v104, v104
  v_exp_f32 v105, v105
  v_exp_f32 v106, v106
  v_exp_f32 v107, v107
  v_cvt_pk_bf16_f32 v132, v104, v105
  v_cvt_pk_bf16_f32 v133, v106, v107
  v_mfma_f32_32x32x16_bf16 v[144:159], v[216:219], v[128:131], v[144:159]
  ds_read_b128 v[200:203], v226 offset:30720
  v_exp_f32 v108, v108
  v_exp_f32 v109, v109
  v_exp_f32 v110, v110
  v_exp_f32 v111, v111
  v_cvt_pk_bf16_f32 v134, v108, v109
  v_cvt_pk_bf16_f32 v135, v110, v111
  v_mfma_f32_32x32x16_bf16 v[80:95], v[192:195], v[184:187], 0
  ds_read_b128 v[204:207], v253 offset:30720
  v_exp_f32 v112, v112
  v_exp_f32 v113, v113
  v_exp_f32 v114, v114
  v_exp_f32 v115, v115
  v_cvt_pk_bf16_f32 v136, v112, v113
  v_cvt_pk_bf16_f32 v137, v114, v115
  v_mfma_f32_32x32x8bf16_1k v[80:95], v[196:197], v[188:189], v[80:95]
  buffer_load_dword v227, v60, s[8:11], s75 offen sc1
  v_exp_f32 v116, v116
  v_exp_f32 v117, v117
  v_exp_f32 v118, v118
  v_exp_f32 v119, v119
  v_cvt_pk_bf16_f32 v138, v116, v117
  v_cvt_pk_bf16_f32 v139, v118, v119
  v_mfma_f32_32x32x16_bf16 v[144:159], v[220:223], v[132:135], v[144:159]
  v_exp_f32 v120, v120
  v_exp_f32 v121, v121
  v_exp_f32 v122, v122
  v_exp_f32 v123, v123
  v_cvt_pk_bf16_f32 v140, v120, v121
  v_cvt_pk_bf16_f32 v141, v122, v123
  v_mfma_f32_32x32x16_bf16 v[160:175], v[216:219], v[136:139], v[160:175]
  s_waitcnt lgkmcnt(0)
  v_exp_f32 v124, v124
  v_exp_f32 v125, v125
  v_exp_f32 v126, v126
  v_exp_f32 v127, v127
  v_cvt_pk_bf16_f32 v142, v124, v125
  v_cvt_pk_bf16_f32 v143, v126, v127
  s_waitcnt vmcnt(15)
  s_barrier
  v_mfma_f32_32x32x16_bf16 v[96:111], v[208:211], v[176:179], 0
  ds_read_b128 v[192:195], v224 offset:36864
  v_exp_f32 v64, v64
  v_exp_f32 v65, v65
  v_exp_f32 v66, v66
  v_exp_f32 v67, v67
  v_cvt_pk_bf16_f32 v128, v64, v65
  v_cvt_pk_bf16_f32 v129, v66, v67
  v_mfma_f32_32x32x8bf16_1k v[96:111], v[212:213], v[180:181], v[96:111]
  ds_read_b64 v[196:197], v225 offset:36864
  v_exp_f32 v68, v68
  v_exp_f32 v69, v69
  v_exp_f32 v70, v70
  v_exp_f32 v71, v71
  v_cvt_pk_bf16_f32 v130, v68, v69
  v_cvt_pk_bf16_f32 v131, v70, v71
  v_mfma_f32_32x32x16_bf16 v[160:175], v[220:223], v[140:143], v[160:175]
  v_exp_f32 v72, v72
  v_exp_f32 v73, v73
  v_exp_f32 v74, v74
  v_exp_f32 v75, v75
  v_cvt_pk_bf16_f32 v132, v72, v73
  v_cvt_pk_bf16_f32 v133, v74, v75
  v_mfma_f32_32x32x16_bf16 v[144:159], v[200:203], v[128:131], v[144:159]
  ds_read_b128 v[216:219], v226 offset:33792
  v_exp_f32 v76, v76
  v_exp_f32 v77, v77
  v_exp_f32 v78, v78
  v_exp_f32 v79, v79
  v_cvt_pk_bf16_f32 v134, v76, v77
  v_cvt_pk_bf16_f32 v135, v78, v79
  v_mfma_f32_32x32x16_bf16 v[112:127], v[208:211], v[184:187], 0
  ds_read_b128 v[220:223], v253 offset:33792
  v_exp_f32 v80, v80
  v_exp_f32 v81, v81
  v_exp_f32 v82, v82
  v_exp_f32 v83, v83
  v_cvt_pk_bf16_f32 v136, v80, v81
  v_cvt_pk_bf16_f32 v137, v82, v83
  v_mfma_f32_32x32x8bf16_1k v[112:127], v[212:213], v[188:189], v[112:127]
  v_exp_f32 v84, v84
  v_exp_f32 v85, v85
  v_exp_f32 v86, v86
  v_exp_f32 v87, v87
  v_cvt_pk_bf16_f32 v138, v84, v85
  v_cvt_pk_bf16_f32 v139, v86, v87
  v_mfma_f32_32x32x16_bf16 v[144:159], v[204:207], v[132:135], v[144:159]
  v_exp_f32 v88, v88
  v_exp_f32 v89, v89
  v_exp_f32 v90, v90
  v_exp_f32 v91, v91
  v_cvt_pk_bf16_f32 v140, v88, v89
  v_cvt_pk_bf16_f32 v141, v90, v91
  v_mfma_f32_32x32x16_bf16 v[160:175], v[200:203], v[136:139], v[160:175]
  s_waitcnt lgkmcnt(0)
  v_exp_f32 v92, v92
  v_exp_f32 v93, v93
  v_exp_f32 v94, v94
  v_exp_f32 v95, v95
  v_cvt_pk_bf16_f32 v142, v92, v93
  v_cvt_pk_bf16_f32 v143, v94, v95
  v_mfma_f32_32x32x16_bf16 v[64:79], v[192:195], v[176:179], 0
  ds_read_b128 v[208:211], v224 offset:39936
  v_exp_f32 v96, v96
  v_exp_f32 v97, v97
  v_exp_f32 v98, v98
  v_exp_f32 v99, v99
  v_cvt_pk_bf16_f32 v128, v96, v97
  v_cvt_pk_bf16_f32 v129, v98, v99
  v_mfma_f32_32x32x8bf16_1k v[64:79], v[196:197], v[180:181], v[64:79]
  ds_read_b64 v[212:213], v225 offset:39936
  v_exp_f32 v100, v100
  v_exp_f32 v101, v101
  v_exp_f32 v102, v102
  v_exp_f32 v103, v103
  v_cvt_pk_bf16_f32 v130, v100, v101
  v_cvt_pk_bf16_f32 v131, v102, v103
  v_mfma_f32_32x32x16_bf16 v[160:175], v[204:207], v[140:143], v[160:175]
  v_exp_f32 v104, v104
  v_exp_f32 v105, v105
  v_exp_f32 v106, v106
  v_exp_f32 v107, v107
  v_cvt_pk_bf16_f32 v132, v104, v105
  v_cvt_pk_bf16_f32 v133, v106, v107
  v_mfma_f32_32x32x16_bf16 v[144:159], v[216:219], v[128:131], v[144:159]
  ds_read_b128 v[200:203], v226 offset:36864
  v_exp_f32 v108, v108
  v_exp_f32 v109, v109
  v_exp_f32 v110, v110
  v_exp_f32 v111, v111
  v_cvt_pk_bf16_f32 v134, v108, v109
  v_cvt_pk_bf16_f32 v135, v110, v111
  v_mfma_f32_32x32x16_bf16 v[80:95], v[192:195], v[184:187], 0
  ds_read_b128 v[204:207], v253 offset:36864
  v_exp_f32 v112, v112
  v_exp_f32 v113, v113
  v_exp_f32 v114, v114
  v_exp_f32 v115, v115
  v_cvt_pk_bf16_f32 v136, v112, v113
  v_cvt_pk_bf16_f32 v137, v114, v115
  v_mfma_f32_32x32x8bf16_1k v[80:95], v[196:197], v[188:189], v[80:95]
  v_exp_f32 v116, v116
  v_exp_f32 v117, v117
  v_exp_f32 v118, v118
  v_exp_f32 v119, v119
  v_cvt_pk_bf16_f32 v138, v116, v117
  v_cvt_pk_bf16_f32 v139, v118, v119
  v_mfma_f32_32x32x16_bf16 v[144:159], v[220:223], v[132:135], v[144:159]
  v_exp_f32 v120, v120
  v_exp_f32 v121, v121
  v_exp_f32 v122, v122
  v_exp_f32 v123, v123
  v_cvt_pk_bf16_f32 v140, v120, v121
  v_cvt_pk_bf16_f32 v141, v122, v123
  v_mfma_f32_32x32x16_bf16 v[160:175], v[216:219], v[136:139], v[160:175]
  s_waitcnt lgkmcnt(0)
  v_exp_f32 v124, v124
  v_exp_f32 v125, v125
  v_exp_f32 v126, v126
  v_exp_f32 v127, v127
  v_cvt_pk_bf16_f32 v142, v124, v125
  v_cvt_pk_bf16_f32 v143, v126, v127
  v_mfma_f32_32x32x16_bf16 v[96:111], v[208:211], v[176:179], 0
  ds_read_b128 v[192:195], v224 offset:43008
  v_exp_f32 v64, v64
  v_exp_f32 v65, v65
  v_exp_f32 v66, v66
  v_exp_f32 v67, v67
  v_cvt_pk_bf16_f32 v128, v64, v65
  v_cvt_pk_bf16_f32 v129, v66, v67
  v_mfma_f32_32x32x8bf16_1k v[96:111], v[212:213], v[180:181], v[96:111]
  ds_read_b64 v[196:197], v225 offset:43008
  v_exp_f32 v68, v68
  v_exp_f32 v69, v69
  v_exp_f32 v70, v70
  v_exp_f32 v71, v71
  v_cvt_pk_bf16_f32 v130, v68, v69
  v_cvt_pk_bf16_f32 v131, v70, v71
  v_mfma_f32_32x32x16_bf16 v[160:175], v[220:223], v[140:143], v[160:175]
  v_exp_f32 v72, v72
  v_exp_f32 v73, v73
  v_exp_f32 v74, v74
  v_exp_f32 v75, v75
  v_cvt_pk_bf16_f32 v132, v72, v73
  v_cvt_pk_bf16_f32 v133, v74, v75
  v_mfma_f32_32x32x16_bf16 v[144:159], v[200:203], v[128:131], v[144:159]
  ds_read_b128 v[216:219], v226 offset:39936
  v_exp_f32 v76, v76
  v_exp_f32 v77, v77
  v_exp_f32 v78, v78
  v_exp_f32 v79, v79
  v_cvt_pk_bf16_f32 v134, v76, v77
  v_cvt_pk_bf16_f32 v135, v78, v79
  v_mfma_f32_32x32x16_bf16 v[112:127], v[208:211], v[184:187], 0
  ds_read_b128 v[220:223], v253 offset:39936
  v_exp_f32 v80, v80
  v_exp_f32 v81, v81
  v_exp_f32 v82, v82
  v_exp_f32 v83, v83
  v_cvt_pk_bf16_f32 v136, v80, v81
  v_cvt_pk_bf16_f32 v137, v82, v83
  v_mfma_f32_32x32x8bf16_1k v[112:127], v[212:213], v[188:189], v[112:127]
  v_exp_f32 v84, v84
  v_exp_f32 v85, v85
  v_exp_f32 v86, v86
  v_exp_f32 v87, v87
  v_cvt_pk_bf16_f32 v138, v84, v85
  v_cvt_pk_bf16_f32 v139, v86, v87
  v_mfma_f32_32x32x16_bf16 v[144:159], v[204:207], v[132:135], v[144:159]
  v_exp_f32 v88, v88
  v_exp_f32 v89, v89
  v_exp_f32 v90, v90
  v_exp_f32 v91, v91
  v_cvt_pk_bf16_f32 v140, v88, v89
  v_cvt_pk_bf16_f32 v141, v90, v91
  v_mfma_f32_32x32x16_bf16 v[160:175], v[200:203], v[136:139], v[160:175]
  s_waitcnt lgkmcnt(0)
  v_exp_f32 v92, v92
  v_exp_f32 v93, v93
  v_exp_f32 v94, v94
  v_exp_f32 v95, v95
  v_cvt_pk_bf16_f32 v142, v92, v93
  v_cvt_pk_bf16_f32 v143, v94, v95
  v_mfma_f32_32x32x16_bf16 v[64:79], v[192:195], v[176:179], 0
  ds_read_b128 v[208:211], v224 offset:46080
  v_exp_f32 v96, v96
  v_exp_f32 v97, v97
  v_exp_f32 v98, v98
  v_exp_f32 v99, v99
  v_cvt_pk_bf16_f32 v128, v96, v97
  v_cvt_pk_bf16_f32 v129, v98, v99
  v_mfma_f32_32x32x8bf16_1k v[64:79], v[196:197], v[180:181], v[64:79]
  ds_read_b64 v[212:213], v225 offset:46080
  v_exp_f32 v100, v100
  v_exp_f32 v101, v101
  v_exp_f32 v102, v102
  v_exp_f32 v103, v103
  v_cvt_pk_bf16_f32 v130, v100, v101
  v_cvt_pk_bf16_f32 v131, v102, v103
  v_mfma_f32_32x32x16_bf16 v[160:175], v[204:207], v[140:143], v[160:175]
  v_exp_f32 v104, v104
  v_exp_f32 v105, v105
  v_exp_f32 v106, v106
  v_exp_f32 v107, v107
  v_cvt_pk_bf16_f32 v132, v104, v105
  v_cvt_pk_bf16_f32 v133, v106, v107
  v_mfma_f32_32x32x16_bf16 v[144:159], v[216:219], v[128:131], v[144:159]
  ds_read_b128 v[200:203], v226 offset:43008
  v_exp_f32 v108, v108
  v_exp_f32 v109, v109
  v_exp_f32 v110, v110
  v_exp_f32 v111, v111
  v_cvt_pk_bf16_f32 v134, v108, v109
  v_cvt_pk_bf16_f32 v135, v110, v111
  v_mfma_f32_32x32x16_bf16 v[80:95], v[192:195], v[184:187], 0
  ds_read_b128 v[204:207], v253 offset:43008
  v_exp_f32 v112, v112
  v_exp_f32 v113, v113
  v_exp_f32 v114, v114
  v_exp_f32 v115, v115
  v_cvt_pk_bf16_f32 v136, v112, v113
  v_cvt_pk_bf16_f32 v137, v114, v115
  v_mfma_f32_32x32x8bf16_1k v[80:95], v[196:197], v[188:189], v[80:95]
  v_exp_f32 v116, v116
  v_exp_f32 v117, v117
  v_exp_f32 v118, v118
  v_exp_f32 v119, v119
  v_cvt_pk_bf16_f32 v138, v116, v117
  v_cvt_pk_bf16_f32 v139, v118, v119
  v_mfma_f32_32x32x16_bf16 v[144:159], v[220:223], v[132:135], v[144:159]
  v_exp_f32 v120, v120
  v_exp_f32 v121, v121
  v_exp_f32 v122, v122
  v_exp_f32 v123, v123
  v_cvt_pk_bf16_f32 v140, v120, v121
  v_cvt_pk_bf16_f32 v141, v122, v123
  v_mfma_f32_32x32x16_bf16 v[160:175], v[216:219], v[136:139], v[160:175]
  s_waitcnt lgkmcnt(0)
  v_exp_f32 v124, v124
  v_exp_f32 v125, v125
  v_exp_f32 v126, v126
  v_exp_f32 v127, v127
  v_cvt_pk_bf16_f32 v142, v124, v125
  v_cvt_pk_bf16_f32 v143, v126, v127
  v_mfma_f32_32x32x16_bf16 v[96:111], v[208:211], v[176:179], 0
  v_exp_f32 v64, v64
  v_exp_f32 v65, v65
  v_exp_f32 v66, v66
  v_exp_f32 v67, v67
  v_cvt_pk_bf16_f32 v128, v64, v65
  v_cvt_pk_bf16_f32 v129, v66, v67
  v_mfma_f32_32x32x8bf16_1k v[96:111], v[212:213], v[180:181], v[96:111]
  v_exp_f32 v68, v68
  v_exp_f32 v69, v69
  v_exp_f32 v70, v70
  v_exp_f32 v71, v71
  v_cvt_pk_bf16_f32 v130, v68, v69
  v_cvt_pk_bf16_f32 v131, v70, v71
  v_mfma_f32_32x32x16_bf16 v[160:175], v[220:223], v[140:143], v[160:175]
  v_exp_f32 v72, v72
  v_exp_f32 v73, v73
  v_exp_f32 v74, v74
  v_exp_f32 v75, v75
  v_cvt_pk_bf16_f32 v132, v72, v73
  v_cvt_pk_bf16_f32 v133, v74, v75
  v_mfma_f32_32x32x16_bf16 v[144:159], v[200:203], v[128:131], v[144:159]
  ds_read_b128 v[216:219], v226 offset:46080
  v_exp_f32 v76, v76
  v_exp_f32 v77, v77
  v_exp_f32 v78, v78
  v_exp_f32 v79, v79
  v_cvt_pk_bf16_f32 v134, v76, v77
  v_cvt_pk_bf16_f32 v135, v78, v79
  v_mfma_f32_32x32x16_bf16 v[112:127], v[208:211], v[184:187], 0
  ds_read_b128 v[220:223], v253 offset:46080
  v_exp_f32 v80, v80
  v_exp_f32 v81, v81
  v_exp_f32 v82, v82
  v_exp_f32 v83, v83
  v_cvt_pk_bf16_f32 v136, v80, v81
  v_cvt_pk_bf16_f32 v137, v82, v83
  v_mfma_f32_32x32x8bf16_1k v[112:127], v[212:213], v[188:189], v[112:127]
  v_exp_f32 v84, v84
  v_exp_f32 v85, v85
  v_exp_f32 v86, v86
  v_exp_f32 v87, v87
  v_cvt_pk_bf16_f32 v138, v84, v85
  v_cvt_pk_bf16_f32 v139, v86, v87
  v_mfma_f32_32x32x16_bf16 v[144:159], v[204:207], v[132:135], v[144:159]
  v_exp_f32 v88, v88
  v_exp_f32 v89, v89
  v_exp_f32 v90, v90
  v_exp_f32 v91, v91
  v_cvt_pk_bf16_f32 v140, v88, v89
  v_cvt_pk_bf16_f32 v141, v90, v91
  v_mfma_f32_32x32x16_bf16 v[160:175], v[200:203], v[136:139], v[160:175]
  s_waitcnt lgkmcnt(0)
  v_exp_f32 v92, v92
  v_exp_f32 v93, v93
  v_exp_f32 v94, v94
  v_exp_f32 v95, v95
  v_cvt_pk_bf16_f32 v142, v92, v93
  v_cvt_pk_bf16_f32 v143, v94, v95
  v_exp_f32 v96, v96
  v_exp_f32 v97, v97
  v_exp_f32 v98, v98
  v_exp_f32 v99, v99
  v_cvt_pk_bf16_f32 v128, v96, v97
  v_cvt_pk_bf16_f32 v129, v98, v99
  v_exp_f32 v100, v100
  v_exp_f32 v101, v101
  v_exp_f32 v102, v102
  v_exp_f32 v103, v103
  v_cvt_pk_bf16_f32 v130, v100, v101
  v_cvt_pk_bf16_f32 v131, v102, v103
  v_mfma_f32_32x32x16_bf16 v[160:175], v[204:207], v[140:143], v[160:175]
  v_exp_f32 v104, v104
  v_exp_f32 v105, v105
  v_exp_f32 v106, v106
  v_exp_f32 v107, v107
  v_cvt_pk_bf16_f32 v132, v104, v105
  v_cvt_pk_bf16_f32 v133, v106, v107
  v_mfma_f32_32x32x16_bf16 v[144:159], v[216:219], v[128:131], v[144:159]
  v_exp_f32 v108, v108
  v_exp_f32 v109, v109
  v_exp_f32 v110, v110
  v_exp_f32 v111, v111
  v_cvt_pk_bf16_f32 v134, v108, v109
  v_cvt_pk_bf16_f32 v135, v110, v111
  v_exp_f32 v112, v112
  v_exp_f32 v113, v113
  v_exp_f32 v114, v114
  v_exp_f32 v115, v115
  v_cvt_pk_bf16_f32 v136, v112, v113
  v_cvt_pk_bf16_f32 v137, v114, v115
  v_exp_f32 v116, v116
  v_exp_f32 v117, v117
  v_exp_f32 v118, v118
  v_exp_f32 v119, v119
  v_cvt_pk_bf16_f32 v138, v116, v117
  v_cvt_pk_bf16_f32 v139, v118, v119
  v_mfma_f32_32x32x16_bf16 v[144:159], v[220:223], v[132:135], v[144:159]
  v_exp_f32 v120, v120
  v_exp_f32 v121, v121
  v_exp_f32 v122, v122
  v_exp_f32 v123, v123
  v_cvt_pk_bf16_f32 v140, v120, v121
  v_cvt_pk_bf16_f32 v141, v122, v123
  v_mfma_f32_32x32x16_bf16 v[160:175], v[216:219], v[136:139], v[160:175]
  s_waitcnt lgkmcnt(0)
  v_exp_f32 v124, v124
  v_exp_f32 v125, v125
  v_exp_f32 v126, v126
  v_exp_f32 v127, v127
  v_cvt_pk_bf16_f32 v142, v124, v125
  v_cvt_pk_bf16_f32 v143, v126, v127
  s_nop 1
  v_mfma_f32_32x32x16_bf16 v[160:175], v[220:223], v[140:143], v[160:175]
  v_mov_b32 v12, v152
  v_mov_b32 v13, v152
  s_nop 1
  v_permlane32_swap_b32 v12, v13
  v_rcp_f32 v13, v13
  s_nop 0
  v_mul_f32 v144, v144, v13
  v_mul_f32 v145, v145, v13
  v_mul_f32 v146, v146, v13
  v_mul_f32 v147, v147, v13
  v_mul_f32 v148, v148, v13
  v_mul_f32 v149, v149, v13
  v_mul_f32 v150, v150, v13
  v_mul_f32 v151, v151, v13
  v_mul_f32 v152, v152, v13
  v_mul_f32 v153, v153, v13
  v_mul_f32 v154, v154, v13
  v_mul_f32 v155, v155, v13
  v_cvt_pk_bf16_f32 v20, v144, v145
  v_cvt_pk_bf16_f32 v21, v146, v147
  v_cvt_pk_bf16_f32 v22, v148, v149
  v_cvt_pk_bf16_f32 v23, v150, v151
  v_cvt_pk_bf16_f32 v24, v152, v153
  v_cvt_pk_bf16_f32 v25, v154, v155
  v_mov_b32 v12, v168
  v_mov_b32 v13, v168
  s_nop 1
  v_permlane32_swap_b32 v12, v13
  v_rcp_f32 v13, v13
  s_nop 0
  v_mul_f32 v160, v160, v13
  v_mul_f32 v161, v161, v13
  v_mul_f32 v162, v162, v13
  v_mul_f32 v163, v163, v13
  v_mul_f32 v164, v164, v13
  v_mul_f32 v165, v165, v13
  v_mul_f32 v166, v166, v13
  v_mul_f32 v167, v167, v13
  v_mul_f32 v168, v168, v13
  v_mul_f32 v169, v169, v13
  v_mul_f32 v170, v170, v13
  v_mul_f32 v171, v171, v13
  v_cvt_pk_bf16_f32 v26, v160, v161
  v_cvt_pk_bf16_f32 v27, v162, v163
  v_cvt_pk_bf16_f32 v28, v164, v165
  v_cvt_pk_bf16_f32 v29, v166, v167
  v_cvt_pk_bf16_f32 v30, v168, v169
  v_cvt_pk_bf16_f32 v31, v170, v171
  s_cmp_eq_u32 s34, 0
  s_nop 0
  s_cbranch_scc1 HS_wt_79
  buffer_store_dwordx2 v[20:21], v61, s[8:11], s77 offen
  buffer_store_dwordx2 v[22:23], v62, s[8:11], s77 offen
  buffer_store_dwordx2 v[26:27], v61, s[8:11], s78 offen
  buffer_store_dwordx2 v[28:29], v62, s[8:11], s78 offen
  s_mov_b32 exec_hi, 0
  buffer_store_dwordx2 v[24:25], v63, s[8:11], s77 offen
  buffer_store_dwordx2 v[30:31], v63, s[8:11], s78 offen
  s_mov_b64 exec, -1
  s_branch HS_j_80
HS_wt_79:
  buffer_store_dwordx2 v[20:21], v61, s[8:11], s77 offen sc1
  buffer_store_dwordx2 v[22:23], v62, s[8:11], s77 offen sc1
  buffer_store_dwordx2 v[26:27], v61, s[8:11], s78 offen sc1
  buffer_store_dwordx2 v[28:29], v62, s[8:11], s78 offen sc1
  s_mov_b32 exec_hi, 0
  buffer_store_dwordx2 v[24:25], v63, s[8:11], s77 offen sc1
  buffer_store_dwordx2 v[30:31], v63, s[8:11], s78 offen sc1
  s_mov_b64 exec, -1
HS_j_80:
  s_waitcnt vmcnt(0)
  s_barrier
  s_cmp_eq_u32 s28, 0
  s_cbranch_scc0 SIG_81
  s_lshl_b32 s43, s32, 3
  s_add_u32 s43, s43, 1
  v_mov_b32 v255, s43
  s_mov_b64 exec, 1
  s_cmp_eq_u32 s34, 0
  s_cbranch_scc1 HS_wt_82
  buffer_store_dword v255, off, s[8:11], s33
  s_branch HS_j_83
HS_wt_82:
  buffer_store_dword v255, off, s[8:11], s33 sc1
HS_j_83:
  s_mov_b64 exec, -1
SIG_81:
  v_accvgpr_read_b32 v17, a246
  v_accvgpr_read_b32 v19, a247
  v_accvgpr_read_b32 v21, a248
  v_accvgpr_read_b32 v23, a249
  v_accvgpr_read_b32 v25, a250
  v_accvgpr_read_b32 v27, a251
  v_accvgpr_read_b32 v29, a252
  v_accvgpr_read_b32 v31, a253
  v_accvgpr_read_b32 v33, a254
  v_accvgpr_read_b32 v35, a255
  v_lshlrev_b32 v16, 16, v17
  v_and_b32 v17, 0xffff0000, v17
  v_lshlrev_b32 v18, 16, v19
  v_and_b32 v19, 0xffff0000, v19
  v_lshlrev_b32 v20, 16, v21
  v_and_b32 v21, 0xffff0000, v21
  v_lshlrev_b32 v22, 16, v23
  v_and_b32 v23, 0xffff0000, v23
  v_lshlrev_b32 v24, 16, v25
  v_and_b32 v25, 0xffff0000, v25
  v_lshlrev_b32 v26, 16, v27
  v_and_b32 v27, 0xffff0000, v27
  v_lshlrev_b32 v28, 16, v29
  v_and_b32 v29, 0xffff0000, v29
  v_lshlrev_b32 v30, 16, v31
  v_and_b32 v31, 0xffff0000, v31
  v_lshlrev_b32 v32, 16, v33
  v_and_b32 v33, 0xffff0000, v33
  v_lshlrev_b32 v34, 16, v35
  v_and_b32 v35, 0xffff0000, v35
  s_cmp_eq_u32 s32, 0
  s_mov_b32 s46, 6324224
  s_cselect_b32 s46, s46, 8945664
  s_lshl_b32 s40, s29, 2
  s_add_u32 s40, s40, s28
  s_mul_i32 s40, s40, 20480
  s_add_u32 s46, s46, s40
  v_mov_b32 v8, v2
  v_add_u32 v9, 0x10000, v2
  v_add_u32 v10, 0x20000, v2
  ds_read_b128 v[36:39], v8 offset:0
  ds_read_b128 v[40:43], v8 offset:1024
  ds_read_b128 v[44:47], v8 offset:2048
  ds_read_b128 v[48:51], v8 offset:3072
  ds_read_b128 v[52:55], v8 offset:4096
  ds_read_b128 v[56:59], v8 offset:5120
  ds_read_b128 v[60:63], v8 offset:6144
  ds_read_b128 v[64:67], v8 offset:7168
  ds_read_b128 v[68:71], v8 offset:8192
  ds_read_b128 v[72:75], v8 offset:9216
  s_cmp_eq_u32 s28, 0
  s_cbranch_scc0 WC_84
  s_lshl_b32 s43, s32, 3
  s_add_u32 s43, s43, 1
  s_mov_b64 exec, 0xff
  v_lshlrev_b32 v254, 2, v1
  s_mov_b32 s42, 400000
  s_nop 0
WCP_85:
  buffer_load_dword v255, v254, s[8:11], s39 offen sc1
  s_waitcnt vmcnt(0)
  v_cmp_gt_u32 vcc, s43, v255
  s_cmp_eq_u64 vcc, 0
  s_nop 3
  s_cbranch_scc1 WCP_done_86
  s_sub_u32 s42, s42, 1
  s_cmp_lg_u32 s42, 0
  s_cbranch_scc1 WCP_85
WCP_done_86:
  s_mov_b64 exec, -1
WC_84:
  s_barrier
  buffer_load_dwordx4 v[96:99], v2, s[8:11], s46 offen offset:0 sc1
  buffer_load_dwordx4 v[100:103], v2, s[8:11], s46 offen offset:1024 sc1
  buffer_load_dwordx4 v[104:107], v2, s[8:11], s46 offen offset:2048 sc1
  buffer_load_dwordx4 v[108:111], v2, s[8:11], s46 offen offset:3072 sc1
  s_add_u32 s46, s46, 4096
  buffer_load_dwordx4 v[112:115], v2, s[8:11], s46 offen offset:0 sc1
  buffer_load_dwordx4 v[116:119], v2, s[8:11], s46 offen offset:1024 sc1
  buffer_load_dwordx4 v[120:123], v2, s[8:11], s46 offen offset:2048 sc1
  buffer_load_dwordx4 v[124:127], v2, s[8:11], s46 offen offset:3072 sc1
  s_waitcnt vmcnt(7)
  s_waitcnt lgkmcnt(5)
  v_mfma_f32_16x16x32_bf16 v[16:19], v[36:39], v[96:99], v[16:19]
  ds_read_b128 v[76:79], v8 offset:10240
  v_mfma_f32_16x16x32_bf16 v[20:23], v[40:43], v[96:99], v[20:23]
  ds_read_b128 v[80:83], v8 offset:11264
  v_mfma_f32_16x16x32_bf16 v[24:27], v[44:47], v[96:99], v[24:27]
  ds_read_b128 v[84:87], v8 offset:12288
  v_mfma_f32_16x16x32_bf16 v[28:31], v[48:51], v[96:99], v[28:31]
  ds_read_b128 v[88:91], v8 offset:13312
  v_mfma_f32_16x16x32_bf16 v[32:35], v[52:55], v[96:99], v[32:35]
  ds_read_b128 v[92:95], v8 offset:14336
  s_add_u32 s46, s46, 4096
  buffer_load_dwordx4 v[128:131], v2, s[8:11], s46 offen offset:0 sc1
  s_waitcnt vmcnt(7)
  s_waitcnt lgkmcnt(5)
  v_mfma_f32_16x16x32_bf16 v[16:19], v[56:59], v[100:103], v[16:19]
  ds_read_b128 v[36:39], v8 offset:15360
  v_mfma_f32_16x16x32_bf16 v[20:23], v[60:63], v[100:103], v[20:23]
  ds_read_b128 v[40:43], v8 offset:16384
  v_mfma_f32_16x16x32_bf16 v[24:27], v[64:67], v[100:103], v[24:27]
  ds_read_b128 v[44:47], v8 offset:17408
  v_mfma_f32_16x16x32_bf16 v[28:31], v[68:71], v[100:103], v[28:31]
  ds_read_b128 v[48:51], v8 offset:18432
  v_mfma_f32_16x16x32_bf16 v[32:35], v[72:75], v[100:103], v[32:35]
  ds_read_b128 v[52:55], v8 offset:19456
  buffer_load_dwordx4 v[132:135], v2, s[8:11], s46 offen offset:1024 sc1
  s_waitcnt vmcnt(6)
  s_waitcnt lgkmcnt(5)
  v_mfma_f32_16x16x32_bf16 v[16:19], v[76:79], v[104:107], v[16:19]
  ds_read_b128 v[56:59], v8 offset:20480
  v_mfma_f32_16x16x32_bf16 v[20:23], v[80:83], v[104:107], v[20:23]
  ds_read_b128 v[60:63], v8 offset:21504
  v_mfma_f32_16x16x32_bf16 v[24:27], v[84:87], v[104:107], v[24:27]
  ds_read_b128 v[64:67], v8 offset:22528
  v_mfma_f32_16x16x32_bf16 v[28:31], v[88:91], v[104:107], v[28:31]
  ds_read_b128 v[68:71], v8 offset:23552
  v_mfma_f32_16x16x32_bf16 v[32:35], v[92:95], v[104:107], v[32:35]
  ds_read_b128 v[72:75], v8 offset:24576
  buffer_load_dwordx4 v[136:139], v2, s[8:11], s46 offen offset:2048 sc1
  s_waitcnt lgkmcnt(5)
  v_mfma_f32_16x16x32_bf16 v[16:19], v[36:39], v[108:111], v[16:19]
  ds_read_b128 v[76:79], v8 offset:25600
  v_mfma_f32_16x16x32_bf16 v[20:23], v[40:43], v[108:111], v[20:23]
  ds_read_b128 v[80:83], v8 offset:26624
  v_mfma_f32_16x16x32_bf16 v[24:27], v[44:47], v[108:111], v[24:27]
  ds_read_b128 v[84:87], v8 offset:27648
  v_mfma_f32_16x16x32_bf16 v[28:31], v[48:51], v[108:111], v[28:31]
  ds_read_b128 v[88:91], v8 offset:28672
  v_mfma_f32_16x16x32_bf16 v[32:35], v[52:55], v[108:111], v[32:35]
  ds_read_b128 v[92:95], v8 offset:29696
  buffer_load_dwordx4 v[140:143], v2, s[8:11], s46 offen offset:3072 sc1
  s_waitcnt vmcnt(6)
  s_waitcnt lgkmcnt(5)
  v_mfma_f32_16x16x32_bf16 v[16:19], v[56:59], v[112:115], v[16:19]
  ds_read_b128 v[36:39], v8 offset:30720
  v_mfma_f32_16x16x32_bf16 v[20:23], v[60:63], v[112:115], v[20:23]
  ds_read_b128 v[40:43], v8 offset:31744
  v_mfma_f32_16x16x32_bf16 v[24:27], v[64:67], v[112:115], v[24:27]
  ds_read_b128 v[44:47], v8 offset:32768
  v_mfma_f32_16x16x32_bf16 v[28:31], v[68:71], v[112:115], v[28:31]
  ds_read_b128 v[48:51], v8 offset:33792
  v_mfma_f32_16x16x32_bf16 v[32:35], v[72:75], v[112:115], v[32:35]
  ds_read_b128 v[52:55], v8 offset:34816
  s_add_u32 s46, s46, 4096
  buffer_load_dwordx4 v[144:147], v2, s[8:11], s46 offen offset:0 sc1
  s_waitcnt lgkmcnt(5)
  v_mfma_f32_16x16x32_bf16 v[16:19], v[76:79], v[116:119], v[16:19]
  ds_read_b128 v[56:59], v8 offset:35840
  v_mfma_f32_16x16x32_bf16 v[20:23], v[80:83], v[116:119], v[20:23]
  ds_read_b128 v[60:63], v8 offset:36864
  v_mfma_f32_16x16x32_bf16 v[24:27], v[84:87], v[116:119], v[24:27]
  ds_read_b128 v[64:67], v8 offset:37888
  v_mfma_f32_16x16x32_bf16 v[28:31], v[88:91], v[116:119], v[28:31]
  ds_read_b128 v[68:71], v8 offset:38912
  v_mfma_f32_16x16x32_bf16 v[32:35], v[92:95], v[116:119], v[32:35]
  ds_read_b128 v[72:75], v8 offset:39936
  buffer_load_dwordx4 v[148:151], v2, s[8:11], s46 offen offset:1024 sc1
  s_waitcnt vmcnt(6)
  s_waitcnt lgkmcnt(5)
  v_mfma_f32_16x16x32_bf16 v[16:19], v[36:39], v[120:123], v[16:19]
  ds_read_b128 v[76:79], v8 offset:40960
  v_mfma_f32_16x16x32_bf16 v[20:23], v[40:43], v[120:123], v[20:23]
  ds_read_b128 v[80:83], v8 offset:41984
  v_mfma_f32_16x16x32_bf16 v[24:27], v[44:47], v[120:123], v[24:27]
  ds_read_b128 v[84:87], v8 offset:43008
  v_mfma_f32_16x16x32_bf16 v[28:31], v[48:51], v[120:123], v[28:31]
  ds_read_b128 v[88:91], v8 offset:44032
  v_mfma_f32_16x16x32_bf16 v[32:35], v[52:55], v[120:123], v[32:35]
  ds_read_b128 v[92:95], v8 offset:45056
  buffer_load_dwordx4 v[152:155], v2, s[8:11], s46 offen offset:2048 sc1
  s_waitcnt lgkmcnt(5)
  v_mfma_f32_16x16x32_bf16 v[16:19], v[56:59], v[124:127], v[16:19]
  ds_read_b128 v[36:39], v8 offset:46080
  v_mfma_f32_16x16x32_bf16 v[20:23], v[60:63], v[124:127], v[20:23]
  ds_read_b128 v[40:43], v8 offset:47104
  v_mfma_f32_16x16x32_bf16 v[24:27], v[64:67], v[124:127], v[24:27]
  ds_read_b128 v[44:47], v8 offset:48128
  v_mfma_f32_16x16x32_bf16 v[28:31], v[68:71], v[124:127], v[28:31]
  ds_read_b128 v[48:51], v8 offset:49152
  v_mfma_f32_16x16x32_bf16 v[32:35], v[72:75], v[124:127], v[32:35]
  ds_read_b128 v[52:55], v8 offset:50176
  buffer_load_dwordx4 v[156:159], v2, s[8:11], s46 offen offset:3072 sc1
  s_waitcnt vmcnt(6)
  s_waitcnt lgkmcnt(5)
  v_mfma_f32_16x16x32_bf16 v[16:19], v[76:79], v[128:131], v[16:19]
  ds_read_b128 v[56:59], v8 offset:51200
  v_mfma_f32_16x16x32_bf16 v[20:23], v[80:83], v[128:131], v[20:23]
  ds_read_b128 v[60:63], v8 offset:52224
  v_mfma_f32_16x16x32_bf16 v[24:27], v[84:87], v[128:131], v[24:27]
  ds_read_b128 v[64:67], v8 offset:53248
  v_mfma_f32_16x16x32_bf16 v[28:31], v[88:91], v[128:131], v[28:31]
  ds_read_b128 v[68:71], v8 offset:54272
  v_mfma_f32_16x16x32_bf16 v[32:35], v[92:95], v[128:131], v[32:35]
  ds_read_b128 v[72:75], v8 offset:55296
  s_add_u32 s46, s46, 4096
  buffer_load_dwordx4 v[160:163], v2, s[8:11], s46 offen offset:0 sc1
  s_waitcnt lgkmcnt(5)
  v_mfma_f32_16x16x32_bf16 v[16:19], v[36:39], v[132:135], v[16:19]
  ds_read_b128 v[76:79], v8 offset:56320
  v_mfma_f32_16x16x32_bf16 v[20:23], v[40:43], v[132:135], v[20:23]
  ds_read_b128 v[80:83], v8 offset:57344
  v_mfma_f32_16x16x32_bf16 v[24:27], v[44:47], v[132:135], v[24:27]
  ds_read_b128 v[84:87], v8 offset:58368
  v_mfma_f32_16x16x32_bf16 v[28:31], v[48:51], v[132:135], v[28:31]
  ds_read_b128 v[88:91], v8 offset:59392
  v_mfma_f32_16x16x32_bf16 v[32:35], v[52:55], v[132:135], v[32:35]
  ds_read_b128 v[92:95], v8 offset:60416
  buffer_load_dwordx4 v[164:167], v2, s[8:11], s46 offen offset:1024 sc1
  s_waitcnt vmcnt(6)
  s_waitcnt lgkmcnt(5)
  v_mfma_f32_16x16x32_bf16 v[16:19], v[56:59], v[136:139], v[16:19]
  ds_read_b128 v[36:39], v8 offset:61440
  v_mfma_f32_16x16x32_bf16 v[20:23], v[60:63], v[136:139], v[20:23]
  ds_read_b128 v[40:43], v8 offset:62464
  v_mfma_f32_16x16x32_bf16 v[24:27], v[64:67], v[136:139], v[24:27]
  ds_read_b128 v[44:47], v8 offset:63488
  v_mfma_f32_16x16x32_bf16 v[28:31], v[68:71], v[136:139], v[28:31]
  ds_read_b128 v[48:51], v8 offset:64512
  v_mfma_f32_16x16x32_bf16 v[32:35], v[72:75], v[136:139], v[32:35]
  ds_read_b128 v[52:55], v9 offset:0
  buffer_load_dwordx4 v[168:171], v2, s[8:11], s46 offen offset:2048 sc1
  s_waitcnt lgkmcnt(5)
  v_mfma_f32_16x16x32_bf16 v[16:19], v[76:79], v[140:143], v[16:19]
  ds_read_b128 v[56:59], v9 offset:1024
  v_mfma_f32_16x16x32_bf16 v[20:23], v[80:83], v[140:143], v[20:23]
  ds_read_b128 v[60:63], v9 offset:2048
  v_mfma_f32_16x16x32_bf16 v[24:27], v[84:87], v[140:143], v[24:27]
  ds_read_b128 v[64:67], v9 offset:3072
  v_mfma_f32_16x16x32_bf16 v[28:31], v[88:91], v[140:143], v[28:31]
  ds_read_b128 v[68:71], v9 offset:4096
  v_mfma_f32_16x16x32_bf16 v[32:35], v[92:95], v[140:143], v[32:35]
  ds_read_b128 v[72:75], v9 offset:5120
  buffer_load_dwordx4 v[172:175], v2, s[8:11], s46 offen offset:3072 sc1
  s_waitcnt vmcnt(6)
  s_waitcnt lgkmcnt(5)
  v_mfma_f32_16x16x32_bf16 v[16:19], v[36:39], v[144:147], v[16:19]
  ds_read_b128 v[76:79], v9 offset:6144
  v_mfma_f32_16x16x32_bf16 v[20:23], v[40:43], v[144:147], v[20:23]
  ds_read_b128 v[80:83], v9 offset:7168
  v_mfma_f32_16x16x32_bf16 v[24:27], v[44:47], v[144:147], v[24:27]
  ds_read_b128 v[84:87], v9 offset:8192
  v_mfma_f32_16x16x32_bf16 v[28:31], v[48:51], v[144:147], v[28:31]
  ds_read_b128 v[88:91], v9 offset:9216
  v_mfma_f32_16x16x32_bf16 v[32:35], v[52:55], v[144:147], v[32:35]
  ds_read_b128 v[92:95], v9 offset:10240
  s_waitcnt lgkmcnt(5)
  v_mfma_f32_16x16x32_bf16 v[16:19], v[56:59], v[148:151], v[16:19]
  ds_read_b128 v[36:39], v9 offset:11264
  v_mfma_f32_16x16x32_bf16 v[20:23], v[60:63], v[148:151], v[20:23]
  ds_read_b128 v[40:43], v9 offset:12288
  v_mfma_f32_16x16x32_bf16 v[24:27], v[64:67], v[148:151], v[24:27]
  ds_read_b128 v[44:47], v9 offset:13312
  v_mfma_f32_16x16x32_bf16 v[28:31], v[68:71], v[148:151], v[28:31]
  ds_read_b128 v[48:51], v9 offset:14336
  v_mfma_f32_16x16x32_bf16 v[32:35], v[72:75], v[148:151], v[32:35]
  ds_read_b128 v[52:55], v9 offset:15360
  s_waitcnt vmcnt(4)
  s_waitcnt lgkmcnt(5)
  v_mfma_f32_16x16x32_bf16 v[16:19], v[76:79], v[152:155], v[16:19]
  ds_read_b128 v[56:59], v9 offset:16384
  v_mfma_f32_16x16x32_bf16 v[20:23], v[80:83], v[152:155], v[20:23]
  ds_read_b128 v[60:63], v9 offset:17408
  v_mfma_f32_16x16x32_bf16 v[24:27], v[84:87], v[152:155], v[24:27]
  ds_read_b128 v[64:67], v9 offset:18432
  v_mfma_f32_16x16x32_bf16 v[28:31], v[88:91], v[152:155], v[28:31]
  ds_read_b128 v[68:71], v9 offset:19456
  v_mfma_f32_16x16x32_bf16 v[32:35], v[92:95], v[152:155], v[32:35]
  ds_read_b128 v[72:75], v9 offset:20480
  s_waitcnt lgkmcnt(5)
  v_mfma_f32_16x16x32_bf16 v[16:19], v[36:39], v[156:159], v[16:19]
  ds_read_b128 v[76:79], v9 offset:21504
  v_mfma_f32_16x16x32_bf16 v[20:23], v[40:43], v[156:159], v[20:23]
  ds_read_b128 v[80:83], v9 offset:22528
  v_mfma_f32_16x16x32_bf16 v[24:27], v[44:47], v[156:159], v[24:27]
  ds_read_b128 v[84:87], v9 offset:23552
  v_mfma_f32_16x16x32_bf16 v[28:31], v[48:51], v[156:159], v[28:31]
  ds_read_b128 v[88:91], v9 offset:24576
  v_mfma_f32_16x16x32_bf16 v[32:35], v[52:55], v[156:159], v[32:35]
  ds_read_b128 v[92:95], v9 offset:25600
  s_waitcnt vmcnt(2)
  s_waitcnt lgkmcnt(5)
  v_mfma_f32_16x16x32_bf16 v[16:19], v[56:59], v[160:163], v[16:19]
  ds_read_b128 v[36:39], v9 offset:26624
  v_mfma_f32_16x16x32_bf16 v[20:23], v[60:63], v[160:163], v[20:23]
  ds_read_b128 v[40:43], v9 offset:27648
  v_mfma_f32_16x16x32_bf16 v[24:27], v[64:67], v[160:163], v[24:27]
  ds_read_b128 v[44:47], v9 offset:28672
  v_mfma_f32_16x16x32_bf16 v[28:31], v[68:71], v[160:163], v[28:31]
  ds_read_b128 v[48:51], v9 offset:29696
  v_mfma_f32_16x16x32_bf16 v[32:35], v[72:75], v[160:163], v[32:35]
  ds_read_b128 v[52:55], v9 offset:30720
  s_waitcnt lgkmcnt(5)
  v_mfma_f32_16x16x32_bf16 v[16:19], v[76:79], v[164:167], v[16:19]
  ds_read_b128 v[56:59], v9 offset:31744
  v_mfma_f32_16x16x32_bf16 v[20:23], v[80:83], v[164:167], v[20:23]
  ds_read_b128 v[60:63], v9 offset:32768
  v_mfma_f32_16x16x32_bf16 v[24:27], v[84:87], v[164:167], v[24:27]
  ds_read_b128 v[64:67], v9 offset:33792
  v_mfma_f32_16x16x32_bf16 v[28:31], v[88:91], v[164:167], v[28:31]
  ds_read_b128 v[68:71], v9 offset:34816
  v_mfma_f32_16x16x32_bf16 v[32:35], v[92:95], v[164:167], v[32:35]
  ds_read_b128 v[72:75], v9 offset:35840
  s_waitcnt vmcnt(0)
  s_waitcnt lgkmcnt(5)
  v_mfma_f32_16x16x32_bf16 v[16:19], v[36:39], v[168:171], v[16:19]
  v_mfma_f32_16x16x32_bf16 v[20:23], v[40:43], v[168:171], v[20:23]
  v_mfma_f32_16x16x32_bf16 v[24:27], v[44:47], v[168:171], v[24:27]
  v_mfma_f32_16x16x32_bf16 v[28:31], v[48:51], v[168:171], v[28:31]
  v_mfma_f32_16x16x32_bf16 v[32:35], v[52:55], v[168:171], v[32:35]
  s_waitcnt lgkmcnt(0)
  v_mfma_f32_16x16x32_bf16 v[16:19], v[56:59], v[172:175], v[16:19]
  v_mfma_f32_16x16x32_bf16 v[20:23], v[60:63], v[172:175], v[20:23]
  v_mfma_f32_16x16x32_bf16 v[24:27], v[64:67], v[172:175], v[24:27]
  v_mfma_f32_16x16x32_bf16 v[28:31], v[68:71], v[172:175], v[28:31]
  v_mfma_f32_16x16x32_bf16 v[32:35], v[72:75], v[172:175], v[32:35]
  s_cmp_eq_u32 s32, 0
  s_mov_b32 s47, 11567104
  s_cselect_b32 s47, s47, 14188544
  s_cmp_eq_u32 s32, 0
  s_mov_b32 s48, 32538624
  s_cselect_b32 s48, s48, 33062912
  s_lshl_b32 s40, s29, 2
  s_add_u32 s40, s40, s28
  s_mul_i32 s40, s40, 20480
  s_add_u32 s42, s40, s47
  s_lshl_b32 s40, s30, 11
  s_add_u32 s40, s40, s42
  s_lshr_b32 s44, s30, 1
  s_add_u32 s44, s44, 16
  s_mul_i32 s44, s44, 1024
  s_and_b32 s41, s30, 1
  s_lshl_b32 s41, s41, 3
  s_add_u32 s44, s44, s41
  s_add_u32 s44, s44, s42
  v_cvt_pk_bf16_f32 v48, v16, v17
  v_cvt_pk_bf16_f32 v49, v18, v19
  v_cvt_pk_bf16_f32 v50, v20, v21
  v_cvt_pk_bf16_f32 v51, v22, v23
  v_cvt_pk_bf16_f32 v52, v24, v25
  v_cvt_pk_bf16_f32 v53, v26, v27
  v_cvt_pk_bf16_f32 v54, v28, v29
  v_cvt_pk_bf16_f32 v55, v30, v31
  v_cvt_pk_bf16_f32 v56, v32, v33
  v_cvt_pk_bf16_f32 v57, v34, v35
  s_cmp_eq_u32 s34, 0
  s_nop 0
  s_cbranch_scc1 HS_wt_87
  buffer_store_dwordx4 v[48:51], v2, s[8:11], s40 offen
  buffer_store_dwordx4 v[52:55], v2, s[8:11], s40 offen offset:1024
  buffer_store_dwordx2 v[56:57], v2, s[8:11], s44 offen
  s_nop 0
  s_branch HS_j_88
HS_wt_87:
  buffer_store_dwordx4 v[48:51], v2, s[8:11], s40 offen sc1
  buffer_store_dwordx4 v[52:55], v2, s[8:11], s40 offen offset:1024 sc1
  buffer_store_dwordx2 v[56:57], v2, s[8:11], s44 offen sc1
  s_nop 0
HS_j_88:
  v_pk_mul_f32 v[62:63], v[16:17], v[16:17]
  v_pk_add_f32 v[64:65], v[16:17], v[18:19]
  v_pk_fma_f32 v[62:63], v[18:19], v[18:19], v[62:63]
  v_pk_add_f32 v[64:65], v[64:65], v[20:21]
  v_pk_fma_f32 v[62:63], v[20:21], v[20:21], v[62:63]
  v_pk_add_f32 v[64:65], v[64:65], v[22:23]
  v_pk_fma_f32 v[62:63], v[22:23], v[22:23], v[62:63]
  v_pk_add_f32 v[64:65], v[64:65], v[24:25]
  v_pk_fma_f32 v[62:63], v[24:25], v[24:25], v[62:63]
  v_pk_add_f32 v[64:65], v[64:65], v[26:27]
  v_pk_fma_f32 v[62:63], v[26:27], v[26:27], v[62:63]
  v_pk_add_f32 v[64:65], v[64:65], v[28:29]
  v_pk_fma_f32 v[62:63], v[28:29], v[28:29], v[62:63]
  v_pk_add_f32 v[64:65], v[64:65], v[30:31]
  v_pk_fma_f32 v[62:63], v[30:31], v[30:31], v[62:63]
  v_pk_add_f32 v[64:65], v[64:65], v[32:33]
  v_pk_fma_f32 v[62:63], v[32:33], v[32:33], v[62:63]
  v_pk_add_f32 v[64:65], v[64:65], v[34:35]
  v_pk_fma_f32 v[62:63], v[34:35], v[34:35], v[62:63]
  v_add_f32 v60, v64, v65
  v_add_f32 v61, v62, v63
  s_lshl_b32 s40, s29, 2
  s_add_u32 s40, s40, s28
  s_lshl_b32 s40, s40, 3
  s_add_u32 s40, s40, s30
  s_lshl_b32 s40, s40, 9
  s_add_u32 s40, s40, s48
  v_lshlrev_b32 v62, 3, v1
  s_cmp_eq_u32 s34, 0
  s_nop 0
  s_cbranch_scc1 HS_wt_89
  buffer_store_dwordx2 v[60:61], v62, s[8:11], s40 offen
  s_branch HS_j_90
HS_wt_89:
  buffer_store_dwordx2 v[60:61], v62, s[8:11], s40 offen sc1
HS_j_90:
  v_accvgpr_write_b32 a246, v48
  v_accvgpr_write_b32 a247, v49
  v_accvgpr_write_b32 a248, v50
  v_accvgpr_write_b32 a249, v51
  v_accvgpr_write_b32 a250, v52
  v_accvgpr_write_b32 a251, v53
  v_accvgpr_write_b32 a252, v54
  v_accvgpr_write_b32 a253, v55
  v_accvgpr_write_b32 a254, v56
  v_accvgpr_write_b32 a255, v57
  s_waitcnt vmcnt(0)
  s_barrier
  s_cmp_eq_u32 s28, 0
  s_cbranch_scc0 SIG_91
  s_lshl_b32 s43, s32, 3
  s_add_u32 s43, s43, 2
  v_mov_b32 v255, s43
  s_mov_b64 exec, 1
  s_cmp_eq_u32 s34, 0
  s_cbranch_scc1 HS_wt_92
  buffer_store_dword v255, off, s[8:11], s33
  s_branch HS_j_93
HS_wt_92:
  buffer_store_dword v255, off, s[8:11], s33 sc1
HS_j_93:
  s_mov_b64 exec, -1
SIG_91:
  s_cmp_eq_u32 s32, 0
  s_mov_b32 s47, 11567104
  s_cselect_b32 s47, s47, 14188544
  s_cmp_eq_u32 s32, 0
  s_mov_b32 s48, 32538624
  s_cselect_b32 s48, s48, 33062912
  s_lshl_b32 s40, s29, 2
  s_mul_i32 s40, s40, 20480
  s_mul_i32 s41, s28, 5120
  s_add_u32 s40, s40, s41
  s_add_u32 s47, s47, s40
  s_cmp_eq_u32 s32, 0
  s_cbranch_scc0 F1_cs_94
  v_mov_b32 v12, 0x3f803f80
  v_mov_b32 v13, 0x3f803f80
  v_mov_b32 v14, 0x3f803f80
  v_mov_b32 v15, 0x3f803f80
  s_nop 1
  v_mfma_f32_16x16x32_bf16 v[240:243], a[0:3], v[12:15], 0
  v_mfma_f32_16x16x32_bf16 v[244:247], a[4:7], v[12:15], 0
  v_mfma_f32_16x16x32_bf16 v[248:251], a[8:11], v[12:15], 0
  v_mfma_f32_16x16x32_bf16 v[240:243], a[12:15], v[12:15], v[240:243]
  v_mfma_f32_16x16x32_bf16 v[244:247], a[16:19], v[12:15], v[244:247]
  v_mfma_f32_16x16x32_bf16 v[248:251], a[20:23], v[12:15], v[248:251]
  v_mfma_f32_16x16x32_bf16 v[240:243], a[24:27], v[12:15], v[240:243]
  v_mfma_f32_16x16x32_bf16 v[244:247], a[28:31], v[12:15], v[244:247]
  v_mfma_f32_16x16x32_bf16 v[248:251], a[32:35], v[12:15], v[248:251]
  v_mfma_f32_16x16x32_bf16 v[240:243], a[36:39], v[12:15], v[240:243]
  v_mfma_f32_16x16x32_bf16 v[244:247], a[40:43], v[12:15], v[244:247]
  v_mfma_f32_16x16x32_bf16 v[248:251], a[44:47], v[12:15], v[248:251]
  v_mfma_f32_16x16x32_bf16 v[240:243], a[48:51], v[12:15], v[240:243]
  v_mfma_f32_16x16x32_bf16 v[244:247], a[52:55], v[12:15], v[244:247]
  v_mfma_f32_16x16x32_bf16 v[248:251], a[56:59], v[12:15], v[248:251]
  v_mfma_f32_16x16x32_bf16 v[240:243], a[60:63], v[12:15], v[240:243]
  v_mfma_f32_16x16x32_bf16 v[244:247], a[64:67], v[12:15], v[244:247]
  v_mfma_f32_16x16x32_bf16 v[248:251], a[68:71], v[12:15], v[248:251]
  v_mfma_f32_16x16x32_bf16 v[240:243], a[72:75], v[12:15], v[240:243]
  v_mfma_f32_16x16x32_bf16 v[244:247], a[76:79], v[12:15], v[244:247]
  v_mfma_f32_16x16x32_bf16 v[248:251], a[80:83], v[12:15], v[248:251]
  v_mfma_f32_16x16x32_bf16 v[240:243], a[84:87], v[12:15], v[240:243]
  v_mfma_f32_16x16x32_bf16 v[244:247], a[88:91], v[12:15], v[244:247]
  v_mfma_f32_16x16x32_bf16 v[248:251], a[92:95], v[12:15], v[248:251]
  v_mfma_f32_16x16x32_bf16 v[240:243], a[96:99], v[12:15], v[240:243]
  v_mfma_f32_16x16x32_bf16 v[244:247], a[100:103], v[12:15], v[244:247]
  v_mfma_f32_16x16x32_bf16 v[248:251], a[104:107], v[12:15], v[248:251]
  v_mfma_f32_16x16x32_bf16 v[240:243], a[108:111], v[12:15], v[240:243]
  v_mfma_f32_16x16x32_bf16 v[244:247], a[112:115], v[12:15], v[244:247]
  v_mfma_f32_16x16x32_bf16 v[248:251], a[116:119], v[12:15], v[248:251]
  v_mfma_f32_16x16x32_bf16 v[240:243], a[120:123], v[12:15], v[240:243]
  v_mfma_f32_16x16x32_bf16 v[244:247], a[124:127], v[12:15], v[244:247]
  v_mfma_f32_16x16x32_bf16 v[248:251], a[128:131], v[12:15], v[248:251]
  v_mfma_f32_16x16x32_bf16 v[240:243], a[132:135], v[12:15], v[240:243]
  v_mfma_f32_16x16x32_bf16 v[244:247], a[136:139], v[12:15], v[244:247]
  v_mfma_f32_16x16x32_bf16 v[248:251], a[140:143], v[12:15], v[248:251]
  v_mfma_f32_16x16x32_bf16 v[240:243], a[144:147], v[12:15], v[240:243]
  v_mfma_f32_16x16x32_bf16 v[244:247], a[148:151], v[12:15], v[244:247]
  v_mfma_f32_16x16x32_bf16 v[248:251], a[152:155], v[12:15], v[248:251]
  v_mfma_f32_16x16x32_bf16 v[240:243], a[156:159], v[12:15], v[240:243]
  v_mfma_f32_16x16x32_bf16 v[244:247], a[160:163], v[12:15], v[244:247]
  v_mfma_f32_16x16x32_bf16 v[248:251], a[164:167], v[12:15], v[248:251]
  v_mfma_f32_16x16x32_bf16 v[240:243], a[168:171], v[12:15], v[240:243]
  v_mfma_f32_16x16x32_bf16 v[244:247], a[172:175], v[12:15], v[244:247]
  v_mfma_f32_16x16x32_bf16 v[248:251], a[176:179], v[12:15], v[248:251]
  v_mfma_f32_16x16x32_bf16 v[240:243], a[180:183], v[12:15], v[240:243]
  v_mfma_f32_16x16x32_bf16 v[244:247], a[184:187], v[12:15], v[244:247]
  v_mfma_f32_16x16x32_bf16 v[248:251], a[188:191], v[12:15], v[248:251]
  v_mfma_f32_16x16x32_bf16 v[240:243], a[192:195], v[12:15], v[240:243]
  v_mfma_f32_16x16x32_bf16 v[244:247], a[196:199], v[12:15], v[244:247]
  v_mfma_f32_16x16x32_bf16 v[248:251], a[200:203], v[12:15], v[248:251]
  v_mfma_f32_16x16x32_bf16 v[240:243], a[204:207], v[12:15], v[240:243]
  v_mfma_f32_16x16x32_bf16 v[244:247], a[208:211], v[12:15], v[244:247]
  v_mfma_f32_16x16x32_bf16 v[248:251], a[212:215], v[12:15], v[248:251]
  v_mfma_f32_16x16x32_bf16 v[240:243], a[216:219], v[12:15], v[240:243]
  v_mfma_f32_16x16x32_bf16 v[244:247], a[220:223], v[12:15], v[244:247]
  v_mfma_f32_16x16x32_bf16 v[248:251], a[224:227], v[12:15], v[248:251]
  v_mfma_f32_16x16x32_bf16 v[240:243], a[228:231], v[12:15], v[240:243]
  v_mfma_f32_16x16x32_bf16 v[244:247], a[232:235], v[12:15], v[244:247]
  v_mfma_f32_16x16x32_bf16 v[248:251], a[236:239], v[12:15], v[248:251]
  s_nop 7
F1_cs_94:
  s_cmp_eq_u32 s32, 0
  s_mov_b32 s44, 19431424
  s_cselect_b32 s44, s44, 25722880
  s_lshl_b32 s40, s29, 2
  s_mul_i32 s40, s40, 48
  s_mul_i32 s41, s30, 6
  s_add_u32 s40, s40, s41
  s_lshl_b32 s40, s40, 10
  s_add_u32 s44, s44, s40
  s_lshr_b32 s45, s28, 1
  s_add_u32 s45, s45, 4
  s_lshl_b32 s45, s45, 10
  s_and_b32 s41, s28, 1
  s_lshl_b32 s41, s41, 3
  s_add_u32 s45, s45, s41
  s_add_u32 s45, s45, s44
  s_lshl_b32 s41, s28, 10
  s_add_u32 s44, s44, s41
  v_lshlrev_b32 v10, 3, v3
  v_add_u32 v10, 81920, v10
  v_mov_b32 v14, 0xbdd2d3e8
  v_mov_b32 v15, 0xc0135761
  v_mov_b32 v42, v2
  v_add_u32 v43, 0x10000, v2
  s_sub_u32 s63, s28, 0
  s_mul_i32 s63, s63, 19456
  s_min_u32 s63, s63, 57344
  s_mul_i32 s62, s30, 245760
  s_add_u32 s62, s62, s63
  s_add_u32 s62, s62, 942080
  s_cmp_eq_u32 s32, 0
  s_cselect_b32 s40, 0, 0x40000000
  v_add_u32 v225, s40, v2
  s_lshr_b32 s40, s30, 2
  s_lshl_b32 s56, s40, 11
  s_add_u32 s56, s56, 118784
  s_lshl_b32 s40, s40, 2
  s_add_u32 s40, s40, s28
  s_mul_i32 s57, s40, 10240
  s_add_u32 s57, s57, 6184960
  s_lshl_b32 s40, s30, 2
  s_add_u32 s40, s40, s28
  s_mul_i32 s64, s40, 3072
  s_add_u32 s64, s64, 20480
  s_lshl_b32 s68, s30, 8
  s_add_u32 s68, s68, 6299648
  s_lshl_b32 s69, s30, 6
  s_add_u32 s69, s69, 6301696
  v_lshlrev_b32 v11, 4, v4
  s_cmp_eq_u32 s32, 0
  s_mov_b32 s88, 16809984
  s_cselect_b32 s88, s88, 16809984
  s_lshl_b32 s40, s29, 3
  s_add_u32 s40, s40, s30
  s_lshl_b32 s40, s40, 2
  s_add_u32 s40, s40, s28
  s_mul_i32 s40, s40, 2560
  s_add_u32 s88, s88, s40
  v_min_u32 v226, 19, v1
  v_lshlrev_b32 v226, 7, v226
  v_add_u32 v226, s38, v226
  s_cmp_eq_u32 s32, 0
  s_cselect_b32 s40, 0, 0x40000000
  v_or_b32 v226, s40, v226
  s_mul_i32 s75, s28, 5120
  s_cmp_eq_u32 s28, 0
  s_cbranch_scc0 WC_95
  s_lshl_b32 s43, s32, 3
  s_add_u32 s43, s43, 2
  s_mov_b64 exec, 0xff
  v_lshlrev_b32 v254, 2, v1
  s_mov_b32 s42, 400000
  s_nop 0
WCP_96:
  buffer_load_dword v255, v254, s[8:11], s39 offen sc1
  s_waitcnt vmcnt(0)
  v_cmp_gt_u32 vcc, s43, v255
  s_cmp_eq_u64 vcc, 0
  s_nop 3
  s_cbranch_scc1 WCP_done_97
  s_sub_u32 s42, s42, 1
  s_cmp_lg_u32 s42, 0
  s_cbranch_scc1 WCP_96
WCP_done_97:
  s_mov_b64 exec, -1
WC_95:
  s_barrier
  s_add_u32 m0, s75, 0
  s_add_u32 s76, s47, 4096
  buffer_load_dwordx4 v2, s[8:11], s47 offen offset:0 sc1 lds
  buffer_load_dwordx4 v2, s[8:11], s47 offen offset:1024 sc1 lds
  buffer_load_dwordx4 v2, s[8:11], s47 offen offset:2048 sc1 lds
  buffer_load_dwordx4 v2, s[8:11], s47 offen offset:3072 sc1 lds
  s_add_u32 m0, s75, 4096
  s_add_u32 s47, s47, 20480
  buffer_load_dwordx4 v2, s[8:11], s76 offen offset:0 sc1 lds
  s_add_u32 m0, s75, 20480
  s_add_u32 s76, s47, 4096
  buffer_load_dwordx4 v2, s[8:11], s47 offen offset:0 sc1 lds
  buffer_load_dwordx4 v2, s[8:11], s47 offen offset:1024 sc1 lds
  buffer_load_dwordx4 v2, s[8:11], s47 offen offset:2048 sc1 lds
  buffer_load_dwordx4 v2, s[8:11], s47 offen offset:3072 sc1 lds
  s_add_u32 m0, s75, 24576
  s_add_u32 s47, s47, 20480
  buffer_load_dwordx4 v2, s[8:11], s76 offen offset:0 sc1 lds
  s_lshl_b32 s40, s29, 2
  s_add_u32 s40, s40, s28
  s_lshl_b32 s40, s40, 12
  s_add_u32 s40, s40, s48
  v_lshlrev_b32 v80, 3, v1
  buffer_load_dwordx2 v[64:65], v80, s[8:11], s40 offen offset:0 sc1
  buffer_load_dwordx2 v[66:67], v80, s[8:11], s40 offen offset:512 sc1
  buffer_load_dwordx2 v[68:69], v80, s[8:11], s40 offen offset:1024 sc1
  buffer_load_dwordx2 v[70:71], v80, s[8:11], s40 offen offset:1536 sc1
  buffer_load_dwordx2 v[72:73], v80, s[8:11], s40 offen offset:2048 sc1
  buffer_load_dwordx2 v[74:75], v80, s[8:11], s40 offen offset:2560 sc1
  buffer_load_dwordx2 v[76:77], v80, s[8:11], s40 offen offset:3072 sc1
  buffer_load_dwordx2 v[78:79], v80, s[8:11], s40 offen offset:3584 sc1
  s_waitcnt vmcnt(13)
  s_barrier
  ds_read_b128 v[176:179], v42 offset:0
  ds_read_b128 v[180:183], v42 offset:1024
  ds_read_b128 v[184:187], v42 offset:2048
  ds_read_b128 v[188:191], v42 offset:3072
  ds_read_b128 v[192:195], v42 offset:4096
  ds_read_b128 v[196:199], v42 offset:5120
  s_waitcnt lgkmcnt(4)
  v_mfma_f32_16x16x32_bf16 v[16:19], a[0:3], v[176:179], 0
  ds_read_b128 v[200:203], v42 offset:6144
  v_mfma_f32_16x16x32_bf16 v[20:23], a[4:7], v[176:179], 0
  s_add_u32 m0, s75, 40960
  s_add_u32 s76, s47, 4096
  buffer_load_dwordx4 v2, s[8:11], s47 offen offset:0 sc1 lds
  v_mfma_f32_16x16x32_bf16 v[24:27], a[8:11], v[176:179], 0
  v_mfma_f32_16x16x32_bf16 v[16:19], a[12:15], v[180:183], v[16:19]
  ds_read_b128 v[204:207], v42 offset:7168
  v_mfma_f32_16x16x32_bf16 v[20:23], a[16:19], v[180:183], v[20:23]
  v_mfma_f32_16x16x32_bf16 v[24:27], a[20:23], v[180:183], v[24:27]
  s_waitcnt lgkmcnt(4)
  v_mfma_f32_16x16x32_bf16 v[16:19], a[24:27], v[184:187], v[16:19]
  ds_read_b128 v[176:179], v42 offset:8192
  v_mfma_f32_16x16x32_bf16 v[20:23], a[28:31], v[184:187], v[20:23]
  buffer_load_dwordx4 v2, s[8:11], s47 offen offset:1024 sc1 lds
  v_mfma_f32_16x16x32_bf16 v[24:27], a[32:35], v[184:187], v[24:27]
  v_mfma_f32_16x16x32_bf16 v[16:19], a[36:39], v[188:191], v[16:19]
  ds_read_b128 v[180:183], v42 offset:9216
  v_mfma_f32_16x16x32_bf16 v[20:23], a[40:43], v[188:191], v[20:23]
  v_mfma_f32_16x16x32_bf16 v[24:27], a[44:47], v[188:191], v[24:27]
  s_waitcnt lgkmcnt(4)
  v_mfma_f32_16x16x32_bf16 v[16:19], a[48:51], v[192:195], v[16:19]
  ds_read_b128 v[184:187], v42 offset:10240
  v_mfma_f32_16x16x32_bf16 v[20:23], a[52:55], v[192:195], v[20:23]
  buffer_load_dwordx4 v2, s[8:11], s47 offen offset:2048 sc1 lds
  v_mfma_f32_16x16x32_bf16 v[24:27], a[56:59], v[192:195], v[24:27]
  v_mfma_f32_16x16x32_bf16 v[16:19], a[60:63], v[196:199], v[16:19]
  ds_read_b128 v[188:191], v42 offset:11264
  v_mfma_f32_16x16x32_bf16 v[20:23], a[64:67], v[196:199], v[20:23]
  v_mfma_f32_16x16x32_bf16 v[24:27], a[68:71], v[196:199], v[24:27]
  s_waitcnt lgkmcnt(4)
  v_mfma_f32_16x16x32_bf16 v[16:19], a[72:75], v[200:203], v[16:19]
  ds_read_b128 v[192:195], v42 offset:12288
  v_mfma_f32_16x16x32_bf16 v[20:23], a[76:79], v[200:203], v[20:23]
  buffer_load_dwordx4 v2, s[8:11], s47 offen offset:3072 sc1 lds
  v_mfma_f32_16x16x32_bf16 v[24:27], a[80:83], v[200:203], v[24:27]
  v_mfma_f32_16x16x32_bf16 v[16:19], a[84:87], v[204:207], v[16:19]
  ds_read_b128 v[196:199], v42 offset:13312
  s_waitcnt vmcnt(4)
  v_add_f32 v64, v64, v66
  v_mfma_f32_16x16x32_bf16 v[20:23], a[88:91], v[204:207], v[20:23]
  v_add_f32 v65, v65, v67
  v_mfma_f32_16x16x32_bf16 v[24:27], a[92:95], v[204:207], v[24:27]
  s_waitcnt lgkmcnt(4)
  v_add_f32 v64, v64, v68
  v_mfma_f32_16x16x32_bf16 v[16:19], a[96:99], v[176:179], v[16:19]
  ds_read_b128 v[200:203], v42 offset:14336
  v_add_f32 v65, v65, v69
  v_mfma_f32_16x16x32_bf16 v[20:23], a[100:103], v[176:179], v[20:23]
  s_add_u32 m0, s75, 45056
  s_add_u32 s47, s47, 20480
  buffer_load_dwordx4 v2, s[8:11], s76 offen offset:0 sc1 lds
  v_add_f32 v64, v64, v70
  v_mfma_f32_16x16x32_bf16 v[24:27], a[104:107], v[176:179], v[24:27]
  v_add_f32 v65, v65, v71
  v_mfma_f32_16x16x32_bf16 v[16:19], a[108:111], v[180:183], v[16:19]
  ds_read_b128 v[204:207], v42 offset:15360
  v_add_f32 v64, v64, v72
  v_mfma_f32_16x16x32_bf16 v[20:23], a[112:115], v[180:183], v[20:23]
  v_add_f32 v65, v65, v73
  v_mfma_f32_16x16x32_bf16 v[24:27], a[116:119], v[180:183], v[24:27]
  s_waitcnt lgkmcnt(4)
  v_add_f32 v64, v64, v74
  v_add_f32 v65, v65, v75
  v_mfma_f32_16x16x32_bf16 v[16:19], a[120:123], v[184:187], v[16:19]
  ds_read_b128 v[176:179], v42 offset:16384
  v_add_f32 v64, v64, v76
  v_mfma_f32_16x16x32_bf16 v[20:23], a[124:127], v[184:187], v[20:23]
  s_add_u32 m0, s75, 61440
  s_add_u32 s76, s47, 4096
  buffer_load_dwordx4 v2, s[8:11], s47 offen offset:0 sc1 lds
  v_add_f32 v65, v65, v77
  v_mfma_f32_16x16x32_bf16 v[24:27], a[128:131], v[184:187], v[24:27]
  v_add_f32 v64, v64, v78
  v_mfma_f32_16x16x32_bf16 v[16:19], a[132:135], v[188:191], v[16:19]
  ds_read_b128 v[180:183], v42 offset:17408
  v_add_f32 v65, v65, v79
  v_mfma_f32_16x16x32_bf16 v[20:23], a[136:139], v[188:191], v[20:23]
  v_mov_b32 v66, v64
  v_mfma_f32_16x16x32_bf16 v[24:27], a[140:143], v[188:191], v[24:27]
  s_waitcnt lgkmcnt(4)
  v_permlane16_swap_b32 v64, v66
  v_mfma_f32_16x16x32_bf16 v[16:19], a[144:147], v[192:195], v[16:19]
  ds_read_b128 v[184:187], v42 offset:18432
  v_add_f32 v64, v64, v66
  v_mfma_f32_16x16x32_bf16 v[20:23], a[148:151], v[192:195], v[20:23]
  buffer_load_dwordx4 v2, s[8:11], s47 offen offset:1024 sc1 lds
  v_mov_b32 v66, v64
  v_mfma_f32_16x16x32_bf16 v[24:27], a[152:155], v[192:195], v[24:27]
  s_nop 0
  v_permlane32_swap_b32 v64, v66
  v_add_f32 v64, v64, v66
  v_mfma_f32_16x16x32_bf16 v[16:19], a[156:159], v[196:199], v[16:19]
  ds_read_b128 v[188:191], v42 offset:19456
  v_mov_b32 v67, v65
  v_mfma_f32_16x16x32_bf16 v[20:23], a[160:163], v[196:199], v[20:23]
  s_nop 0
  v_permlane16_swap_b32 v65, v67
  v_mfma_f32_16x16x32_bf16 v[24:27], a[164:167], v[196:199], v[24:27]
  s_waitcnt lgkmcnt(4)
  v_add_f32 v65, v65, v67
  v_mfma_f32_16x16x32_bf16 v[16:19], a[168:171], v[200:203], v[16:19]
  v_mov_b32 v67, v65
  v_mfma_f32_16x16x32_bf16 v[20:23], a[172:175], v[200:203], v[20:23]
  buffer_load_dwordx4 v2, s[8:11], s47 offen offset:2048 sc1 lds
  v_permlane32_swap_b32 v65, v67
  v_mfma_f32_16x16x32_bf16 v[24:27], a[176:179], v[200:203], v[24:27]
  v_add_f32 v65, v65, v67
  v_mfma_f32_16x16x32_bf16 v[16:19], a[180:183], v[204:207], v[16:19]
  v_mul_f32 v64, 0x3acccccd, v64
  v_mfma_f32_16x16x32_bf16 v[20:23], a[184:187], v[204:207], v[20:23]
  v_mul_f32 v65, 0x3acccccd, v65
  v_mfma_f32_16x16x32_bf16 v[24:27], a[188:191], v[204:207], v[24:27]
  s_waitcnt lgkmcnt(2)
  v_fma_f32 v65, -v64, v64, v65
  v_max_f32 v65, 0, v65
  v_mfma_f32_16x16x32_bf16 v[16:19], a[192:195], v[176:179], v[16:19]
  v_add_f32 v65, 0x3727c5ac, v65
  v_mfma_f32_16x16x32_bf16 v[20:23], a[196:199], v[176:179], v[20:23]
  buffer_load_dwordx4 v2, s[8:11], s47 offen offset:3072 sc1 lds
  v_rsq_f32 v66, v65
  v_mfma_f32_16x16x32_bf16 v[24:27], a[200:203], v[176:179], v[24:27]
  v_mul_f32 v67, v64, v66
  v_mfma_f32_16x16x32_bf16 v[16:19], a[204:207], v[180:183], v[16:19]
  v_sub_f32 v67, 0, v67
  v_mfma_f32_16x16x32_bf16 v[20:23], a[208:211], v[180:183], v[20:23]
  s_lshl_b32 s40, s28, 7
  v_mfma_f32_16x16x32_bf16 v[24:27], a[212:215], v[180:183], v[24:27]
  s_waitcnt lgkmcnt(0)
  s_add_u32 s40, s40, 81920
  v_mfma_f32_16x16x32_bf16 v[16:19], a[216:219], v[184:187], v[16:19]
  v_lshlrev_b32 v68, 3, v3
  v_mfma_f32_16x16x32_bf16 v[20:23], a[220:223], v[184:187], v[20:23]
  s_add_u32 m0, s75, 65536
  s_add_u32 s47, s47, 20480
  buffer_load_dwordx4 v2, s[8:11], s76 offen offset:0 sc1 lds
  v_add_u32 v68, s40, v68
  v_mfma_f32_16x16x32_bf16 v[24:27], a[224:227], v[184:187], v[24:27]
  s_mov_b64 exec, 0xffff
  ds_write_b64 v68, v[66:67]
  s_mov_b64 exec, -1
  v_mfma_f32_16x16x32_bf16 v[16:19], a[228:231], v[188:191], v[16:19]
  v_mfma_f32_16x16x32_bf16 v[20:23], a[232:235], v[188:191], v[20:23]
  v_mfma_f32_16x16x32_bf16 v[24:27], a[236:239], v[188:191], v[24:27]
  s_waitcnt lgkmcnt(0)
  s_barrier
  ds_read_b128 v[192:195], v42 offset:20480
  ds_read_b128 v[196:199], v42 offset:21504
  ds_read_b128 v[200:203], v42 offset:22528
  ds_read_b128 v[204:207], v42 offset:23552
  ds_read_b128 v[176:179], v42 offset:24576
  ds_read_b128 v[180:183], v42 offset:25600
  ds_read_b64 v[12:13], v10 offset:0
  ds_read_b64 v[40:41], v10 offset:128
  s_waitcnt lgkmcnt(6)
  s_waitcnt lgkmcnt(1)
  v_mfma_f32_16x16x32_bf16 v[28:31], a[0:3], v[192:195], 0
  ds_read_b128 v[184:187], v42 offset:26624
  v_fma_f32 v56, v13, v240, v228
  v_fma_f32 v57, v13, v241, v229
  v_fma_f32 v16, v16, v12, v56
  v_mfma_f32_16x16x32_bf16 v[32:35], a[4:7], v[192:195], 0
  buffer_load_dword v227, v226, s[8:11], s88 offen sc1
  v_fma_f32 v17, v17, v12, v57
  v_mul_f32 v56, v16, v16
  v_mul_f32 v57, v17, v17
  v_mfma_f32_16x16x32_bf16 v[36:39], a[8:11], v[192:195], 0
  v_fma_f32 v56, v56, v14, v15
  v_fma_f32 v57, v57, v14, v15
  v_mfma_f32_16x16x32_bf16 v[28:31], a[12:15], v[196:199], v[28:31]
  ds_read_b128 v[188:191], v42 offset:27648
  v_mul_f32 v56, v56, v16
  v_mul_f32 v57, v57, v17
  v_exp_f32 v56, v56
  v_mfma_f32_16x16x32_bf16 v[32:35], a[16:19], v[196:199], v[32:35]
  s_add_u32 m0, s63, 83968
  s_add_u32 s41, s62, 0
  buffer_load_dwordx4 v2, s[8:11], s41 offen offset:0 sc1 lds
  v_exp_f32 v57, v57
  v_mfma_f32_16x16x32_bf16 v[36:39], a[20:23], v[196:199], v[36:39]
  v_add_f32 v56, 1.0, v56
  v_add_f32 v57, 1.0, v57
  v_mfma_f32_16x16x32_bf16 v[28:31], a[24:27], v[200:203], v[28:31]
  ds_read_b128 v[192:195], v42 offset:28672
  v_rcp_f32 v56, v56
  v_mfma_f32_16x16x32_bf16 v[32:35], a[28:31], v[200:203], v[32:35]
  v_rcp_f32 v57, v57
  v_mul_f32 v16, v16, v56
  v_mfma_f32_16x16x32_bf16 v[36:39], a[32:35], v[200:203], v[36:39]
  v_mul_f32 v17, v17, v57
  v_cvt_pk_bf16_f32 v48, v16, v17
  v_mfma_f32_16x16x32_bf16 v[28:31], a[36:39], v[204:207], v[28:31]
  ds_read_b128 v[196:199], v42 offset:29696
  v_fma_f32 v56, v13, v242, v230
  v_fma_f32 v57, v13, v243, v231
  v_fma_f32 v18, v18, v12, v56
  v_mfma_f32_16x16x32_bf16 v[32:35], a[40:43], v[204:207], v[32:35]
  buffer_load_dwordx4 v2, s[8:11], s41 offen offset:1024 sc1 lds
  v_fma_f32 v19, v19, v12, v57
  v_mul_f32 v56, v18, v18
  v_mul_f32 v57, v19, v19
  v_mfma_f32_16x16x32_bf16 v[36:39], a[44:47], v[204:207], v[36:39]
  v_fma_f32 v56, v56, v14, v15
  v_fma_f32 v57, v57, v14, v15
  v_mfma_f32_16x16x32_bf16 v[28:31], a[48:51], v[176:179], v[28:31]
  ds_read_b128 v[200:203], v42 offset:30720
  v_mul_f32 v56, v56, v18
  v_mul_f32 v57, v57, v19
  v_exp_f32 v56, v56
  v_mfma_f32_16x16x32_bf16 v[32:35], a[52:55], v[176:179], v[32:35]
  buffer_load_dwordx4 v2, s[8:11], s41 offen offset:2048 sc1 lds
  v_exp_f32 v57, v57
  v_mfma_f32_16x16x32_bf16 v[36:39], a[56:59], v[176:179], v[36:39]
  v_add_f32 v56, 1.0, v56
  v_add_f32 v57, 1.0, v57
  v_mfma_f32_16x16x32_bf16 v[28:31], a[60:63], v[180:183], v[28:31]
  ds_read_b128 v[204:207], v42 offset:31744
  v_rcp_f32 v56, v56
  v_mfma_f32_16x16x32_bf16 v[32:35], a[64:67], v[180:183], v[32:35]
  v_rcp_f32 v57, v57
  v_mul_f32 v18, v18, v56
  v_mfma_f32_16x16x32_bf16 v[36:39], a[68:71], v[180:183], v[36:39]
  s_waitcnt lgkmcnt(4)
  v_mul_f32 v19, v19, v57
  v_cvt_pk_bf16_f32 v49, v18, v19
  v_mfma_f32_16x16x32_bf16 v[28:31], a[72:75], v[184:187], v[28:31]
  ds_read_b128 v[176:179], v42 offset:32768
  v_fma_f32 v56, v13, v244, v232
  v_fma_f32 v57, v13, v245, v233
  v_fma_f32 v20, v20, v12, v56
  v_mfma_f32_16x16x32_bf16 v[32:35], a[76:79], v[184:187], v[32:35]
  buffer_load_dwordx4 v2, s[8:11], s41 offen offset:3072 sc1 lds
  v_fma_f32 v21, v21, v12, v57
  v_mul_f32 v56, v20, v20
  v_mul_f32 v57, v21, v21
  v_mfma_f32_16x16x32_bf16 v[36:39], a[80:83], v[184:187], v[36:39]
  v_fma_f32 v56, v56, v14, v15
  v_fma_f32 v57, v57, v14, v15
  v_mfma_f32_16x16x32_bf16 v[28:31], a[84:87], v[188:191], v[28:31]
  ds_read_b128 v[180:183], v42 offset:33792
  v_mul_f32 v56, v56, v20
  v_mul_f32 v57, v57, v21
  v_exp_f32 v56, v56
  v_mfma_f32_16x16x32_bf16 v[32:35], a[88:91], v[188:191], v[32:35]
  s_add_u32 m0, s63, 88064
  s_add_u32 s41, s62, 4096
  buffer_load_dwordx4 v2, s[8:11], s41 offen offset:0 sc1 lds
  v_exp_f32 v57, v57
  v_mfma_f32_16x16x32_bf16 v[36:39], a[92:95], v[188:191], v[36:39]
  s_waitcnt lgkmcnt(4)
  v_add_f32 v56, 1.0, v56
  v_add_f32 v57, 1.0, v57
  v_mfma_f32_16x16x32_bf16 v[28:31], a[96:99], v[192:195], v[28:31]
  ds_read_b128 v[184:187], v42 offset:34816
  v_rcp_f32 v56, v56
  v_mfma_f32_16x16x32_bf16 v[32:35], a[100:103], v[192:195], v[32:35]
  v_rcp_f32 v57, v57
  v_mul_f32 v20, v20, v56
  v_mfma_f32_16x16x32_bf16 v[36:39], a[104:107], v[192:195], v[36:39]
  v_mul_f32 v21, v21, v57
  v_cvt_pk_bf16_f32 v50, v20, v21
  v_mfma_f32_16x16x32_bf16 v[28:31], a[108:111], v[196:199], v[28:31]
  ds_read_b128 v[188:191], v42 offset:35840
  v_fma_f32 v56, v13, v246, v234
  v_fma_f32 v57, v13, v247, v235
  v_fma_f32 v22, v22, v12, v56
  v_mfma_f32_16x16x32_bf16 v[32:35], a[112:115], v[196:199], v[32:35]
  buffer_load_dwordx4 v2, s[8:11], s41 offen offset:1024 sc1 lds
  v_fma_f32 v23, v23, v12, v57
  v_mul_f32 v56, v22, v22
  v_mul_f32 v57, v23, v23
  v_mfma_f32_16x16x32_bf16 v[36:39], a[116:119], v[196:199], v[36:39]
  s_waitcnt lgkmcnt(4)
  v_fma_f32 v56, v56, v14, v15
  v_fma_f32 v57, v57, v14, v15
  v_mfma_f32_16x16x32_bf16 v[28:31], a[120:123], v[200:203], v[28:31]
  ds_read_b128 v[192:195], v42 offset:36864
  v_mul_f32 v56, v56, v22
  v_mul_f32 v57, v57, v23
  v_exp_f32 v56, v56
  v_mfma_f32_16x16x32_bf16 v[32:35], a[124:127], v[200:203], v[32:35]
  buffer_load_dwordx4 v2, s[8:11], s41 offen offset:2048 sc1 lds
  v_exp_f32 v57, v57
  v_mfma_f32_16x16x32_bf16 v[36:39], a[128:131], v[200:203], v[36:39]
  v_add_f32 v56, 1.0, v56
  v_add_f32 v57, 1.0, v57
  v_mfma_f32_16x16x32_bf16 v[28:31], a[132:135], v[204:207], v[28:31]
  ds_read_b128 v[196:199], v42 offset:37888
  v_rcp_f32 v56, v56
  v_mfma_f32_16x16x32_bf16 v[32:35], a[136:139], v[204:207], v[32:35]
  v_rcp_f32 v57, v57
  v_mul_f32 v22, v22, v56
  v_mfma_f32_16x16x32_bf16 v[36:39], a[140:143], v[204:207], v[36:39]
  s_waitcnt lgkmcnt(4)
  v_mul_f32 v23, v23, v57
  v_cvt_pk_bf16_f32 v51, v22, v23
  v_mfma_f32_16x16x32_bf16 v[28:31], a[144:147], v[176:179], v[28:31]
  ds_read_b128 v[200:203], v42 offset:38912
  v_fma_f32 v56, v13, v248, v236
  v_fma_f32 v57, v13, v249, v237
  v_fma_f32 v24, v24, v12, v56
  v_mfma_f32_16x16x32_bf16 v[32:35], a[148:151], v[176:179], v[32:35]
  buffer_load_dwordx4 v2, s[8:11], s41 offen offset:3072 sc1 lds
  v_fma_f32 v25, v25, v12, v57
  v_mul_f32 v56, v24, v24
  v_mul_f32 v57, v25, v25
  v_mfma_f32_16x16x32_bf16 v[36:39], a[152:155], v[176:179], v[36:39]
  v_fma_f32 v56, v56, v14, v15
  v_fma_f32 v57, v57, v14, v15
  v_mfma_f32_16x16x32_bf16 v[28:31], a[156:159], v[180:183], v[28:31]
  ds_read_b128 v[204:207], v42 offset:39936
  v_mul_f32 v56, v56, v24
  v_mul_f32 v57, v57, v25
  v_exp_f32 v56, v56
  v_mfma_f32_16x16x32_bf16 v[32:35], a[160:163], v[180:183], v[32:35]
  s_add_u32 m0, s63, 92160
  s_add_u32 s41, s62, 8192
  buffer_load_dwordx4 v2, s[8:11], s41 offen offset:0 sc1 lds
  v_exp_f32 v57, v57
  v_mfma_f32_16x16x32_bf16 v[36:39], a[164:167], v[180:183], v[36:39]
  s_waitcnt lgkmcnt(4)
  v_add_f32 v56, 1.0, v56
  v_add_f32 v57, 1.0, v57
  v_mfma_f32_16x16x32_bf16 v[28:31], a[168:171], v[184:187], v[28:31]
  v_rcp_f32 v56, v56
  v_mfma_f32_16x16x32_bf16 v[32:35], a[172:175], v[184:187], v[32:35]
  v_rcp_f32 v57, v57
  v_mul_f32 v24, v24, v56
  v_mfma_f32_16x16x32_bf16 v[36:39], a[176:179], v[184:187], v[36:39]
  v_mul_f32 v25, v25, v57
  v_cvt_pk_bf16_f32 v52, v24, v25
  v_mfma_f32_16x16x32_bf16 v[28:31], a[180:183], v[188:191], v[28:31]
  v_fma_f32 v56, v13, v250, v238
  v_fma_f32 v57, v13, v251, v239
  v_fma_f32 v26, v26, v12, v56
  v_mfma_f32_16x16x32_bf16 v[32:35], a[184:187], v[188:191], v[32:35]
  buffer_load_dwordx4 v2, s[8:11], s41 offen offset:1024 sc1 lds
  v_fma_f32 v27, v27, v12, v57
  v_mul_f32 v56, v26, v26
  v_mul_f32 v57, v27, v27
  v_mfma_f32_16x16x32_bf16 v[36:39], a[188:191], v[188:191], v[36:39]
  s_waitcnt lgkmcnt(2)
  v_fma_f32 v56, v56, v14, v15
  v_fma_f32 v57, v57, v14, v15
  v_mfma_f32_16x16x32_bf16 v[28:31], a[192:195], v[192:195], v[28:31]
  v_mul_f32 v56, v56, v26
  v_mul_f32 v57, v57, v27
  v_exp_f32 v56, v56
  v_mfma_f32_16x16x32_bf16 v[32:35], a[196:199], v[192:195], v[32:35]
  buffer_load_dwordx4 v2, s[8:11], s41 offen offset:2048 sc1 lds
  v_exp_f32 v57, v57
  v_mfma_f32_16x16x32_bf16 v[36:39], a[200:203], v[192:195], v[36:39]
  v_add_f32 v56, 1.0, v56
  v_add_f32 v57, 1.0, v57
  v_mfma_f32_16x16x32_bf16 v[28:31], a[204:207], v[196:199], v[28:31]
  v_rcp_f32 v56, v56
  v_mfma_f32_16x16x32_bf16 v[32:35], a[208:211], v[196:199], v[32:35]
  v_rcp_f32 v57, v57
  v_mul_f32 v26, v26, v56
  v_mfma_f32_16x16x32_bf16 v[36:39], a[212:215], v[196:199], v[36:39]
  s_waitcnt lgkmcnt(0)
  v_mul_f32 v27, v27, v57
  v_cvt_pk_bf16_f32 v53, v26, v27
  v_mfma_f32_16x16x32_bf16 v[28:31], a[216:219], v[200:203], v[28:31]
  v_mfma_f32_16x16x32_bf16 v[32:35], a[220:223], v[200:203], v[32:35]
  buffer_load_dwordx4 v2, s[8:11], s41 offen offset:3072 sc1 lds
  v_mfma_f32_16x16x32_bf16 v[36:39], a[224:227], v[200:203], v[36:39]
  v_mfma_f32_16x16x32_bf16 v[28:31], a[228:231], v[204:207], v[28:31]
  v_mfma_f32_16x16x32_bf16 v[32:35], a[232:235], v[204:207], v[32:35]
  v_mfma_f32_16x16x32_bf16 v[36:39], a[236:239], v[204:207], v[36:39]
  buffer_store_dwordx4 v[48:51], v5, s[8:11], s44 offen
  buffer_store_dwordx2 v[52:53], v5, s[8:11], s45 offen
  buffer_store_dwordx4 v[48:51], v6, s[8:11], s44 offen sc1
  buffer_store_dwordx2 v[52:53], v6, s[8:11], s45 offen sc1
  s_add_u32 s44, s44, 49152
  s_add_u32 s45, s45, 49152
  s_waitcnt vmcnt(17)
  s_barrier
  ds_read_b128 v[176:179], v42 offset:40960
  ds_read_b128 v[180:183], v42 offset:41984
  ds_read_b128 v[184:187], v42 offset:43008
  ds_read_b128 v[188:191], v42 offset:44032
  ds_read_b128 v[192:195], v42 offset:45056
  ds_read_b128 v[196:199], v42 offset:46080
  ds_read_b64 v[12:13], v10 offset:256
  s_waitcnt lgkmcnt(5)
  v_mfma_f32_16x16x32_bf16 v[16:19], a[0:3], v[176:179], 0
  ds_read_b128 v[200:203], v42 offset:47104
  v_fma_f32 v56, v41, v240, v228
  v_fma_f32 v57, v41, v241, v229
  v_fma_f32 v28, v28, v40, v56
  v_mfma_f32_16x16x32_bf16 v[20:23], a[4:7], v[176:179], 0
  s_add_u32 m0, s63, 96256
  s_add_u32 s41, s62, 12288
  buffer_load_dwordx4 v2, s[8:11], s41 offen offset:0 sc1 lds
  v_fma_f32 v29, v29, v40, v57
  v_mul_f32 v56, v28, v28
  v_mul_f32 v57, v29, v29
  v_mfma_f32_16x16x32_bf16 v[24:27], a[8:11], v[176:179], 0
  v_fma_f32 v56, v56, v14, v15
  v_fma_f32 v57, v57, v14, v15
  v_mfma_f32_16x16x32_bf16 v[16:19], a[12:15], v[180:183], v[16:19]
  ds_read_b128 v[204:207], v42 offset:48128
  v_mul_f32 v56, v56, v28
  v_mul_f32 v57, v57, v29
  v_exp_f32 v56, v56
  v_mfma_f32_16x16x32_bf16 v[20:23], a[16:19], v[180:183], v[20:23]
  buffer_load_dwordx4 v2, s[8:11], s41 offen offset:1024 sc1 lds
  v_exp_f32 v57, v57
  v_mfma_f32_16x16x32_bf16 v[24:27], a[20:23], v[180:183], v[24:27]
  s_waitcnt lgkmcnt(5)
  v_add_f32 v56, 1.0, v56
  v_add_f32 v57, 1.0, v57
  v_mfma_f32_16x16x32_bf16 v[16:19], a[24:27], v[184:187], v[16:19]
  ds_read_b128 v[176:179], v42 offset:49152
  v_rcp_f32 v56, v56
  v_mfma_f32_16x16x32_bf16 v[20:23], a[28:31], v[184:187], v[20:23]
  v_rcp_f32 v57, v57
  v_mul_f32 v28, v28, v56
  v_mfma_f32_16x16x32_bf16 v[24:27], a[32:35], v[184:187], v[24:27]
  v_mul_f32 v29, v29, v57
  v_cvt_pk_bf16_f32 v48, v28, v29
  v_mfma_f32_16x16x32_bf16 v[16:19], a[36:39], v[188:191], v[16:19]
  ds_read_b128 v[180:183], v42 offset:50176
  v_fma_f32 v56, v41, v242, v230
  v_fma_f32 v57, v41, v243, v231
  v_fma_f32 v30, v30, v40, v56
  v_mfma_f32_16x16x32_bf16 v[20:23], a[40:43], v[188:191], v[20:23]
  buffer_load_dwordx4 v2, s[8:11], s41 offen offset:2048 sc1 lds
  v_fma_f32 v31, v31, v40, v57
  v_mul_f32 v56, v30, v30
  v_mul_f32 v57, v31, v31
  v_mfma_f32_16x16x32_bf16 v[24:27], a[44:47], v[188:191], v[24:27]
  s_waitcnt lgkmcnt(5)
  v_fma_f32 v56, v56, v14, v15
  v_fma_f32 v57, v57, v14, v15
  v_mfma_f32_16x16x32_bf16 v[16:19], a[48:51], v[192:195], v[16:19]
  ds_read_b128 v[184:187], v42 offset:51200
  v_mul_f32 v56, v56, v30
  v_mul_f32 v57, v57, v31
  v_exp_f32 v56, v56
  v_mfma_f32_16x16x32_bf16 v[20:23], a[52:55], v[192:195], v[20:23]
  v_exp_f32 v57, v57
  v_mfma_f32_16x16x32_bf16 v[24:27], a[56:59], v[192:195], v[24:27]
  v_add_f32 v56, 1.0, v56
  v_add_f32 v57, 1.0, v57
  v_mfma_f32_16x16x32_bf16 v[16:19], a[60:63], v[196:199], v[16:19]
  ds_read_b128 v[188:191], v42 offset:52224
  v_rcp_f32 v56, v56
  v_mfma_f32_16x16x32_bf16 v[20:23], a[64:67], v[196:199], v[20:23]
  buffer_load_dwordx4 v2, s[8:11], s41 offen offset:3072 sc1 lds
  v_rcp_f32 v57, v57
  v_mul_f32 v30, v30, v56
  v_mfma_f32_16x16x32_bf16 v[24:27], a[68:71], v[196:199], v[24:27]
  s_waitcnt lgkmcnt(4)
  v_mul_f32 v31, v31, v57
  v_cvt_pk_bf16_f32 v49, v30, v31
  v_mfma_f32_16x16x32_bf16 v[16:19], a[72:75], v[200:203], v[16:19]
  ds_read_b128 v[192:195], v42 offset:53248
  v_fma_f32 v56, v41, v244, v232
  v_fma_f32 v57, v41, v245, v233
  v_fma_f32 v32, v32, v40, v56
  v_mfma_f32_16x16x32_bf16 v[20:23], a[76:79], v[200:203], v[20:23]
  s_add_u32 m0, s63, 100352
  s_add_u32 s41, s62, 16384
  buffer_load_dwordx4 v2, s[8:11], s41 offen offset:0 sc1 lds
  v_fma_f32 v33, v33, v40, v57
  v_mul_f32 v56, v32, v32
  v_mul_f32 v57, v33, v33
  v_mfma_f32_16x16x32_bf16 v[24:27], a[80:83], v[200:203], v[24:27]
  v_fma_f32 v56, v56, v14, v15
  v_fma_f32 v57, v57, v14, v15
  v_mfma_f32_16x16x32_bf16 v[16:19], a[84:87], v[204:207], v[16:19]
  ds_read_b128 v[196:199], v42 offset:54272
  v_mul_f32 v56, v56, v32
  v_mul_f32 v57, v57, v33
  v_exp_f32 v56, v56
  v_mfma_f32_16x16x32_bf16 v[20:23], a[88:91], v[204:207], v[20:23]
  v_exp_f32 v57, v57
  v_mfma_f32_16x16x32_bf16 v[24:27], a[92:95], v[204:207], v[24:27]
  s_waitcnt lgkmcnt(4)
  v_add_f32 v56, 1.0, v56
  v_add_f32 v57, 1.0, v57
  v_mfma_f32_16x16x32_bf16 v[16:19], a[96:99], v[176:179], v[16:19]
  ds_read_b128 v[200:203], v42 offset:55296
  v_rcp_f32 v56, v56
  v_mfma_f32_16x16x32_bf16 v[20:23], a[100:103], v[176:179], v[20:23]
  buffer_load_dwordx4 v2, s[8:11], s41 offen offset:1024 sc1 lds
  v_rcp_f32 v57, v57
  v_mul_f32 v32, v32, v56
  v_mfma_f32_16x16x32_bf16 v[24:27], a[104:107], v[176:179], v[24:27]
  v_mul_f32 v33, v33, v57
  v_cvt_pk_bf16_f32 v50, v32, v33
  v_mfma_f32_16x16x32_bf16 v[16:19], a[108:111], v[180:183], v[16:19]
  ds_read_b128 v[204:207], v42 offset:56320
  v_fma_f32 v56, v41, v246, v234
  v_fma_f32 v57, v41, v247, v235
  v_fma_f32 v34, v34, v40, v56
  v_mfma_f32_16x16x32_bf16 v[20:23], a[112:115], v[180:183], v[20:23]
  v_fma_f32 v35, v35, v40, v57
  v_mul_f32 v56, v34, v34
  v_mul_f32 v57, v35, v35
  v_mfma_f32_16x16x32_bf16 v[24:27], a[116:119], v[180:183], v[24:27]
  s_waitcnt lgkmcnt(4)
  v_fma_f32 v56, v56, v14, v15
  v_fma_f32 v57, v57, v14, v15
  v_mfma_f32_16x16x32_bf16 v[16:19], a[120:123], v[184:187], v[16:19]
  ds_read_b128 v[176:179], v42 offset:57344
  v_mul_f32 v56, v56, v34
  v_mul_f32 v57, v57, v35
  v_exp_f32 v56, v56
  v_mfma_f32_16x16x32_bf16 v[20:23], a[124:127], v[184:187], v[20:23]
  buffer_load_dwordx4 v2, s[8:11], s41 offen offset:2048 sc1 lds
  v_exp_f32 v57, v57
  v_mfma_f32_16x16x32_bf16 v[24:27], a[128:131], v[184:187], v[24:27]
  v_add_f32 v56, 1.0, v56
  v_add_f32 v57, 1.0, v57
  v_mfma_f32_16x16x32_bf16 v[16:19], a[132:135], v[188:191], v[16:19]
  ds_read_b128 v[180:183], v42 offset:58368
  v_rcp_f32 v56, v56
  v_mfma_f32_16x16x32_bf16 v[20:23], a[136:139], v[188:191], v[20:23]
  buffer_load_dwordx4 v[84:87], v11, s[8:11], s68 offen offset:0 sc1
  v_rcp_f32 v57, v57
  v_mul_f32 v34, v34, v56
  v_mfma_f32_16x16x32_bf16 v[24:27], a[140:143], v[188:191], v[24:27]
  s_waitcnt lgkmcnt(4)
  v_mul_f32 v35, v35, v57
  v_cvt_pk_bf16_f32 v51, v34, v35
  v_mfma_f32_16x16x32_bf16 v[16:19], a[144:147], v[192:195], v[16:19]
  ds_read_b128 v[184:187], v42 offset:59392
  v_fma_f32 v56, v41, v248, v236
  v_fma_f32 v57, v41, v249, v237
  v_fma_f32 v36, v36, v40, v56
  v_mfma_f32_16x16x32_bf16 v[20:23], a[148:151], v[192:195], v[20:23]
  v_fma_f32 v37, v37, v40, v57
  v_mul_f32 v56, v36, v36
  v_mul_f32 v57, v37, v37
  v_mfma_f32_16x16x32_bf16 v[24:27], a[152:155], v[192:195], v[24:27]
  v_fma_f32 v56, v56, v14, v15
  v_fma_f32 v57, v57, v14, v15
  v_mfma_f32_16x16x32_bf16 v[16:19], a[156:159], v[196:199], v[16:19]
  ds_read_b128 v[188:191], v42 offset:60416
  v_mul_f32 v56, v56, v36
  v_mul_f32 v57, v57, v37
  v_exp_f32 v56, v56
  v_mfma_f32_16x16x32_bf16 v[20:23], a[160:163], v[196:199], v[20:23]
  buffer_load_dwordx4 v[88:91], v11, s[8:11], s68 offen offset:64 sc1
  v_exp_f32 v57, v57
  v_mfma_f32_16x16x32_bf16 v[24:27], a[164:167], v[196:199], v[24:27]
  s_waitcnt lgkmcnt(4)
  v_add_f32 v56, 1.0, v56
  v_add_f32 v57, 1.0, v57
  v_mfma_f32_16x16x32_bf16 v[16:19], a[168:171], v[200:203], v[16:19]
  ds_read_b128 v[192:195], v42 offset:61440
  v_rcp_f32 v56, v56
  v_mfma_f32_16x16x32_bf16 v[20:23], a[172:175], v[200:203], v[20:23]
  v_rcp_f32 v57, v57
  v_mul_f32 v36, v36, v56
  v_mfma_f32_16x16x32_bf16 v[24:27], a[176:179], v[200:203], v[24:27]
  v_mul_f32 v37, v37, v57
  v_cvt_pk_bf16_f32 v52, v36, v37
  v_mfma_f32_16x16x32_bf16 v[16:19], a[180:183], v[204:207], v[16:19]
  ds_read_b128 v[196:199], v42 offset:62464
  v_fma_f32 v56, v41, v250, v238
  v_fma_f32 v57, v41, v251, v239
  v_fma_f32 v38, v38, v40, v56
  v_mfma_f32_16x16x32_bf16 v[20:23], a[184:187], v[204:207], v[20:23]
  buffer_load_dwordx4 v[92:95], v11, s[8:11], s68 offen offset:128 sc1
  v_fma_f32 v39, v39, v40, v57
  v_mul_f32 v56, v38, v38
  v_mul_f32 v57, v39, v39
  v_mfma_f32_16x16x32_bf16 v[24:27], a[188:191], v[204:207], v[24:27]
  s_waitcnt lgkmcnt(4)
  v_fma_f32 v56, v56, v14, v15
  v_fma_f32 v57, v57, v14, v15
  v_mfma_f32_16x16x32_bf16 v[16:19], a[192:195], v[176:179], v[16:19]
  ds_read_b128 v[200:203], v42 offset:63488
  v_mul_f32 v56, v56, v38
  v_mul_f32 v57, v57, v39
  v_exp_f32 v56, v56
  v_mfma_f32_16x16x32_bf16 v[20:23], a[196:199], v[176:179], v[20:23]
  buffer_load_dwordx4 v[96:99], v11, s[8:11], s68 offen offset:192 sc1
  v_exp_f32 v57, v57
  v_mfma_f32_16x16x32_bf16 v[24:27], a[200:203], v[176:179], v[24:27]
  v_add_f32 v56, 1.0, v56
  v_add_f32 v57, 1.0, v57
  v_mfma_f32_16x16x32_bf16 v[16:19], a[204:207], v[180:183], v[16:19]
  ds_read_b128 v[204:207], v42 offset:64512
  v_rcp_f32 v56, v56
  v_mfma_f32_16x16x32_bf16 v[20:23], a[208:211], v[180:183], v[20:23]
  v_rcp_f32 v57, v57
  v_mul_f32 v38, v38, v56
  v_mfma_f32_16x16x32_bf16 v[24:27], a[212:215], v[180:183], v[24:27]
  s_waitcnt lgkmcnt(4)
  v_mul_f32 v39, v39, v57
  v_cvt_pk_bf16_f32 v53, v38, v39
  v_mfma_f32_16x16x32_bf16 v[16:19], a[216:219], v[184:187], v[16:19]
  ds_read_b128 v[176:179], v43 offset:0
  v_mfma_f32_16x16x32_bf16 v[20:23], a[220:223], v[184:187], v[20:23]
  buffer_load_dwordx4 v[100:103], v11, s[8:11], s69 offen sc1
  v_mfma_f32_16x16x32_bf16 v[24:27], a[224:227], v[184:187], v[24:27]
  v_mfma_f32_16x16x32_bf16 v[16:19], a[228:231], v[188:191], v[16:19]
  ds_read_b128 v[180:183], v43 offset:1024
  v_mfma_f32_16x16x32_bf16 v[20:23], a[232:235], v[188:191], v[20:23]
  v_mfma_f32_16x16x32_bf16 v[24:27], a[236:239], v[188:191], v[24:27]
  buffer_store_dwordx4 v[48:51], v5, s[8:11], s44 offen
  buffer_store_dwordx2 v[52:53], v5, s[8:11], s45 offen
  buffer_store_dwordx4 v[48:51], v6, s[8:11], s44 offen sc1
  buffer_store_dwordx2 v[52:53], v6, s[8:11], s45 offen sc1
  s_add_u32 s44, s44, 49152
  s_add_u32 s45, s45, 49152
  ds_read_b64 v[40:41], v10 offset:384
  s_waitcnt lgkmcnt(5)
  v_mfma_f32_16x16x32_bf16 v[28:31], a[0:3], v[192:195], 0
  ds_read_b128 v[184:187], v43 offset:2048
  v_fma_f32 v56, v13, v240, v228
  v_fma_f32 v57, v13, v241, v229
  v_fma_f32 v16, v16, v12, v56
  v_mfma_f32_16x16x32_bf16 v[32:35], a[4:7], v[192:195], 0
  buffer_load_dwordx4 v[128:131], v225, s[8:11], s57 offen offset:0 sc1
  v_fma_f32 v17, v17, v12, v57
  v_mul_f32 v56, v16, v16
  v_mul_f32 v57, v17, v17
  v_mfma_f32_16x16x32_bf16 v[36:39], a[8:11], v[192:195], 0
  v_fma_f32 v56, v56, v14, v15
  v_fma_f32 v57, v57, v14, v15
  v_mfma_f32_16x16x32_bf16 v[28:31], a[12:15], v[196:199], v[28:31]
  ds_read_b128 v[188:191], v43 offset:3072
  v_mul_f32 v56, v56, v16
  v_mul_f32 v57, v57, v17
  v_exp_f32 v56, v56
  v_mfma_f32_16x16x32_bf16 v[32:35], a[16:19], v[196:199], v[32:35]
  buffer_load_dwordx4 v[132:135], v225, s[8:11], s57 offen offset:1024 sc1
  v_exp_f32 v57, v57
  v_mfma_f32_16x16x32_bf16 v[36:39], a[20:23], v[196:199], v[36:39]
  s_waitcnt lgkmcnt(5)
  v_add_f32 v56, 1.0, v56
  v_add_f32 v57, 1.0, v57
  v_mfma_f32_16x16x32_bf16 v[28:31], a[24:27], v[200:203], v[28:31]
  ds_read_b128 v[192:195], v43 offset:4096
  v_rcp_f32 v56, v56
  v_mfma_f32_16x16x32_bf16 v[32:35], a[28:31], v[200:203], v[32:35]
  buffer_load_dwordx4 v[136:139], v225, s[8:11], s57 offen offset:2048 sc1
  v_rcp_f32 v57, v57
  v_mul_f32 v16, v16, v56
  v_mfma_f32_16x16x32_bf16 v[36:39], a[32:35], v[200:203], v[36:39]
  v_mul_f32 v17, v17, v57
  v_cvt_pk_bf16_f32 v48, v16, v17
  v_mfma_f32_16x16x32_bf16 v[28:31], a[36:39], v[204:207], v[28:31]
  ds_read_b128 v[196:199], v43 offset:5120
  v_fma_f32 v56, v13, v242, v230
  v_fma_f32 v57, v13, v243, v231
  v_fma_f32 v18, v18, v12, v56
  v_mfma_f32_16x16x32_bf16 v[32:35], a[40:43], v[204:207], v[32:35]
  v_fma_f32 v19, v19, v12, v57
  v_mul_f32 v56, v18, v18
  v_mul_f32 v57, v19, v19
  v_mfma_f32_16x16x32_bf16 v[36:39], a[44:47], v[204:207], v[36:39]
  s_waitcnt lgkmcnt(5)
  v_fma_f32 v56, v56, v14, v15
  v_fma_f32 v57, v57, v14, v15
  v_mfma_f32_16x16x32_bf16 v[28:31], a[48:51], v[176:179], v[28:31]
  ds_read_b128 v[200:203], v43 offset:6144
  v_mul_f32 v56, v56, v18
  v_mul_f32 v57, v57, v19
  v_exp_f32 v56, v56
  v_mfma_f32_16x16x32_bf16 v[32:35], a[52:55], v[176:179], v[32:35]
  buffer_load_dwordx4 v[140:143], v225, s[8:11], s57 offen offset:3072 sc1
  v_exp_f32 v57, v57
  v_mfma_f32_16x16x32_bf16 v[36:39], a[56:59], v[176:179], v[36:39]
  v_add_f32 v56, 1.0, v56
  v_add_f32 v57, 1.0, v57
  v_mfma_f32_16x16x32_bf16 v[28:31], a[60:63], v[180:183], v[28:31]
  ds_read_b128 v[204:207], v43 offset:7168
  v_rcp_f32 v56, v56
  v_mfma_f32_16x16x32_bf16 v[32:35], a[64:67], v[180:183], v[32:35]
  s_add_u32 s57, s57, 4096
  buffer_load_dwordx4 v[144:147], v225, s[8:11], s57 offen offset:0 sc1
  v_rcp_f32 v57, v57
  v_mul_f32 v18, v18, v56
  v_mfma_f32_16x16x32_bf16 v[36:39], a[68:71], v[180:183], v[36:39]
  s_waitcnt lgkmcnt(4)
  v_mul_f32 v19, v19, v57
  v_cvt_pk_bf16_f32 v49, v18, v19
  v_mfma_f32_16x16x32_bf16 v[28:31], a[72:75], v[184:187], v[28:31]
  ds_read_b128 v[176:179], v43 offset:8192
  v_fma_f32 v56, v13, v244, v232
  v_fma_f32 v57, v13, v245, v233
  v_fma_f32 v20, v20, v12, v56
  v_mfma_f32_16x16x32_bf16 v[32:35], a[76:79], v[184:187], v[32:35]
  buffer_load_dwordx4 v[148:151], v225, s[8:11], s57 offen offset:1024 sc1
  v_fma_f32 v21, v21, v12, v57
  v_mul_f32 v56, v20, v20
  v_mul_f32 v57, v21, v21
  v_mfma_f32_16x16x32_bf16 v[36:39], a[80:83], v[184:187], v[36:39]
  v_fma_f32 v56, v56, v14, v15
  v_fma_f32 v57, v57, v14, v15
  v_mfma_f32_16x16x32_bf16 v[28:31], a[84:87], v[188:191], v[28:31]
  ds_read_b128 v[180:183], v43 offset:9216
  v_mul_f32 v56, v56, v20
  v_mul_f32 v57, v57, v21
  v_exp_f32 v56, v56
  v_mfma_f32_16x16x32_bf16 v[32:35], a[88:91], v[188:191], v[32:35]
  v_exp_f32 v57, v57
  v_mfma_f32_16x16x32_bf16 v[36:39], a[92:95], v[188:191], v[36:39]
  s_waitcnt lgkmcnt(4)
  v_add_f32 v56, 1.0, v56
  v_add_f32 v57, 1.0, v57
  v_mfma_f32_16x16x32_bf16 v[28:31], a[96:99], v[192:195], v[28:31]
  ds_read_b128 v[184:187], v43 offset:10240
  v_rcp_f32 v56, v56
  v_mfma_f32_16x16x32_bf16 v[32:35], a[100:103], v[192:195], v[32:35]
  buffer_load_dwordx4 v[152:155], v225, s[8:11], s57 offen offset:2048 sc1
  v_rcp_f32 v57, v57
  v_mul_f32 v20, v20, v56
  v_mfma_f32_16x16x32_bf16 v[36:39], a[104:107], v[192:195], v[36:39]
  v_mul_f32 v21, v21, v57
  v_cvt_pk_bf16_f32 v50, v20, v21
  v_mfma_f32_16x16x32_bf16 v[28:31], a[108:111], v[196:199], v[28:31]
  ds_read_b128 v[188:191], v43 offset:11264
  v_fma_f32 v56, v13, v246, v234
  v_fma_f32 v57, v13, v247, v235
  v_fma_f32 v22, v22, v12, v56
  v_mfma_f32_16x16x32_bf16 v[32:35], a[112:115], v[196:199], v[32:35]
  buffer_load_dwordx4 v[156:159], v225, s[8:11], s57 offen offset:3072 sc1
  v_fma_f32 v23, v23, v12, v57
  v_mul_f32 v56, v22, v22
  v_mul_f32 v57, v23, v23
  v_mfma_f32_16x16x32_bf16 v[36:39], a[116:119], v[196:199], v[36:39]
  s_waitcnt lgkmcnt(4)
  v_fma_f32 v56, v56, v14, v15
  v_fma_f32 v57, v57, v14, v15
  v_mfma_f32_16x16x32_bf16 v[28:31], a[120:123], v[200:203], v[28:31]
  ds_read_b128 v[192:195], v43 offset:12288
  v_mul_f32 v56, v56, v22
  v_mul_f32 v57, v57, v23
  v_exp_f32 v56, v56
  v_mfma_f32_16x16x32_bf16 v[32:35], a[124:127], v[200:203], v[32:35]
  s_add_u32 s57, s57, 4096
  buffer_load_dwordx4 v[160:163], v225, s[8:11], s57 offen offset:0 sc1
  v_exp_f32 v57, v57
  v_mfma_f32_16x16x32_bf16 v[36:39], a[128:131], v[200:203], v[36:39]
  v_add_f32 v56, 1.0, v56
  v_add_f32 v57, 1.0, v57
  v_mfma_f32_16x16x32_bf16 v[28:31], a[132:135], v[204:207], v[28:31]
  ds_read_b128 v[196:199], v43 offset:13312
  v_rcp_f32 v56, v56
  v_mfma_f32_16x16x32_bf16 v[32:35], a[136:139], v[204:207], v[32:35]
  v_rcp_f32 v57, v57
  v_mul_f32 v22, v22, v56
  v_mfma_f32_16x16x32_bf16 v[36:39], a[140:143], v[204:207], v[36:39]
  s_waitcnt lgkmcnt(4)
  v_mul_f32 v23, v23, v57
  v_cvt_pk_bf16_f32 v51, v22, v23
  v_mfma_f32_16x16x32_bf16 v[28:31], a[144:147], v[176:179], v[28:31]
  ds_read_b128 v[200:203], v43 offset:14336
  v_fma_f32 v56, v13, v248, v236
  v_fma_f32 v57, v13, v249, v237
  v_fma_f32 v24, v24, v12, v56
  v_mfma_f32_16x16x32_bf16 v[32:35], a[148:151], v[176:179], v[32:35]
  buffer_load_dwordx4 v[164:167], v225, s[8:11], s57 offen offset:1024 sc1
  v_fma_f32 v25, v25, v12, v57
  v_mul_f32 v56, v24, v24
  v_mul_f32 v57, v25, v25
  v_mfma_f32_16x16x32_bf16 v[36:39], a[152:155], v[176:179], v[36:39]
  v_fma_f32 v56, v56, v14, v15
  v_fma_f32 v57, v57, v14, v15
  v_mfma_f32_16x16x32_bf16 v[28:31], a[156:159], v[180:183], v[28:31]
  ds_read_b128 v[204:207], v43 offset:15360
  v_mul_f32 v56, v56, v24
  v_mul_f32 v57, v57, v25
  v_exp_f32 v56, v56
  v_mfma_f32_16x16x32_bf16 v[32:35], a[160:163], v[180:183], v[32:35]
  buffer_load_dwordx4 v[168:171], v225, s[8:11], s56 offen offset:0 sc1
  v_exp_f32 v57, v57
  v_mfma_f32_16x16x32_bf16 v[36:39], a[164:167], v[180:183], v[36:39]
  s_waitcnt lgkmcnt(4)
  v_add_f32 v56, 1.0, v56
  v_add_f32 v57, 1.0, v57
  v_mfma_f32_16x16x32_bf16 v[28:31], a[168:171], v[184:187], v[28:31]
  v_rcp_f32 v56, v56
  v_mfma_f32_16x16x32_bf16 v[32:35], a[172:175], v[184:187], v[32:35]
  buffer_load_dwordx4 v[172:175], v225, s[8:11], s56 offen offset:1024 sc1
  v_rcp_f32 v57, v57
  v_mul_f32 v24, v24, v56
  v_mfma_f32_16x16x32_bf16 v[36:39], a[176:179], v[184:187], v[36:39]
  v_mul_f32 v25, v25, v57
  v_cvt_pk_bf16_f32 v52, v24, v25
  v_mfma_f32_16x16x32_bf16 v[28:31], a[180:183], v[188:191], v[28:31]
  v_fma_f32 v56, v13, v250, v238
  v_fma_f32 v57, v13, v251, v239
  v_fma_f32 v26, v26, v12, v56
  v_mfma_f32_16x16x32_bf16 v[32:35], a[184:187], v[188:191], v[32:35]
  v_fma_f32 v27, v27, v12, v57
  v_mul_f32 v56, v26, v26
  v_mul_f32 v57, v27, v27
  v_mfma_f32_16x16x32_bf16 v[36:39], a[188:191], v[188:191], v[36:39]
  s_waitcnt lgkmcnt(2)
  v_fma_f32 v56, v56, v14, v15
  v_fma_f32 v57, v57, v14, v15
  v_mfma_f32_16x16x32_bf16 v[28:31], a[192:195], v[192:195], v[28:31]
  v_mul_f32 v56, v56, v26
  v_mul_f32 v57, v57, v27
  v_exp_f32 v56, v56
  v_mfma_f32_16x16x32_bf16 v[32:35], a[196:199], v[192:195], v[32:35]
  buffer_load_dwordx4 v[208:211], v225, s[8:11], s64 offen offset:0 sc1
  v_exp_f32 v57, v57
  v_mfma_f32_16x16x32_bf16 v[36:39], a[200:203], v[192:195], v[36:39]
  v_add_f32 v56, 1.0, v56
  v_add_f32 v57, 1.0, v57
  v_mfma_f32_16x16x32_bf16 v[28:31], a[204:207], v[196:199], v[28:31]
  v_rcp_f32 v56, v56
  v_mfma_f32_16x16x32_bf16 v[32:35], a[208:211], v[196:199], v[32:35]
  buffer_load_dwordx4 v[212:215], v225, s[8:11], s64 offen offset:1024 sc1
  v_rcp_f32 v57, v57
  v_mul_f32 v26, v26, v56
  v_mfma_f32_16x16x32_bf16 v[36:39], a[212:215], v[196:199], v[36:39]
  s_waitcnt lgkmcnt(0)
  v_mul_f32 v27, v27, v57
  v_cvt_pk_bf16_f32 v53, v26, v27
  v_mfma_f32_16x16x32_bf16 v[28:31], a[216:219], v[200:203], v[28:31]
  v_mfma_f32_16x16x32_bf16 v[32:35], a[220:223], v[200:203], v[32:35]
  buffer_load_dwordx4 v[216:219], v225, s[8:11], s64 offen offset:2048 sc1
  v_mfma_f32_16x16x32_bf16 v[36:39], a[224:227], v[200:203], v[36:39]
  v_mfma_f32_16x16x32_bf16 v[28:31], a[228:231], v[204:207], v[28:31]
  v_mfma_f32_16x16x32_bf16 v[32:35], a[232:235], v[204:207], v[32:35]
  v_mfma_f32_16x16x32_bf16 v[36:39], a[236:239], v[204:207], v[36:39]
  buffer_store_dwordx4 v[48:51], v5, s[8:11], s44 offen
  buffer_store_dwordx2 v[52:53], v5, s[8:11], s45 offen
  buffer_store_dwordx4 v[48:51], v6, s[8:11], s44 offen sc1
  buffer_store_dwordx2 v[52:53], v6, s[8:11], s45 offen sc1
  s_add_u32 s44, s44, 49152
  s_add_u32 s45, s45, 49152
  v_mov_b32 v58, 1.0
  v_mov_b32 v59, 1.0
  v_pk_fma_f32 v[56:57], v[40:41], v[240:241], v[228:229] op_sel:[1,0,0] op_sel_hi:[1,1,1]
  v_pk_fma_f32 v[28:29], v[28:29], v[40:41], v[56:57] op_sel_hi:[1,0,1]
  v_pk_mul_f32 v[56:57], v[28:29], v[28:29]
  v_pk_fma_f32 v[56:57], v[56:57], v[14:15], v[14:15] op_sel:[0,0,1] op_sel_hi:[1,0,1]
  v_pk_mul_f32 v[56:57], v[56:57], v[28:29]
  v_exp_f32 v56, v56
  v_exp_f32 v57, v57
  s_nop 0
  v_pk_add_f32 v[56:57], v[56:57], v[58:59]
  v_rcp_f32 v56, v56
  v_rcp_f32 v57, v57
  s_nop 0
  v_pk_mul_f32 v[28:29], v[28:29], v[56:57]
  v_cvt_pk_bf16_f32 v48, v28, v29
  v_pk_fma_f32 v[56:57], v[40:41], v[242:243], v[230:231] op_sel:[1,0,0] op_sel_hi:[1,1,1]
  v_pk_fma_f32 v[30:31], v[30:31], v[40:41], v[56:57] op_sel_hi:[1,0,1]
  v_pk_mul_f32 v[56:57], v[30:31], v[30:31]
  v_pk_fma_f32 v[56:57], v[56:57], v[14:15], v[14:15] op_sel:[0,0,1] op_sel_hi:[1,0,1]
  v_pk_mul_f32 v[56:57], v[56:57], v[30:31]
  v_exp_f32 v56, v56
  v_exp_f32 v57, v57
  s_nop 0
  v_pk_add_f32 v[56:57], v[56:57], v[58:59]
  v_rcp_f32 v56, v56
  v_rcp_f32 v57, v57
  s_nop 0
  v_pk_mul_f32 v[30:31], v[30:31], v[56:57]
  v_cvt_pk_bf16_f32 v49, v30, v31
  v_pk_fma_f32 v[56:57], v[40:41], v[244:245], v[232:233] op_sel:[1,0,0] op_sel_hi:[1,1,1]
  v_pk_fma_f32 v[32:33], v[32:33], v[40:41], v[56:57] op_sel_hi:[1,0,1]
  v_pk_mul_f32 v[56:57], v[32:33], v[32:33]
  v_pk_fma_f32 v[56:57], v[56:57], v[14:15], v[14:15] op_sel:[0,0,1] op_sel_hi:[1,0,1]
  v_pk_mul_f32 v[56:57], v[56:57], v[32:33]
  v_exp_f32 v56, v56
  v_exp_f32 v57, v57
  s_nop 0
  v_pk_add_f32 v[56:57], v[56:57], v[58:59]
  v_rcp_f32 v56, v56
  v_rcp_f32 v57, v57
  s_nop 0
  v_pk_mul_f32 v[32:33], v[32:33], v[56:57]
  v_cvt_pk_bf16_f32 v50, v32, v33
  v_pk_fma_f32 v[56:57], v[40:41], v[246:247], v[234:235] op_sel:[1,0,0] op_sel_hi:[1,1,1]
  v_pk_fma_f32 v[34:35], v[34:35], v[40:41], v[56:57] op_sel_hi:[1,0,1]
  v_pk_mul_f32 v[56:57], v[34:35], v[34:35]
  v_pk_fma_f32 v[56:57], v[56:57], v[14:15], v[14:15] op_sel:[0,0,1] op_sel_hi:[1,0,1]
  v_pk_mul_f32 v[56:57], v[56:57], v[34:35]
  v_exp_f32 v56, v56
  v_exp_f32 v57, v57
  s_nop 0
  v_pk_add_f32 v[56:57], v[56:57], v[58:59]
  v_rcp_f32 v56, v56
  v_rcp_f32 v57, v57
  s_nop 0
  v_pk_mul_f32 v[34:35], v[34:35], v[56:57]
  v_cvt_pk_bf16_f32 v51, v34, v35
  v_pk_fma_f32 v[56:57], v[40:41], v[248:249], v[236:237] op_sel:[1,0,0] op_sel_hi:[1,1,1]
  v_pk_fma_f32 v[36:37], v[36:37], v[40:41], v[56:57] op_sel_hi:[1,0,1]
  v_pk_mul_f32 v[56:57], v[36:37], v[36:37]
  v_pk_fma_f32 v[56:57], v[56:57], v[14:15], v[14:15] op_sel:[0,0,1] op_sel_hi:[1,0,1]
  v_pk_mul_f32 v[56:57], v[56:57], v[36:37]
  v_exp_f32 v56, v56
  v_exp_f32 v57, v57
  s_nop 0
  v_pk_add_f32 v[56:57], v[56:57], v[58:59]
  v_rcp_f32 v56, v56
  v_rcp_f32 v57, v57
  s_nop 0
  v_pk_mul_f32 v[36:37], v[36:37], v[56:57]
  v_cvt_pk_bf16_f32 v52, v36, v37
  v_pk_fma_f32 v[56:57], v[40:41], v[250:251], v[238:239] op_sel:[1,0,0] op_sel_hi:[1,1,1]
  v_pk_fma_f32 v[38:39], v[38:39], v[40:41], v[56:57] op_sel_hi:[1,0,1]
  v_pk_mul_f32 v[56:57], v[38:39], v[38:39]
  v_pk_fma_f32 v[56:57], v[56:57], v[14:15], v[14:15] op_sel:[0,0,1] op_sel_hi:[1,0,1]
  v_pk_mul_f32 v[56:57], v[56:57], v[38:39]
  v_exp_f32 v56, v56
  v_exp_f32 v57, v57
  s_nop 0
  v_pk_add_f32 v[56:57], v[56:57], v[58:59]
  v_rcp_f32 v56, v56
  v_rcp_f32 v57, v57
  s_nop 0
  v_pk_mul_f32 v[38:39], v[38:39], v[56:57]
  v_cvt_pk_bf16_f32 v53, v38, v39
  buffer_store_dwordx4 v[48:51], v5, s[8:11], s44 offen
  buffer_store_dwordx2 v[52:53], v5, s[8:11], s45 offen
  buffer_store_dwordx4 v[48:51], v6, s[8:11], s44 offen sc1
  buffer_store_dwordx2 v[52:53], v6, s[8:11], s45 offen sc1
  s_add_u32 s44, s44, 49152
  s_add_u32 s45, s45, 49152
  s_barrier
  s_cmp_eq_u32 s28, 0
  s_cbranch_scc1 SB0_98
  s_sub_u32 s63, s28, 1
  s_mul_i32 s63, s63, 27648
  s_min_u32 s63, s63, 54272
  s_mul_i32 s62, s30, 245760
  s_add_u32 s62, s62, s63
  s_add_u32 s62, s62, 1018880
  s_add_u32 m0, s63, 0
  s_add_u32 s41, s62, 0
  buffer_load_dwordx4 v2, s[8:11], s41 offen offset:0 sc1 lds
  buffer_load_dwordx4 v2, s[8:11], s41 offen offset:1024 sc1 lds
  buffer_load_dwordx4 v2, s[8:11], s41 offen offset:2048 sc1 lds
  buffer_load_dwordx4 v2, s[8:11], s41 offen offset:3072 sc1 lds
  s_add_u32 m0, s63, 4096
  s_add_u32 s41, s62, 4096
  buffer_load_dwordx4 v2, s[8:11], s41 offen offset:0 sc1 lds
  buffer_load_dwordx4 v2, s[8:11], s41 offen offset:1024 sc1 lds
  buffer_load_dwordx4 v2, s[8:11], s41 offen offset:2048 sc1 lds
  buffer_load_dwordx4 v2, s[8:11], s41 offen offset:3072 sc1 lds
  s_waitcnt vmcnt(8)
  s_barrier
  s_add_u32 m0, s63, 8192
  s_add_u32 s41, s62, 8192
  buffer_load_dwordx4 v2, s[8:11], s41 offen offset:0 sc1 lds
  buffer_load_dwordx4 v2, s[8:11], s41 offen offset:1024 sc1 lds
  buffer_load_dwordx4 v2, s[8:11], s41 offen offset:2048 sc1 lds
  buffer_load_dwordx4 v2, s[8:11], s41 offen offset:3072 sc1 lds
  s_add_u32 m0, s63, 12288
  s_add_u32 s41, s62, 12288
  buffer_load_dwordx4 v2, s[8:11], s41 offen offset:0 sc1 lds
  buffer_load_dwordx4 v2, s[8:11], s41 offen offset:1024 sc1 lds
  buffer_load_dwordx4 v2, s[8:11], s41 offen offset:2048 sc1 lds
  buffer_load_dwordx4 v2, s[8:11], s41 offen offset:3072 sc1 lds
  s_add_u32 m0, s63, 16384
  s_add_u32 s41, s62, 16384
  buffer_load_dwordx4 v2, s[8:11], s41 offen offset:0 sc1 lds
  buffer_load_dwordx4 v2, s[8:11], s41 offen offset:1024 sc1 lds
  buffer_load_dwordx4 v2, s[8:11], s41 offen offset:2048 sc1 lds
  buffer_load_dwordx4 v2, s[8:11], s41 offen offset:3072 sc1 lds
  s_add_u32 m0, s63, 20480
  s_add_u32 s41, s62, 20480
  buffer_load_dwordx4 v2, s[8:11], s41 offen offset:0 sc1 lds
  buffer_load_dwordx4 v2, s[8:11], s41 offen offset:1024 sc1 lds
  buffer_load_dwordx4 v2, s[8:11], s41 offen offset:2048 sc1 lds
  buffer_load_dwordx4 v2, s[8:11], s41 offen offset:3072 sc1 lds
  s_add_u32 m0, s63, 24576
  s_add_u32 s41, s62, 24576
  buffer_load_dwordx4 v2, s[8:11], s41 offen offset:0 sc1 lds
  buffer_load_dwordx4 v2, s[8:11], s41 offen offset:1024 sc1 lds
  buffer_load_dwordx4 v2, s[8:11], s41 offen offset:2048 sc1 lds
  s_branch SB1_99
SB0_98:
  s_waitcnt vmcnt(0)
  s_barrier
  s_lshl_b32 s43, s32, 3
  s_add_u32 s43, s43, 3
  v_mov_b32 v255, s43
  s_mov_b64 exec, 1
  s_cmp_eq_u32 s34, 0
  s_cbranch_scc1 HS_wt_101
  buffer_store_dword v255, off, s[8:11], s33
  s_branch HS_j_102
HS_wt_101:
  buffer_store_dword v255, off, s[8:11], s33 sc1
HS_j_102:
  s_mov_b64 exec, -1
SB1_99:
  v_accvgpr_read_b32 v17, a246
  v_accvgpr_read_b32 v19, a247
  v_accvgpr_read_b32 v21, a248
  v_accvgpr_read_b32 v23, a249
  v_accvgpr_read_b32 v25, a250
  v_accvgpr_read_b32 v27, a251
  v_accvgpr_read_b32 v29, a252
  v_accvgpr_read_b32 v31, a253
  v_accvgpr_read_b32 v33, a254
  v_accvgpr_read_b32 v35, a255
  v_lshlrev_b32 v16, 16, v17
  v_and_b32 v17, 0xffff0000, v17
  v_lshlrev_b32 v18, 16, v19
  v_and_b32 v19, 0xffff0000, v19
  v_lshlrev_b32 v20, 16, v21
  v_and_b32 v21, 0xffff0000, v21
  v_lshlrev_b32 v22, 16, v23
  v_and_b32 v23, 0xffff0000, v23
  v_lshlrev_b32 v24, 16, v25
  v_and_b32 v25, 0xffff0000, v25
  v_lshlrev_b32 v26, 16, v27
  v_and_b32 v27, 0xffff0000, v27
  v_lshlrev_b32 v28, 16, v29
  v_and_b32 v29, 0xffff0000, v29
  v_lshlrev_b32 v30, 16, v31
  v_and_b32 v31, 0xffff0000, v31
  v_lshlrev_b32 v32, 16, v33
  v_and_b32 v33, 0xffff0000, v33
  v_lshlrev_b32 v34, 16, v35
  v_and_b32 v35, 0xffff0000, v35
  s_cmp_eq_u32 s32, 0
  s_mov_b32 s46, 19431424
  s_cselect_b32 s46, s46, 25722880
  s_lshl_b32 s40, s29, 2
  s_add_u32 s40, s40, s28
  s_mul_i32 s40, s40, 49152
  s_add_u32 s46, s46, s40
  v_add_f32 v16, v16, v84
  v_add_f32 v17, v17, v85
  v_add_f32 v18, v18, v86
  v_add_f32 v19, v19, v87
  v_add_f32 v20, v20, v88
  v_add_f32 v21, v21, v89
  v_add_f32 v22, v22, v90
  v_add_f32 v23, v23, v91
  v_add_f32 v24, v24, v92
  v_add_f32 v25, v25, v93
  v_add_f32 v26, v26, v94
  v_add_f32 v27, v27, v95
  v_add_f32 v28, v28, v96
  v_add_f32 v29, v29, v97
  v_add_f32 v30, v30, v98
  v_add_f32 v31, v31, v99
  v_add_f32 v32, v32, v100
  v_add_f32 v33, v33, v101
  v_add_f32 v34, v34, v102
  v_add_f32 v35, v35, v103
  v_mov_b32 v8, v2
  v_add_u32 v9, 0x10000, v2
  v_add_u32 v10, 0x20000, v2
  ds_read_b128 v[40:43], v9 offset:18432
  ds_read_b128 v[44:47], v9 offset:19456
  ds_read_b128 v[48:51], v9 offset:20480
  ds_read_b128 v[52:55], v9 offset:21504
  ds_read_b128 v[56:59], v9 offset:22528
  ds_read_b128 v[60:63], v9 offset:23552
  ds_read_b128 v[64:67], v9 offset:24576
  ds_read_b128 v[68:71], v9 offset:25600
  ds_read_b128 v[72:75], v9 offset:26624
  ds_read_b128 v[76:79], v9 offset:27648
  s_cmp_eq_u32 s28, 0
  s_cbranch_scc0 WC_103
  s_lshl_b32 s43, s32, 3
  s_add_u32 s43, s43, 3
  s_mov_b64 exec, 0xff
  v_lshlrev_b32 v254, 2, v1
  s_mov_b32 s42, 400000
  s_nop 0
WCP_104:
  buffer_load_dword v255, v254, s[8:11], s39 offen sc1
  s_waitcnt vmcnt(0)
  v_cmp_gt_u32 vcc, s43, v255
  s_cmp_eq_u64 vcc, 0
  s_nop 3
  s_cbranch_scc1 WCP_done_105
  s_sub_u32 s42, s42, 1
  s_cmp_lg_u32 s42, 0
  s_cbranch_scc1 WCP_104
WCP_done_105:
  s_mov_b64 exec, -1
WC_103:
  s_barrier
  buffer_load_dwordx4 a[160:163], v2, s[8:11], s46 offen offset:0 sc1
  buffer_load_dwordx4 a[164:167], v2, s[8:11], s46 offen offset:1024 sc1
  buffer_load_dwordx4 a[168:171], v2, s[8:11], s46 offen offset:2048 sc1
  buffer_load_dwordx4 a[172:175], v2, s[8:11], s46 offen offset:3072 sc1
  s_add_u32 s46, s46, 4096
  buffer_load_dwordx4 a[176:179], v2, s[8:11], s46 offen offset:0 sc1
  buffer_load_dwordx4 a[180:183], v2, s[8:11], s46 offen offset:1024 sc1
  buffer_load_dwordx4 a[184:187], v2, s[8:11], s46 offen offset:2048 sc1
  buffer_load_dwordx4 a[188:191], v2, s[8:11], s46 offen offset:3072 sc1
  s_add_u32 s46, s46, 4096
  buffer_load_dwordx4 a[192:195], v2, s[8:11], s46 offen offset:0 sc1
  buffer_load_dwordx4 a[196:199], v2, s[8:11], s46 offen offset:1024 sc1
  buffer_load_dwordx4 a[200:203], v2, s[8:11], s46 offen offset:2048 sc1
  buffer_load_dwordx4 a[204:207], v2, s[8:11], s46 offen offset:3072 sc1
  s_add_u32 s46, s46, 4096
  buffer_load_dwordx4 a[208:211], v2, s[8:11], s46 offen offset:0 sc1
  buffer_load_dwordx4 a[212:215], v2, s[8:11], s46 offen offset:1024 sc1
  buffer_load_dwordx4 a[216:219], v2, s[8:11], s46 offen offset:2048 sc1
  buffer_load_dwordx4 a[220:223], v2, s[8:11], s46 offen offset:3072 sc1
  s_waitcnt vmcnt(15)
  s_waitcnt lgkmcnt(5)
  v_mfma_f32_16x16x32_bf16 v[16:19], v[40:43], a[160:163], v[16:19]
  ds_read_b128 v[80:83], v9 offset:28672
  v_mfma_f32_16x16x32_bf16 v[20:23], v[44:47], a[160:163], v[20:23]
  ds_read_b128 v[84:87], v9 offset:29696
  v_mfma_f32_16x16x32_bf16 v[24:27], v[48:51], a[160:163], v[24:27]
  ds_read_b128 v[88:91], v9 offset:30720
  v_mfma_f32_16x16x32_bf16 v[28:31], v[52:55], a[160:163], v[28:31]
  ds_read_b128 v[92:95], v9 offset:31744
  v_mfma_f32_16x16x32_bf16 v[32:35], v[56:59], a[160:163], v[32:35]
  ds_read_b128 v[96:99], v9 offset:32768
  s_add_u32 s46, s46, 4096
  buffer_load_dwordx4 a[224:227], v2, s[8:11], s46 offen offset:0 sc1
  s_waitcnt vmcnt(15)
  s_waitcnt lgkmcnt(5)
  v_mfma_f32_16x16x32_bf16 v[16:19], v[60:63], a[164:167], v[16:19]
  ds_read_b128 v[40:43], v9 offset:33792
  v_mfma_f32_16x16x32_bf16 v[20:23], v[64:67], a[164:167], v[20:23]
  ds_read_b128 v[44:47], v9 offset:34816
  v_mfma_f32_16x16x32_bf16 v[24:27], v[68:71], a[164:167], v[24:27]
  ds_read_b128 v[48:51], v9 offset:35840
  v_mfma_f32_16x16x32_bf16 v[28:31], v[72:75], a[164:167], v[28:31]
  ds_read_b128 v[52:55], v9 offset:36864
  v_mfma_f32_16x16x32_bf16 v[32:35], v[76:79], a[164:167], v[32:35]
  ds_read_b128 v[56:59], v9 offset:37888
  buffer_load_dwordx4 a[228:231], v2, s[8:11], s46 offen offset:1024 sc1
  s_waitcnt vmcnt(14)
  s_waitcnt lgkmcnt(5)
  v_mfma_f32_16x16x32_bf16 v[16:19], v[80:83], a[168:171], v[16:19]
  ds_read_b128 v[60:63], v9 offset:38912
  v_mfma_f32_16x16x32_bf16 v[20:23], v[84:87], a[168:171], v[20:23]
  ds_read_b128 v[64:67], v9 offset:39936
  v_mfma_f32_16x16x32_bf16 v[24:27], v[88:91], a[168:171], v[24:27]
  ds_read_b128 v[68:71], v9 offset:40960
  v_mfma_f32_16x16x32_bf16 v[28:31], v[92:95], a[168:171], v[28:31]
  ds_read_b128 v[72:75], v9 offset:41984
  v_mfma_f32_16x16x32_bf16 v[32:35], v[96:99], a[168:171], v[32:35]
  ds_read_b128 v[76:79], v9 offset:43008
  buffer_load_dwordx4 a[232:235], v2, s[8:11], s46 offen offset:2048 sc1
  s_waitcnt lgkmcnt(5)
  v_mfma_f32_16x16x32_bf16 v[16:19], v[40:43], a[172:175], v[16:19]
  ds_read_b128 v[80:83], v9 offset:44032
  v_mfma_f32_16x16x32_bf16 v[20:23], v[44:47], a[172:175], v[20:23]
  ds_read_b128 v[84:87], v9 offset:45056
  v_mfma_f32_16x16x32_bf16 v[24:27], v[48:51], a[172:175], v[24:27]
  ds_read_b128 v[88:91], v9 offset:46080
  v_mfma_f32_16x16x32_bf16 v[28:31], v[52:55], a[172:175], v[28:31]
  ds_read_b128 v[92:95], v9 offset:47104
  v_mfma_f32_16x16x32_bf16 v[32:35], v[56:59], a[172:175], v[32:35]
  ds_read_b128 v[96:99], v9 offset:48128
  buffer_load_dwordx4 a[236:239], v2, s[8:11], s46 offen offset:3072 sc1
  s_add_u32 s46, s46, 4096
  buffer_load_dwordx4 a[160:163], v2, s[8:11], s46 offen offset:0 sc1
  s_waitcnt vmcnt(15)
  s_waitcnt lgkmcnt(5)
  v_mfma_f32_16x16x32_bf16 v[16:19], v[60:63], a[176:179], v[16:19]
  ds_read_b128 v[40:43], v9 offset:49152
  v_mfma_f32_16x16x32_bf16 v[20:23], v[64:67], a[176:179], v[20:23]
  ds_read_b128 v[44:47], v9 offset:50176
  v_mfma_f32_16x16x32_bf16 v[24:27], v[68:71], a[176:179], v[24:27]
  ds_read_b128 v[48:51], v9 offset:51200
  v_mfma_f32_16x16x32_bf16 v[28:31], v[72:75], a[176:179], v[28:31]
  ds_read_b128 v[52:55], v9 offset:52224
  v_mfma_f32_16x16x32_bf16 v[32:35], v[76:79], a[176:179], v[32:35]
  ds_read_b128 v[56:59], v9 offset:53248
  buffer_load_dwordx4 a[164:167], v2, s[8:11], s46 offen offset:1024 sc1
  s_waitcnt lgkmcnt(5)
  v_mfma_f32_16x16x32_bf16 v[16:19], v[80:83], a[180:183], v[16:19]
  ds_read_b128 v[60:63], v9 offset:54272
  v_mfma_f32_16x16x32_bf16 v[20:23], v[84:87], a[180:183], v[20:23]
  ds_read_b128 v[64:67], v9 offset:55296
  v_mfma_f32_16x16x32_bf16 v[24:27], v[88:91], a[180:183], v[24:27]
  ds_read_b128 v[68:71], v9 offset:56320
  v_mfma_f32_16x16x32_bf16 v[28:31], v[92:95], a[180:183], v[28:31]
  ds_read_b128 v[72:75], v9 offset:57344
  v_mfma_f32_16x16x32_bf16 v[32:35], v[96:99], a[180:183], v[32:35]
  ds_read_b128 v[76:79], v9 offset:58368
  buffer_load_dwordx4 a[168:171], v2, s[8:11], s46 offen offset:2048 sc1
  s_waitcnt vmcnt(15)
  s_waitcnt lgkmcnt(5)
  v_mfma_f32_16x16x32_bf16 v[16:19], v[40:43], a[184:187], v[16:19]
  ds_read_b128 v[80:83], v9 offset:59392
  v_mfma_f32_16x16x32_bf16 v[20:23], v[44:47], a[184:187], v[20:23]
  ds_read_b128 v[84:87], v9 offset:60416
  v_mfma_f32_16x16x32_bf16 v[24:27], v[48:51], a[184:187], v[24:27]
  ds_read_b128 v[88:91], v9 offset:61440
  v_mfma_f32_16x16x32_bf16 v[28:31], v[52:55], a[184:187], v[28:31]
  ds_read_b128 v[92:95], v9 offset:62464
  v_mfma_f32_16x16x32_bf16 v[32:35], v[56:59], a[184:187], v[32:35]
  ds_read_b128 v[96:99], v9 offset:63488
  buffer_load_dwordx4 a[172:175], v2, s[8:11], s46 offen offset:3072 sc1
  s_add_u32 s46, s46, 4096
  buffer_load_dwordx4 a[176:179], v2, s[8:11], s46 offen offset:0 sc1
  s_waitcnt lgkmcnt(5)
  v_mfma_f32_16x16x32_bf16 v[16:19], v[60:63], a[188:191], v[16:19]
  ds_read_b128 v[40:43], v9 offset:64512
  v_mfma_f32_16x16x32_bf16 v[20:23], v[64:67], a[188:191], v[20:23]
  ds_read_b128 v[44:47], v10 offset:0
  v_mfma_f32_16x16x32_bf16 v[24:27], v[68:71], a[188:191], v[24:27]
  ds_read_b128 v[48:51], v10 offset:1024
  v_mfma_f32_16x16x32_bf16 v[28:31], v[72:75], a[188:191], v[28:31]
  ds_read_b128 v[52:55], v10 offset:2048
  v_mfma_f32_16x16x32_bf16 v[32:35], v[76:79], a[188:191], v[32:35]
  ds_read_b128 v[56:59], v10 offset:3072
  buffer_load_dwordx4 a[180:183], v2, s[8:11], s46 offen offset:1024 sc1
  s_waitcnt vmcnt(16)
  s_waitcnt lgkmcnt(5)
  v_mfma_f32_16x16x32_bf16 v[16:19], v[80:83], a[192:195], v[16:19]
  ds_read_b128 v[60:63], v10 offset:4096
  v_mfma_f32_16x16x32_bf16 v[20:23], v[84:87], a[192:195], v[20:23]
  ds_read_b128 v[64:67], v10 offset:5120
  v_mfma_f32_16x16x32_bf16 v[24:27], v[88:91], a[192:195], v[24:27]
  ds_read_b128 v[68:71], v10 offset:6144
  v_mfma_f32_16x16x32_bf16 v[28:31], v[92:95], a[192:195], v[28:31]
  ds_read_b128 v[72:75], v10 offset:7168
  v_mfma_f32_16x16x32_bf16 v[32:35], v[96:99], a[192:195], v[32:35]
  ds_read_b128 v[76:79], v10 offset:8192
  s_barrier
  s_sub_u32 s63, s28, 0
  s_mul_i32 s63, s63, 10240
  s_min_u32 s63, s63, 30720
  s_mul_i32 s62, s30, 245760
  s_add_u32 s62, s62, s63
  s_add_u32 s62, s62, 1100800
  s_add_u32 m0, s63, 83968
  s_add_u32 s41, s62, 0
  buffer_load_dwordx4 v2, s[8:11], s41 offen offset:0 sc1 lds
  s_waitcnt lgkmcnt(5)
  v_mfma_f32_16x16x32_bf16 v[16:19], v[40:43], a[196:199], v[16:19]
  ds_read_b128 v[80:83], v10 offset:9216
  v_mfma_f32_16x16x32_bf16 v[20:23], v[44:47], a[196:199], v[20:23]
  ds_read_b128 v[84:87], v10 offset:10240
  v_mfma_f32_16x16x32_bf16 v[24:27], v[48:51], a[196:199], v[24:27]
  ds_read_b128 v[88:91], v10 offset:11264
  v_mfma_f32_16x16x32_bf16 v[28:31], v[52:55], a[196:199], v[28:31]
  ds_read_b128 v[92:95], v10 offset:12288
  v_mfma_f32_16x16x32_bf16 v[32:35], v[56:59], a[196:199], v[32:35]
  ds_read_b128 v[96:99], v10 offset:13312
  buffer_load_dwordx4 v2, s[8:11], s41 offen offset:1024 sc1 lds
  buffer_load_dwordx4 v2, s[8:11], s41 offen offset:2048 sc1 lds
  s_waitcnt vmcnt(17)
  s_waitcnt lgkmcnt(5)
  v_mfma_f32_16x16x32_bf16 v[16:19], v[60:63], a[200:203], v[16:19]
  ds_read_b128 v[40:43], v10 offset:14336
  v_mfma_f32_16x16x32_bf16 v[20:23], v[64:67], a[200:203], v[20:23]
  ds_read_b128 v[44:47], v10 offset:15360
  v_mfma_f32_16x16x32_bf16 v[24:27], v[68:71], a[200:203], v[24:27]
  ds_read_b128 v[48:51], v10 offset:16384
  v_mfma_f32_16x16x32_bf16 v[28:31], v[72:75], a[200:203], v[28:31]
  ds_read_b128 v[52:55], v10 offset:17408
  v_mfma_f32_16x16x32_bf16 v[32:35], v[76:79], a[200:203], v[32:35]
  ds_read_b128 v[56:59], v10 offset:18432
  buffer_load_dwordx4 v2, s[8:11], s41 offen offset:3072 sc1 lds
  s_waitcnt lgkmcnt(5)
  v_mfma_f32_16x16x32_bf16 v[16:19], v[80:83], a[204:207], v[16:19]
  ds_read_b128 v[60:63], v10 offset:19456
  v_mfma_f32_16x16x32_bf16 v[20:23], v[84:87], a[204:207], v[20:23]
  ds_read_b128 v[64:67], v10 offset:20480
  v_mfma_f32_16x16x32_bf16 v[24:27], v[88:91], a[204:207], v[24:27]
  ds_read_b128 v[68:71], v10 offset:21504
  v_mfma_f32_16x16x32_bf16 v[28:31], v[92:95], a[204:207], v[28:31]
  ds_read_b128 v[72:75], v10 offset:22528
  v_mfma_f32_16x16x32_bf16 v[32:35], v[96:99], a[204:207], v[32:35]
  ds_read_b128 v[76:79], v10 offset:23552
  s_add_u32 m0, s63, 88064
  s_add_u32 s41, s62, 4096
  buffer_load_dwordx4 v2, s[8:11], s41 offen offset:0 sc1 lds
  s_waitcnt vmcnt(17)
  s_waitcnt lgkmcnt(5)
  v_mfma_f32_16x16x32_bf16 v[16:19], v[40:43], a[208:211], v[16:19]
  ds_read_b128 v[80:83], v10 offset:24576
  v_mfma_f32_16x16x32_bf16 v[20:23], v[44:47], a[208:211], v[20:23]
  ds_read_b128 v[84:87], v10 offset:25600
  v_mfma_f32_16x16x32_bf16 v[24:27], v[48:51], a[208:211], v[24:27]
  ds_read_b128 v[88:91], v10 offset:26624
  v_mfma_f32_16x16x32_bf16 v[28:31], v[52:55], a[208:211], v[28:31]
  ds_read_b128 v[92:95], v10 offset:27648
  v_mfma_f32_16x16x32_bf16 v[32:35], v[56:59], a[208:211], v[32:35]
  ds_read_b128 v[96:99], v10 offset:28672
  buffer_load_dwordx4 v2, s[8:11], s41 offen offset:1024 sc1 lds
  s_waitcnt lgkmcnt(5)
  v_mfma_f32_16x16x32_bf16 v[16:19], v[60:63], a[212:215], v[16:19]
  ds_read_b128 v[40:43], v8 offset:0
  v_mfma_f32_16x16x32_bf16 v[20:23], v[64:67], a[212:215], v[20:23]
  ds_read_b128 v[44:47], v8 offset:1024
  v_mfma_f32_16x16x32_bf16 v[24:27], v[68:71], a[212:215], v[24:27]
  ds_read_b128 v[48:51], v8 offset:2048
  v_mfma_f32_16x16x32_bf16 v[28:31], v[72:75], a[212:215], v[28:31]
  ds_read_b128 v[52:55], v8 offset:3072
  v_mfma_f32_16x16x32_bf16 v[32:35], v[76:79], a[212:215], v[32:35]
  ds_read_b128 v[56:59], v8 offset:4096
  buffer_load_dwordx4 v2, s[8:11], s41 offen offset:2048 sc1 lds
  buffer_load_dwordx4 v2, s[8:11], s41 offen offset:3072 sc1 lds
  s_waitcnt vmcnt(18)
  s_waitcnt lgkmcnt(5)
  v_mfma_f32_16x16x32_bf16 v[16:19], v[80:83], a[216:219], v[16:19]
  ds_read_b128 v[60:63], v8 offset:5120
  v_mfma_f32_16x16x32_bf16 v[20:23], v[84:87], a[216:219], v[20:23]
  ds_read_b128 v[64:67], v8 offset:6144
  v_mfma_f32_16x16x32_bf16 v[24:27], v[88:91], a[216:219], v[24:27]
  ds_read_b128 v[68:71], v8 offset:7168
  v_mfma_f32_16x16x32_bf16 v[28:31], v[92:95], a[216:219], v[28:31]
  ds_read_b128 v[72:75], v8 offset:8192
  v_mfma_f32_16x16x32_bf16 v[32:35], v[96:99], a[216:219], v[32:35]
  ds_read_b128 v[76:79], v8 offset:9216
  buffer_load_dwordx4 a[184:187], v2, s[8:11], s46 offen offset:2048 sc1
  s_waitcnt lgkmcnt(5)
  v_mfma_f32_16x16x32_bf16 v[16:19], v[40:43], a[220:223], v[16:19]
  ds_read_b128 v[80:83], v8 offset:10240
  v_mfma_f32_16x16x32_bf16 v[20:23], v[44:47], a[220:223], v[20:23]
  ds_read_b128 v[84:87], v8 offset:11264
  v_mfma_f32_16x16x32_bf16 v[24:27], v[48:51], a[220:223], v[24:27]
  ds_read_b128 v[88:91], v8 offset:12288
  v_mfma_f32_16x16x32_bf16 v[28:31], v[52:55], a[220:223], v[28:31]
  ds_read_b128 v[92:95], v8 offset:13312
  v_mfma_f32_16x16x32_bf16 v[32:35], v[56:59], a[220:223], v[32:35]
  ds_read_b128 v[96:99], v8 offset:14336
  s_add_u32 m0, s63, 92160
  s_add_u32 s41, s62, 8192
  buffer_load_dwordx4 v2, s[8:11], s41 offen offset:0 sc1 lds
  s_waitcnt vmcnt(18)
  s_waitcnt lgkmcnt(5)
  v_mfma_f32_16x16x32_bf16 v[16:19], v[60:63], a[224:227], v[16:19]
  ds_read_b128 v[40:43], v8 offset:15360
  v_mfma_f32_16x16x32_bf16 v[20:23], v[64:67], a[224:227], v[20:23]
  ds_read_b128 v[44:47], v8 offset:16384
  v_mfma_f32_16x16x32_bf16 v[24:27], v[68:71], a[224:227], v[24:27]
  ds_read_b128 v[48:51], v8 offset:17408
  v_mfma_f32_16x16x32_bf16 v[28:31], v[72:75], a[224:227], v[28:31]
  ds_read_b128 v[52:55], v8 offset:18432
  v_mfma_f32_16x16x32_bf16 v[32:35], v[76:79], a[224:227], v[32:35]
  ds_read_b128 v[56:59], v8 offset:19456
  buffer_load_dwordx4 a[188:191], v2, s[8:11], s46 offen offset:3072 sc1
  buffer_load_dwordx4 v2, s[8:11], s41 offen offset:1024 sc1 lds
  s_waitcnt lgkmcnt(5)
  v_mfma_f32_16x16x32_bf16 v[16:19], v[80:83], a[228:231], v[16:19]
  ds_read_b128 v[60:63], v8 offset:20480
  v_mfma_f32_16x16x32_bf16 v[20:23], v[84:87], a[228:231], v[20:23]
  ds_read_b128 v[64:67], v8 offset:21504
  v_mfma_f32_16x16x32_bf16 v[24:27], v[88:91], a[228:231], v[24:27]
  ds_read_b128 v[68:71], v8 offset:22528
  v_mfma_f32_16x16x32_bf16 v[28:31], v[92:95], a[228:231], v[28:31]
  ds_read_b128 v[72:75], v8 offset:23552
  v_mfma_f32_16x16x32_bf16 v[32:35], v[96:99], a[228:231], v[32:35]
  ds_read_b128 v[76:79], v8 offset:24576
  s_barrier
  s_sub_u32 s78, s28, 0
  s_mul_i32 s78, s78, 9216
  s_min_u32 s78, s78, 26624
  s_mul_i32 s77, s30, 245760
  s_add_u32 s77, s77, s78
  s_add_u32 s77, s77, 1141760
  s_sub_u32 s36, s28, 0
  s_mul_i32 s36, s36, 3072
  s_min_u32 s36, s36, 7168
  s_mul_i32 s79, s30, 245760
  s_add_u32 s79, s79, s36
  s_add_u32 s79, s79, 1177600
  s_add_u32 s46, s46, 4096
  buffer_load_dwordx4 a[192:195], v2, s[8:11], s46 offen offset:0 sc1
  s_waitcnt vmcnt(19)
  s_waitcnt lgkmcnt(5)
  v_mfma_f32_16x16x32_bf16 v[16:19], v[40:43], a[232:235], v[16:19]
  ds_read_b128 v[80:83], v8 offset:25600
  v_mfma_f32_16x16x32_bf16 v[20:23], v[44:47], a[232:235], v[20:23]
  ds_read_b128 v[84:87], v8 offset:26624
  v_mfma_f32_16x16x32_bf16 v[24:27], v[48:51], a[232:235], v[24:27]
  ds_read_b128 v[88:91], v8 offset:27648
  v_mfma_f32_16x16x32_bf16 v[28:31], v[52:55], a[232:235], v[28:31]
  ds_read_b128 v[92:95], v8 offset:28672
  v_mfma_f32_16x16x32_bf16 v[32:35], v[56:59], a[232:235], v[32:35]
  ds_read_b128 v[96:99], v8 offset:29696
  s_add_u32 m0, s78, 124928
  s_add_u32 s41, s77, 0
  buffer_load_dwordx4 v2, s[8:11], s41 offen offset:0 sc1 lds
  s_waitcnt lgkmcnt(5)
  v_mfma_f32_16x16x32_bf16 v[16:19], v[60:63], a[236:239], v[16:19]
  ds_read_b128 v[40:43], v8 offset:30720
  v_mfma_f32_16x16x32_bf16 v[20:23], v[64:67], a[236:239], v[20:23]
  ds_read_b128 v[44:47], v8 offset:31744
  v_mfma_f32_16x16x32_bf16 v[24:27], v[68:71], a[236:239], v[24:27]
  ds_read_b128 v[48:51], v8 offset:32768
  v_mfma_f32_16x16x32_bf16 v[28:31], v[72:75], a[236:239], v[28:31]
  ds_read_b128 v[52:55], v8 offset:33792
  v_mfma_f32_16x16x32_bf16 v[32:35], v[76:79], a[236:239], v[32:35]
  ds_read_b128 v[56:59], v8 offset:34816
  buffer_load_dwordx4 a[196:199], v2, s[8:11], s46 offen offset:1024 sc1
  buffer_load_dwordx4 v2, s[8:11], s41 offen offset:1024 sc1 lds
  s_waitcnt vmcnt(20)
  s_waitcnt lgkmcnt(5)
  v_mfma_f32_16x16x32_bf16 v[16:19], v[80:83], a[160:163], v[16:19]
  ds_read_b128 v[60:63], v8 offset:35840
  v_mfma_f32_16x16x32_bf16 v[20:23], v[84:87], a[160:163], v[20:23]
  ds_read_b128 v[64:67], v8 offset:36864
  v_mfma_f32_16x16x32_bf16 v[24:27], v[88:91], a[160:163], v[24:27]
  ds_read_b128 v[68:71], v8 offset:37888
  v_mfma_f32_16x16x32_bf16 v[28:31], v[92:95], a[160:163], v[28:31]
  ds_read_b128 v[72:75], v8 offset:38912
  v_mfma_f32_16x16x32_bf16 v[32:35], v[96:99], a[160:163], v[32:35]
  ds_read_b128 v[76:79], v8 offset:39936
  buffer_load_dwordx4 a[200:203], v2, s[8:11], s46 offen offset:2048 sc1
  s_waitcnt lgkmcnt(5)
  v_mfma_f32_16x16x32_bf16 v[16:19], v[40:43], a[164:167], v[16:19]
  ds_read_b128 v[80:83], v8 offset:40960
  v_mfma_f32_16x16x32_bf16 v[20:23], v[44:47], a[164:167], v[20:23]
  ds_read_b128 v[84:87], v8 offset:41984
  v_mfma_f32_16x16x32_bf16 v[24:27], v[48:51], a[164:167], v[24:27]
  ds_read_b128 v[88:91], v8 offset:43008
  v_mfma_f32_16x16x32_bf16 v[28:31], v[52:55], a[164:167], v[28:31]
  ds_read_b128 v[92:95], v8 offset:44032
  v_mfma_f32_16x16x32_bf16 v[32:35], v[56:59], a[164:167], v[32:35]
  ds_read_b128 v[96:99], v8 offset:45056
  buffer_load_dwordx4 v2, s[8:11], s41 offen offset:2048 sc1 lds
  buffer_load_dwordx4 v2, s[8:11], s41 offen offset:3072 sc1 lds
  buffer_load_dwordx4 a[204:207], v2, s[8:11], s46 offen offset:3072 sc1
  s_waitcnt vmcnt(22)
  s_waitcnt lgkmcnt(5)
  v_mfma_f32_16x16x32_bf16 v[16:19], v[60:63], a[168:171], v[16:19]
  ds_read_b128 v[40:43], v8 offset:46080
  v_mfma_f32_16x16x32_bf16 v[20:23], v[64:67], a[168:171], v[20:23]
  ds_read_b128 v[44:47], v8 offset:47104
  v_mfma_f32_16x16x32_bf16 v[24:27], v[68:71], a[168:171], v[24:27]
  ds_read_b128 v[48:51], v8 offset:48128
  v_mfma_f32_16x16x32_bf16 v[28:31], v[72:75], a[168:171], v[28:31]
  ds_read_b128 v[52:55], v8 offset:49152
  v_mfma_f32_16x16x32_bf16 v[32:35], v[76:79], a[168:171], v[32:35]
  ds_read_b128 v[56:59], v8 offset:50176
  s_add_u32 m0, s78, 129024
  s_add_u32 s41, s77, 4096
  buffer_load_dwordx4 v2, s[8:11], s41 offen offset:0 sc1 lds
  s_add_u32 s46, s46, 4096
  buffer_load_dwordx4 a[208:211], v2, s[8:11], s46 offen offset:0 sc1
  s_waitcnt lgkmcnt(5)
  v_mfma_f32_16x16x32_bf16 v[16:19], v[80:83], a[172:175], v[16:19]
  ds_read_b128 v[60:63], v8 offset:51200
  v_mfma_f32_16x16x32_bf16 v[20:23], v[84:87], a[172:175], v[20:23]
  ds_read_b128 v[64:67], v8 offset:52224
  v_mfma_f32_16x16x32_bf16 v[24:27], v[88:91], a[172:175], v[24:27]
  ds_read_b128 v[68:71], v8 offset:53248
  v_mfma_f32_16x16x32_bf16 v[28:31], v[92:95], a[172:175], v[28:31]
  ds_read_b128 v[72:75], v8 offset:54272
  v_mfma_f32_16x16x32_bf16 v[32:35], v[96:99], a[172:175], v[32:35]
  ds_read_b128 v[76:79], v8 offset:55296
  buffer_load_dwordx4 v2, s[8:11], s41 offen offset:1024 sc1 lds
  buffer_load_dwordx4 v2, s[8:11], s41 offen offset:2048 sc1 lds
  buffer_load_dwordx4 a[212:215], v2, s[8:11], s46 offen offset:1024 sc1
  s_waitcnt vmcnt(25)
  s_waitcnt lgkmcnt(5)
  v_mfma_f32_16x16x32_bf16 v[16:19], v[40:43], a[176:179], v[16:19]
  ds_read_b128 v[80:83], v8 offset:56320
  v_mfma_f32_16x16x32_bf16 v[20:23], v[44:47], a[176:179], v[20:23]
  ds_read_b128 v[84:87], v8 offset:57344
  v_mfma_f32_16x16x32_bf16 v[24:27], v[48:51], a[176:179], v[24:27]
  ds_read_b128 v[88:91], v8 offset:58368
  v_mfma_f32_16x16x32_bf16 v[28:31], v[52:55], a[176:179], v[28:31]
  ds_read_b128 v[92:95], v8 offset:59392
  v_mfma_f32_16x16x32_bf16 v[32:35], v[56:59], a[176:179], v[32:35]
  ds_read_b128 v[96:99], v8 offset:60416
  buffer_load_dwordx4 v2, s[8:11], s41 offen offset:3072 sc1 lds
  buffer_load_dwordx4 a[216:219], v2, s[8:11], s46 offen offset:2048 sc1
  s_waitcnt lgkmcnt(5)
  v_mfma_f32_16x16x32_bf16 v[16:19], v[60:63], a[180:183], v[16:19]
  ds_read_b128 v[40:43], v8 offset:61440
  v_mfma_f32_16x16x32_bf16 v[20:23], v[64:67], a[180:183], v[20:23]
  ds_read_b128 v[44:47], v8 offset:62464
  v_mfma_f32_16x16x32_bf16 v[24:27], v[68:71], a[180:183], v[24:27]
  ds_read_b128 v[48:51], v8 offset:63488
  v_mfma_f32_16x16x32_bf16 v[28:31], v[72:75], a[180:183], v[28:31]
  ds_read_b128 v[52:55], v8 offset:64512
  v_mfma_f32_16x16x32_bf16 v[32:35], v[76:79], a[180:183], v[32:35]
  ds_read_b128 v[56:59], v9 offset:0
  s_add_u32 m0, s78, 133120
  s_add_u32 s41, s77, 8192
  buffer_load_dwordx4 v2, s[8:11], s41 offen offset:0 sc1 lds
  s_add_u32 m0, s36, 0
  s_add_u32 s41, s79, 0
  buffer_load_dwordx4 v2, s[8:11], s41 offen offset:0 sc1 lds
  buffer_load_dwordx4 a[220:223], v2, s[8:11], s46 offen offset:3072 sc1
  s_waitcnt vmcnt(19)
  s_waitcnt lgkmcnt(5)
  v_mfma_f32_16x16x32_bf16 v[16:19], v[80:83], a[184:187], v[16:19]
  ds_read_b128 v[60:63], v9 offset:1024
  v_mfma_f32_16x16x32_bf16 v[20:23], v[84:87], a[184:187], v[20:23]
  ds_read_b128 v[64:67], v9 offset:2048
  v_mfma_f32_16x16x32_bf16 v[24:27], v[88:91], a[184:187], v[24:27]
  ds_read_b128 v[68:71], v9 offset:3072
  v_mfma_f32_16x16x32_bf16 v[28:31], v[92:95], a[184:187], v[28:31]
  ds_read_b128 v[72:75], v9 offset:4096
  v_mfma_f32_16x16x32_bf16 v[32:35], v[96:99], a[184:187], v[32:35]
  ds_read_b128 v[76:79], v9 offset:5120
  buffer_load_dwordx4 v2, s[8:11], s41 offen offset:1024 sc1 lds
  s_add_u32 s46, s46, 4096
  buffer_load_dwordx4 a[224:227], v2, s[8:11], s46 offen offset:0 sc1
  s_waitcnt lgkmcnt(5)
  v_mfma_f32_16x16x32_bf16 v[16:19], v[40:43], a[188:191], v[16:19]
  ds_read_b128 v[80:83], v9 offset:6144
  v_mfma_f32_16x16x32_bf16 v[20:23], v[44:47], a[188:191], v[20:23]
  ds_read_b128 v[84:87], v9 offset:7168
  v_mfma_f32_16x16x32_bf16 v[24:27], v[48:51], a[188:191], v[24:27]
  ds_read_b128 v[88:91], v9 offset:8192
  v_mfma_f32_16x16x32_bf16 v[28:31], v[52:55], a[188:191], v[28:31]
  ds_read_b128 v[92:95], v9 offset:9216
  v_mfma_f32_16x16x32_bf16 v[32:35], v[56:59], a[188:191], v[32:35]
  ds_read_b128 v[96:99], v9 offset:10240
  buffer_load_dwordx4 v2, s[8:11], s41 offen offset:2048 sc1 lds
  buffer_load_dwordx4 a[228:231], v2, s[8:11], s46 offen offset:1024 sc1
  s_waitcnt vmcnt(19)
  s_waitcnt lgkmcnt(5)
  v_mfma_f32_16x16x32_bf16 v[16:19], v[60:63], a[192:195], v[16:19]
  ds_read_b128 v[40:43], v9 offset:11264
  v_mfma_f32_16x16x32_bf16 v[20:23], v[64:67], a[192:195], v[20:23]
  ds_read_b128 v[44:47], v9 offset:12288
  v_mfma_f32_16x16x32_bf16 v[24:27], v[68:71], a[192:195], v[24:27]
  ds_read_b128 v[48:51], v9 offset:13312
  v_mfma_f32_16x16x32_bf16 v[28:31], v[72:75], a[192:195], v[28:31]
  ds_read_b128 v[52:55], v9 offset:14336
  v_mfma_f32_16x16x32_bf16 v[32:35], v[76:79], a[192:195], v[32:35]
  ds_read_b128 v[56:59], v9 offset:15360
  buffer_load_dwordx4 a[232:235], v2, s[8:11], s46 offen offset:2048 sc1
  s_barrier
  s_waitcnt lgkmcnt(5)
  v_mfma_f32_16x16x32_bf16 v[16:19], v[80:83], a[196:199], v[16:19]
  ds_read_b128 v[60:63], v9 offset:18432
  v_mfma_f32_16x16x32_bf16 v[20:23], v[84:87], a[196:199], v[20:23]
  ds_read_b128 v[64:67], v9 offset:19456
  v_mfma_f32_16x16x32_bf16 v[24:27], v[88:91], a[196:199], v[24:27]
  ds_read_b128 v[68:71], v9 offset:20480
  v_mfma_f32_16x16x32_bf16 v[28:31], v[92:95], a[196:199], v[28:31]
  ds_read_b128 v[72:75], v9 offset:21504
  v_mfma_f32_16x16x32_bf16 v[32:35], v[96:99], a[196:199], v[32:35]
  ds_read_b128 v[76:79], v9 offset:22528
  buffer_load_dwordx4 a[236:239], v2, s[8:11], s46 offen offset:3072 sc1
  s_waitcnt vmcnt(16)
  s_waitcnt lgkmcnt(5)
  v_mfma_f32_16x16x32_bf16 v[16:19], v[40:43], a[200:203], v[16:19]
  ds_read_b128 v[80:83], v9 offset:23552
  v_mfma_f32_16x16x32_bf16 v[20:23], v[44:47], a[200:203], v[20:23]
  ds_read_b128 v[84:87], v9 offset:24576
  v_mfma_f32_16x16x32_bf16 v[24:27], v[48:51], a[200:203], v[24:27]
  ds_read_b128 v[88:91], v9 offset:25600
  v_mfma_f32_16x16x32_bf16 v[28:31], v[52:55], a[200:203], v[28:31]
  ds_read_b128 v[92:95], v9 offset:26624
  v_mfma_f32_16x16x32_bf16 v[32:35], v[56:59], a[200:203], v[32:35]
  ds_read_b128 v[96:99], v9 offset:27648
  s_add_u32 s46, s46, 4096
  buffer_load_dwordx4 a[160:163], v2, s[8:11], s46 offen offset:0 sc1
  s_waitcnt lgkmcnt(5)
  v_mfma_f32_16x16x32_bf16 v[16:19], v[60:63], a[204:207], v[16:19]
  ds_read_b128 v[40:43], v9 offset:28672
  v_mfma_f32_16x16x32_bf16 v[20:23], v[64:67], a[204:207], v[20:23]
  ds_read_b128 v[44:47], v9 offset:29696
  v_mfma_f32_16x16x32_bf16 v[24:27], v[68:71], a[204:207], v[24:27]
  ds_read_b128 v[48:51], v9 offset:30720
  v_mfma_f32_16x16x32_bf16 v[28:31], v[72:75], a[204:207], v[28:31]
  ds_read_b128 v[52:55], v9 offset:31744
  v_mfma_f32_16x16x32_bf16 v[32:35], v[76:79], a[204:207], v[32:35]
  ds_read_b128 v[56:59], v9 offset:32768
  buffer_load_dwordx4 a[164:167], v2, s[8:11], s46 offen offset:1024 sc1
  s_waitcnt vmcnt(13)
  s_waitcnt lgkmcnt(5)
  v_mfma_f32_16x16x32_bf16 v[16:19], v[80:83], a[208:211], v[16:19]
  ds_read_b128 v[60:63], v9 offset:33792
  v_mfma_f32_16x16x32_bf16 v[20:23], v[84:87], a[208:211], v[20:23]
  ds_read_b128 v[64:67], v9 offset:34816
  v_mfma_f32_16x16x32_bf16 v[24:27], v[88:91], a[208:211], v[24:27]
  ds_read_b128 v[68:71], v9 offset:35840
  v_mfma_f32_16x16x32_bf16 v[28:31], v[92:95], a[208:211], v[28:31]
  ds_read_b128 v[72:75], v9 offset:36864
  v_mfma_f32_16x16x32_bf16 v[32:35], v[96:99], a[208:211], v[32:35]
  ds_read_b128 v[76:79], v9 offset:37888
  buffer_load_dwordx4 a[168:171], v2, s[8:11], s46 offen offset:2048 sc1
  s_waitcnt lgkmcnt(5)
  v_mfma_f32_16x16x32_bf16 v[16:19], v[40:43], a[212:215], v[16:19]
  ds_read_b128 v[80:83], v9 offset:38912
  v_mfma_f32_16x16x32_bf16 v[20:23], v[44:47], a[212:215], v[20:23]
  ds_read_b128 v[84:87], v9 offset:39936
  v_mfma_f32_16x16x32_bf16 v[24:27], v[48:51], a[212:215], v[24:27]
  ds_read_b128 v[88:91], v9 offset:40960
  v_mfma_f32_16x16x32_bf16 v[28:31], v[52:55], a[212:215], v[28:31]
  ds_read_b128 v[92:95], v9 offset:41984
  v_mfma_f32_16x16x32_bf16 v[32:35], v[56:59], a[212:215], v[32:35]
  ds_read_b128 v[96:99], v9 offset:43008
  buffer_load_dwordx4 a[172:175], v2, s[8:11], s46 offen offset:3072 sc1
  s_waitcnt vmcnt(10)
  s_waitcnt lgkmcnt(5)
  v_mfma_f32_16x16x32_bf16 v[16:19], v[60:63], a[216:219], v[16:19]
  ds_read_b128 v[40:43], v9 offset:44032
  v_mfma_f32_16x16x32_bf16 v[20:23], v[64:67], a[216:219], v[20:23]
  ds_read_b128 v[44:47], v9 offset:45056
  v_mfma_f32_16x16x32_bf16 v[24:27], v[68:71], a[216:219], v[24:27]
  ds_read_b128 v[48:51], v9 offset:46080
  v_mfma_f32_16x16x32_bf16 v[28:31], v[72:75], a[216:219], v[28:31]
  ds_read_b128 v[52:55], v9 offset:47104
  v_mfma_f32_16x16x32_bf16 v[32:35], v[76:79], a[216:219], v[32:35]
  ds_read_b128 v[56:59], v9 offset:48128
  s_add_u32 s46, s46, 4096
  buffer_load_dwordx4 a[176:179], v2, s[8:11], s46 offen offset:0 sc1
  s_waitcnt lgkmcnt(5)
  v_mfma_f32_16x16x32_bf16 v[16:19], v[80:83], a[220:223], v[16:19]
  ds_read_b128 v[60:63], v9 offset:49152
  v_mfma_f32_16x16x32_bf16 v[20:23], v[84:87], a[220:223], v[20:23]
  ds_read_b128 v[64:67], v9 offset:50176
  v_mfma_f32_16x16x32_bf16 v[24:27], v[88:91], a[220:223], v[24:27]
  ds_read_b128 v[68:71], v9 offset:51200
  v_mfma_f32_16x16x32_bf16 v[28:31], v[92:95], a[220:223], v[28:31]
  ds_read_b128 v[72:75], v9 offset:52224
  v_mfma_f32_16x16x32_bf16 v[32:35], v[96:99], a[220:223], v[32:35]
  ds_read_b128 v[76:79], v9 offset:53248
  buffer_load_dwordx4 a[180:183], v2, s[8:11], s46 offen offset:1024 sc1
  s_waitcnt vmcnt(8)
  s_waitcnt lgkmcnt(5)
  v_mfma_f32_16x16x32_bf16 v[16:19], v[40:43], a[224:227], v[16:19]
  ds_read_b128 v[80:83], v9 offset:54272
  v_mfma_f32_16x16x32_bf16 v[20:23], v[44:47], a[224:227], v[20:23]
  ds_read_b128 v[84:87], v9 offset:55296
  v_mfma_f32_16x16x32_bf16 v[24:27], v[48:51], a[224:227], v[24:27]
  ds_read_b128 v[88:91], v9 offset:56320
  v_mfma_f32_16x16x32_bf16 v[28:31], v[52:55], a[224:227], v[28:31]
  ds_read_b128 v[92:95], v9 offset:57344
  v_mfma_f32_16x16x32_bf16 v[32:35], v[56:59], a[224:227], v[32:35]
  ds_read_b128 v[96:99], v9 offset:58368
  buffer_load_dwordx4 a[184:187], v2, s[8:11], s46 offen offset:2048 sc1
  s_barrier
  s_waitcnt lgkmcnt(5)
  v_mfma_f32_16x16x32_bf16 v[16:19], v[60:63], a[228:231], v[16:19]
  ds_read_b128 v[40:43], v9 offset:59392
  v_mfma_f32_16x16x32_bf16 v[20:23], v[64:67], a[228:231], v[20:23]
  ds_read_b128 v[44:47], v9 offset:60416
  v_mfma_f32_16x16x32_bf16 v[24:27], v[68:71], a[228:231], v[24:27]
  ds_read_b128 v[48:51], v9 offset:61440
  v_mfma_f32_16x16x32_bf16 v[28:31], v[72:75], a[228:231], v[28:31]
  ds_read_b128 v[52:55], v9 offset:62464
  v_mfma_f32_16x16x32_bf16 v[32:35], v[76:79], a[228:231], v[32:35]
  ds_read_b128 v[56:59], v9 offset:63488
  buffer_load_dwordx4 a[188:191], v2, s[8:11], s46 offen offset:3072 sc1
  s_waitcnt vmcnt(8)
  s_waitcnt lgkmcnt(5)
  v_mfma_f32_16x16x32_bf16 v[16:19], v[80:83], a[232:235], v[16:19]
  ds_read_b128 v[60:63], v9 offset:64512
  v_mfma_f32_16x16x32_bf16 v[20:23], v[84:87], a[232:235], v[20:23]
  ds_read_b128 v[64:67], v10 offset:0
  v_mfma_f32_16x16x32_bf16 v[24:27], v[88:91], a[232:235], v[24:27]
  ds_read_b128 v[68:71], v10 offset:1024
  v_mfma_f32_16x16x32_bf16 v[28:31], v[92:95], a[232:235], v[28:31]
  ds_read_b128 v[72:75], v10 offset:2048
  v_mfma_f32_16x16x32_bf16 v[32:35], v[96:99], a[232:235], v[32:35]
  ds_read_b128 v[76:79], v10 offset:3072
  s_waitcnt lgkmcnt(5)
  v_mfma_f32_16x16x32_bf16 v[16:19], v[40:43], a[236:239], v[16:19]
  ds_read_b128 v[80:83], v10 offset:4096
  v_mfma_f32_16x16x32_bf16 v[20:23], v[44:47], a[236:239], v[20:23]
  ds_read_b128 v[84:87], v10 offset:5120
  v_mfma_f32_16x16x32_bf16 v[24:27], v[48:51], a[236:239], v[24:27]
  ds_read_b128 v[88:91], v10 offset:6144
  v_mfma_f32_16x16x32_bf16 v[28:31], v[52:55], a[236:239], v[28:31]
  ds_read_b128 v[92:95], v10 offset:7168
  v_mfma_f32_16x16x32_bf16 v[32:35], v[56:59], a[236:239], v[32:35]
  ds_read_b128 v[96:99], v10 offset:8192
  s_waitcnt vmcnt(6)
  s_waitcnt lgkmcnt(5)
  v_mfma_f32_16x16x32_bf16 v[16:19], v[60:63], a[160:163], v[16:19]
  ds_read_b128 v[40:43], v10 offset:9216
  v_mfma_f32_16x16x32_bf16 v[20:23], v[64:67], a[160:163], v[20:23]
  ds_read_b128 v[44:47], v10 offset:10240
  v_mfma_f32_16x16x32_bf16 v[24:27], v[68:71], a[160:163], v[24:27]
  ds_read_b128 v[48:51], v10 offset:11264
  v_mfma_f32_16x16x32_bf16 v[28:31], v[72:75], a[160:163], v[28:31]
  ds_read_b128 v[52:55], v10 offset:12288
  v_mfma_f32_16x16x32_bf16 v[32:35], v[76:79], a[160:163], v[32:35]
  ds_read_b128 v[56:59], v10 offset:13312
  s_waitcnt lgkmcnt(5)
  v_mfma_f32_16x16x32_bf16 v[16:19], v[80:83], a[164:167], v[16:19]
  ds_read_b128 v[60:63], v10 offset:14336
  v_mfma_f32_16x16x32_bf16 v[20:23], v[84:87], a[164:167], v[20:23]
  ds_read_b128 v[64:67], v10 offset:15360
  v_mfma_f32_16x16x32_bf16 v[24:27], v[88:91], a[164:167], v[24:27]
  ds_read_b128 v[68:71], v10 offset:16384
  v_mfma_f32_16x16x32_bf16 v[28:31], v[92:95], a[164:167], v[28:31]
  ds_read_b128 v[72:75], v10 offset:17408
  v_mfma_f32_16x16x32_bf16 v[32:35], v[96:99], a[164:167], v[32:35]
  ds_read_b128 v[76:79], v10 offset:18432
  s_waitcnt vmcnt(4)
  s_waitcnt lgkmcnt(5)
  v_mfma_f32_16x16x32_bf16 v[16:19], v[40:43], a[168:171], v[16:19]
  ds_read_b128 v[80:83], v10 offset:19456
  v_mfma_f32_16x16x32_bf16 v[20:23], v[44:47], a[168:171], v[20:23]
  ds_read_b128 v[84:87], v10 offset:20480
  v_mfma_f32_16x16x32_bf16 v[24:27], v[48:51], a[168:171], v[24:27]
  ds_read_b128 v[88:91], v10 offset:21504
  v_mfma_f32_16x16x32_bf16 v[28:31], v[52:55], a[168:171], v[28:31]
  ds_read_b128 v[92:95], v10 offset:22528
  v_mfma_f32_16x16x32_bf16 v[32:35], v[56:59], a[168:171], v[32:35]
  ds_read_b128 v[96:99], v10 offset:23552
  s_waitcnt lgkmcnt(5)
  v_mfma_f32_16x16x32_bf16 v[16:19], v[60:63], a[172:175], v[16:19]
  ds_read_b128 v[40:43], v10 offset:24576
  v_mfma_f32_16x16x32_bf16 v[20:23], v[64:67], a[172:175], v[20:23]
  ds_read_b128 v[44:47], v10 offset:25600
  v_mfma_f32_16x16x32_bf16 v[24:27], v[68:71], a[172:175], v[24:27]
  ds_read_b128 v[48:51], v10 offset:26624
  v_mfma_f32_16x16x32_bf16 v[28:31], v[72:75], a[172:175], v[28:31]
  ds_read_b128 v[52:55], v10 offset:27648
  v_mfma_f32_16x16x32_bf16 v[32:35], v[76:79], a[172:175], v[32:35]
  ds_read_b128 v[56:59], v10 offset:28672
  s_waitcnt vmcnt(2)
  s_waitcnt lgkmcnt(5)
  v_mfma_f32_16x16x32_bf16 v[16:19], v[80:83], a[176:179], v[16:19]
  ds_read_b128 v[60:63], v8 offset:0
  v_mfma_f32_16x16x32_bf16 v[20:23], v[84:87], a[176:179], v[20:23]
  ds_read_b128 v[64:67], v8 offset:1024
  v_mfma_f32_16x16x32_bf16 v[24:27], v[88:91], a[176:179], v[24:27]
  ds_read_b128 v[68:71], v8 offset:2048
  v_mfma_f32_16x16x32_bf16 v[28:31], v[92:95], a[176:179], v[28:31]
  ds_read_b128 v[72:75], v8 offset:3072
  v_mfma_f32_16x16x32_bf16 v[32:35], v[96:99], a[176:179], v[32:35]
  ds_read_b128 v[76:79], v8 offset:4096
  s_waitcnt lgkmcnt(5)
  v_mfma_f32_16x16x32_bf16 v[16:19], v[40:43], a[180:183], v[16:19]
  ds_read_b128 v[80:83], v8 offset:5120
  v_mfma_f32_16x16x32_bf16 v[20:23], v[44:47], a[180:183], v[20:23]
  ds_read_b128 v[84:87], v8 offset:6144
  v_mfma_f32_16x16x32_bf16 v[24:27], v[48:51], a[180:183], v[24:27]
  ds_read_b128 v[88:91], v8 offset:7168
  v_mfma_f32_16x16x32_bf16 v[28:31], v[52:55], a[180:183], v[28:31]
  ds_read_b128 v[92:95], v8 offset:8192
  v_mfma_f32_16x16x32_bf16 v[32:35], v[56:59], a[180:183], v[32:35]
  ds_read_b128 v[96:99], v8 offset:9216
  s_waitcnt vmcnt(0)
  s_waitcnt lgkmcnt(5)
  v_mfma_f32_16x16x32_bf16 v[16:19], v[60:63], a[184:187], v[16:19]
  v_mfma_f32_16x16x32_bf16 v[20:23], v[64:67], a[184:187], v[20:23]
  v_mfma_f32_16x16x32_bf16 v[24:27], v[68:71], a[184:187], v[24:27]
  v_mfma_f32_16x16x32_bf16 v[28:31], v[72:75], a[184:187], v[28:31]
  v_mfma_f32_16x16x32_bf16 v[32:35], v[76:79], a[184:187], v[32:35]
  s_waitcnt lgkmcnt(0)
  v_mfma_f32_16x16x32_bf16 v[16:19], v[80:83], a[188:191], v[16:19]
  v_mfma_f32_16x16x32_bf16 v[20:23], v[84:87], a[188:191], v[20:23]
  v_mfma_f32_16x16x32_bf16 v[24:27], v[88:91], a[188:191], v[24:27]
  v_mfma_f32_16x16x32_bf16 v[28:31], v[92:95], a[188:191], v[28:31]
  v_mfma_f32_16x16x32_bf16 v[32:35], v[96:99], a[188:191], v[32:35]
  s_cmp_eq_u32 s32, 0
  s_nop 6
  s_cbranch_scc0 F2_final_106
  s_mov_b32 s47, 16809984
  s_lshl_b32 s40, s29, 2
  s_add_u32 s40, s40, s28
  s_mul_i32 s40, s40, 20480
  s_add_u32 s42, s40, s47
  s_lshl_b32 s40, s30, 11
  s_add_u32 s40, s40, s42
  s_lshr_b32 s44, s30, 1
  s_add_u32 s44, s44, 16
  s_mul_i32 s44, s44, 1024
  s_and_b32 s41, s30, 1
  s_lshl_b32 s41, s41, 3
  s_add_u32 s44, s44, s41
  s_add_u32 s44, s44, s42
  v_cvt_pk_bf16_f32 v48, v16, v17
  v_cvt_pk_bf16_f32 v49, v18, v19
  v_cvt_pk_bf16_f32 v50, v20, v21
  v_cvt_pk_bf16_f32 v51, v22, v23
  v_cvt_pk_bf16_f32 v52, v24, v25
  v_cvt_pk_bf16_f32 v53, v26, v27
  v_cvt_pk_bf16_f32 v54, v28, v29
  v_cvt_pk_bf16_f32 v55, v30, v31
  v_cvt_pk_bf16_f32 v56, v32, v33
  v_cvt_pk_bf16_f32 v57, v34, v35
  s_cmp_eq_u32 s34, 0
  s_nop 0
  s_cbranch_scc1 HS_wt_108
  buffer_store_dwordx4 v[48:51], v2, s[8:11], s40 offen
  buffer_store_dwordx4 v[52:55], v2, s[8:11], s40 offen offset:1024
  buffer_store_dwordx2 v[56:57], v2, s[8:11], s44 offen
  s_nop 0
  s_branch HS_j_109
HS_wt_108:
  buffer_store_dwordx4 v[48:51], v2, s[8:11], s40 offen sc1
  buffer_store_dwordx4 v[52:55], v2, s[8:11], s40 offen offset:1024 sc1
  buffer_store_dwordx2 v[56:57], v2, s[8:11], s44 offen sc1
  s_nop 0
HS_j_109:
  v_accvgpr_write_b32 a246, v48
  v_accvgpr_write_b32 a247, v49
  v_accvgpr_write_b32 a248, v50
  v_accvgpr_write_b32 a249, v51
  v_accvgpr_write_b32 a250, v52
  v_accvgpr_write_b32 a251, v53
  v_accvgpr_write_b32 a252, v54
  v_accvgpr_write_b32 a253, v55
  v_accvgpr_write_b32 a254, v56
  v_accvgpr_write_b32 a255, v57
  s_waitcnt vmcnt(0)
  s_barrier
  s_cmp_eq_u32 s28, 0
  s_cbranch_scc0 SIG_110
  s_mov_b32 s43, 4
  v_mov_b32 v255, s43
  s_mov_b64 exec, 1
  s_cmp_eq_u32 s34, 0
  s_cbranch_scc1 HS_wt_111
  buffer_store_dword v255, off, s[8:11], s33
  s_branch HS_j_112
HS_wt_111:
  buffer_store_dword v255, off, s[8:11], s33 sc1
HS_j_112:
  s_mov_b64 exec, -1
SIG_110:
  s_branch F2_done_107
F2_final_106:
  s_lshl_b32 s40, s29, 6
  s_lshl_b32 s41, s28, 4
  s_add_u32 s40, s40, s41
  v_add_u32 v8, s40, v3
  v_mul_u32_u24 v8, 1280, v8
  v_lshlrev_b32 v9, 4, v4
  v_add_u32 v8, v8, v9
  s_lshl_b32 s40, s30, 7
  s_lshr_b32 s44, s30, 1
  s_add_u32 s44, s44, 16
  s_mul_i32 s44, s44, 64
  s_and_b32 s41, s30, 1
  s_lshl_b32 s41, s41, 3
  s_add_u32 s44, s44, s41
  v_cvt_pk_bf16_f32 v48, v16, v17
  v_cvt_pk_bf16_f32 v49, v18, v19
  v_cvt_pk_bf16_f32 v50, v20, v21
  v_cvt_pk_bf16_f32 v51, v22, v23
  v_cvt_pk_bf16_f32 v52, v24, v25
  v_cvt_pk_bf16_f32 v53, v26, v27
  v_cvt_pk_bf16_f32 v54, v28, v29
  v_cvt_pk_bf16_f32 v55, v30, v31
  v_cvt_pk_bf16_f32 v56, v32, v33
  v_cvt_pk_bf16_f32 v57, v34, v35
  buffer_store_dwordx4 v[48:51], v8, s[16:19], s40 offen
  buffer_store_dwordx4 v[52:55], v8, s[16:19], s40 offen offset:64
  buffer_store_dwordx2 v[56:57], v8, s[16:19], s44 offen
  s_waitcnt vmcnt(0)
F2_done_107:
  s_add_u32 s32, s32, 1
  s_cmp_lt_u32 s32, 2
  s_cbranch_scc1 L_LAYER
L_END:
  s_endpgm
.section .rodata,"a"
.p2align 6
.amdhsa_kernel interleave_layers__grouped_kv_mqa__dense_activation_gelu__prompt_kernel
  .amdhsa_next_free_vgpr 512
  .amdhsa_next_free_sgpr 102
  .amdhsa_accum_offset 256
  .amdhsa_group_segment_fixed_size 0
  .amdhsa_kernarg_size 104
  .amdhsa_user_sgpr_count 2
  .amdhsa_user_sgpr_kernarg_segment_ptr 1
  .amdhsa_system_sgpr_workgroup_id_x 1
.end_amdhsa_kernel
```
